```python
import torch

def _softmax(x, axis=-1):
    return torch.softmax(x, dim=axis)

def _gelu(x):
    return torch.nn.functional.gelu(x, approximate='tanh')

def _silu(x):
    return torch.nn.functional.silu(x)

def _sigmoid(x):
    return torch.sigmoid(x)

def _layernorm(x, axis=-1, eps=1e-05):
    m = x.mean(dim=axis, keepdim=True)
    v = x.var(dim=axis, keepdim=True, unbiased=False)
    return (x - m) / torch.sqrt(v + eps)

def _scatter_add(tgt, idx, src, axis=0):
    return tgt.clone().index_add_(axis, idx, src)

def _segment_sum(src, seg, n):
    out = torch.zeros((n,) + src.shape[1:], dtype=src.dtype)
    return out.index_add_(0, seg, src)

def _pad(x, pw):
    flat = tuple((v for pair in reversed(pw) for v in pair))
    return torch.nn.functional.pad(x, flat)
kernel_name = 'adaLN_cond__sliding_block_cached__mixer_gmlp__prompt'

def setup_inputs():

    _w = lambda a: (lambda t: t.to(torch.bfloat16) if t.is_floating_point() else t)(torch.as_tensor(a))

    def _A_setup():
        B, Sq, D = (1, 2048, 448)
        Hq, Hkv, Sk, Dh = (16, 8, 2048, 256)
        assert Hq % Hkv == 0, (Hq, Hkv)
        return {'x': _w((lambda *s: torch.randn(*s, dtype=torch.bfloat16) * 0.1)(B, Sq, D)), 'k_cache': _w((lambda *s: torch.randn(*s, dtype=torch.bfloat16) * 0.8)(B, Hkv, Sk, Dh)), 'v_cache': _w((lambda *s: torch.randn(*s, dtype=torch.bfloat16) * 1.6)(B, Hkv, Sk, Dh)), 'wq': _w((lambda *s: torch.randn(*s, dtype=torch.bfloat16) * 0.8)(D, Hq * Dh) * D ** (-0.5)), 'wo': _w((lambda *s: torch.randn(*s, dtype=torch.bfloat16) * 1.6)(Hq * Dh, D) * (Hq * Dh) ** (-0.5))}
    _A_in = _A_setup()

    def _B_setup():
        B, S, D, F = (1, 2048, 448, 1792)
        Fh = F // 2
        return {'x': _w((lambda *s: torch.randn(*s, dtype=torch.bfloat16) * 0.1)(B, S, D)), 'w_in': _w((lambda *s: torch.randn(*s, dtype=torch.bfloat16) * 1.6)(D, 2 * Fh)), 'w_sp': _w(0.01 * (lambda *s: torch.randn(*s, dtype=torch.bfloat16) * 1.6)(S, S)), 'b_sp': _w(1.0 + 0.01 * (lambda *s: torch.randn(*s, dtype=torch.bfloat16) * 0.2)(S)), 'w_out': _w((lambda *s: torch.randn(*s, dtype=torch.bfloat16) * 0.2)(Fh, D))}
    _B_in = _B_setup()
    return {'A_x': _A_in['x'], 'A_k_cache': _A_in['k_cache'], 'A_v_cache': _A_in['v_cache'], 'A_wq': _A_in['wq'], 'A_wo': _A_in['wo'], 'B_x': _B_in['x'], 'B_w_in': _B_in['w_in'], 'B_w_sp': _B_in['w_sp'], 'B_b_sp': _B_in['b_sp'], 'B_w_out': _B_in['w_out'], 'c': _w((lambda *s: torch.randn(*s, dtype=torch.bfloat16) * 0.8)(1, 448) * 8.0), 'w_mod': _w((lambda *s: torch.randn(*s, dtype=torch.bfloat16) * 0.8)(448, 6 * 448) * 448 ** (-0.5) * 8.0)}

def reference(A_x, A_k_cache, A_v_cache, A_wq, A_wo, B_x, B_w_in, B_w_sp, B_b_sp, B_w_out, c, w_mod):

    def _A_ref(x, k_cache, v_cache, wq, wo):
        B, Sq, D = x.shape
        Hq, Dh = (16, 256)
        Hkv, Sk = (k_cache.shape[1], k_cache.shape[2])
        W = min(4096, max(256, Sk // 4))
        rep = Hq // Hkv
        q = (lambda x, *d: x.permute(*d))((x @ wq).reshape(B, Sq, Hq, Dh), 0, 2, 1, 3)
        k = (lambda x, n, axis: torch.repeat_interleave(x, n, dim=axis))(k_cache[:, :, Sk - W:, :], rep, axis=1)
        v = (lambda x, n, axis: torch.repeat_interleave(x, n, dim=axis))(v_cache[:, :, Sk - W:, :], rep, axis=1)
        scores = torch.einsum('bhqd,bhkd->bhqk', q, k) * Dh ** (-0.5)
        p = _softmax(scores, axis=-1)
        o = torch.einsum('bhqk,bhkd->bhqd', p, v)
        return (lambda x, *d: x.permute(*d))(o, 0, 2, 1, 3).reshape(B, Sq, Hq * Dh) @ wo

    def _B_ref(x, w_in, w_sp, b_sp, w_out):
        B, S, D = x.shape
        F = w_in.shape[-1]
        Fh = F // 2
        z = _gelu(torch.einsum('bsd,df->bsf', x, w_in))
        z1 = z[..., :Fh].clone()
        z2 = _layernorm(z[..., Fh:], axis=-1)
        g = torch.einsum('ts,bsf->btf', w_sp, z2) + b_sp[None, :, None]
        return torch.einsum('bsf,fd->bsd', z1 * g, w_out)
    x = A_x
    mod = (_silu(c) @ w_mod).reshape(c.shape[0], 6, 1, -1)
    sa, ca, ga, sb, cb, gb = (mod[:, 0].clone(), mod[:, 1].clone(), mod[:, 2].clone(), mod[:, 3].clone(), mod[:, 4].clone(), mod[:, 5].clone())
    h = _layernorm(x, axis=-1) * (1 + ca) + sa
    x = x + ga * _A_ref(h, A_k_cache, A_v_cache, A_wq, A_wo)
    h = _layernorm(x, axis=-1) * (1 + cb) + sb
    x = x + gb * _B_ref(h, B_w_in, B_w_sp, B_b_sp, B_w_out)
    return x
```

```asm
; @launch kernel=k1_kernel grid=(256,1,1) block=(256,1,1) lds=163840
; @launch kernel=k2a_kernel grid=(256,1,1) block=(448,1,1) lds=512
; @launch kernel=k2b_kernel grid=(256,1,1) block=(256,1,1) lds=163840
; @launch kernel=k3_kernel grid=(256,1,1) block=(256,1,1) lds=163840
; @launch kernel=k4_kernel grid=(224,1,1) block=(256,1,1) lds=114688
.amdgcn_target "amdgcn-amd-amdhsa--gfx950"
.text
.globl k1_kernel
.p2align 8
.type k1_kernel,@function
k1_kernel:
 s_cmp_ge_u32 s2, 256
 s_cbranch_scc1 K1_END
 s_load_dwordx2 s[40:41], s[0:1], 112
 s_load_dwordx4 s[44:47], s[0:1], 8
 s_load_dwordx4 s[48:51], s[0:1], 24
 v_mov_b32 v255, v0
 s_cmp_ge_u32 s2, 205
 s_cbranch_scc1 K0_END
 s_cmp_ge_u32 s2, 149
 s_cbranch_scc1 K0_PF
 s_load_dwordx2 s[4:5], s[0:1], 112
 s_cmp_ge_u32 s2, 84
 s_cbranch_scc1 K0_LN
 s_load_dwordx2 s[6:7], s[0:1], 80
 s_load_dwordx2 s[8:9], s[0:1], 88
 v_lshrrev_b32 v1, 2, v0
 v_and_b32 v2, 3, v0
 v_mul_u32_u24 v3, 5376, v1
 v_lshl_add_u32 v3, v2, 4, v3
 v_lshlrev_b32 v4, 1, v1
 s_lshl_b32 s10, s2, 6
 s_waitcnt lgkmcnt(0)
 s_mov_b32 s12, s6
 s_mov_b32 s13, s7
 s_mov_b32 s14, 0x380
 s_mov_b32 s15, 0x00020000
 s_mov_b32 s16, s8
 s_mov_b32 s17, s9
 s_mov_b32 s18, 0x24c000
 s_mov_b32 s19, 0x00020000
 s_mov_b32 s20, s4
 s_mov_b32 s21, s5
 s_mov_b32 s22, 0x2300000
 s_mov_b32 s23, 0x00020000
 buffer_load_ushort v8, v4, s[12:15], 0 offen offset:0
 buffer_load_ushort v9, v4, s[12:15], 0 offen offset:128
 buffer_load_ushort v10, v4, s[12:15], 0 offen offset:256
 buffer_load_ushort v11, v4, s[12:15], 0 offen offset:384
 buffer_load_ushort v12, v4, s[12:15], 0 offen offset:512
 buffer_load_ushort v13, v4, s[12:15], 0 offen offset:640
 buffer_load_ushort v14, v4, s[12:15], 0 offen offset:768
 buffer_load_dwordx4 v[16:19], v3, s[16:19], s10 offen
 s_add_u32 s10, s10, 344064
 buffer_load_dwordx4 v[20:23], v3, s[16:19], s10 offen
 s_add_u32 s10, s10, 344064
 buffer_load_dwordx4 v[24:27], v3, s[16:19], s10 offen
 s_add_u32 s10, s10, 344064
 buffer_load_dwordx4 v[28:31], v3, s[16:19], s10 offen
 s_add_u32 s10, s10, 344064
 buffer_load_dwordx4 v[32:35], v3, s[16:19], s10 offen
 s_add_u32 s10, s10, 344064
 buffer_load_dwordx4 v[36:39], v3, s[16:19], s10 offen
 s_add_u32 s10, s10, 344064
 buffer_load_dwordx4 v[40:43], v3, s[16:19], s10 offen
 s_mov_b32 s11, 0xbfb8aa3b
 s_waitcnt vmcnt(13)
 v_lshlrev_b32 v8, 16, v8
 s_waitcnt vmcnt(12)
 v_lshlrev_b32 v9, 16, v9
 s_waitcnt vmcnt(11)
 v_lshlrev_b32 v10, 16, v10
 s_waitcnt vmcnt(10)
 v_lshlrev_b32 v11, 16, v11
 s_waitcnt vmcnt(9)
 v_lshlrev_b32 v12, 16, v12
 s_waitcnt vmcnt(8)
 v_lshlrev_b32 v13, 16, v13
 s_waitcnt vmcnt(7)
 v_lshlrev_b32 v14, 16, v14
 v_mul_f32 v48, s11, v8
 v_mul_f32 v49, s11, v9
 v_mul_f32 v50, s11, v10
 v_mul_f32 v51, s11, v11
 v_mul_f32 v52, s11, v12
 v_mul_f32 v53, s11, v13
 v_mul_f32 v54, s11, v14
 v_exp_f32 v48, v48
 v_exp_f32 v49, v49
 v_exp_f32 v50, v50
 v_exp_f32 v51, v51
 v_exp_f32 v52, v52
 v_exp_f32 v53, v53
 v_exp_f32 v54, v54
 v_add_f32 v48, 1.0, v48
 v_add_f32 v49, 1.0, v49
 v_add_f32 v50, 1.0, v50
 v_add_f32 v51, 1.0, v51
 v_add_f32 v52, 1.0, v52
 v_add_f32 v53, 1.0, v53
 v_add_f32 v54, 1.0, v54
 v_rcp_f32 v48, v48
 v_rcp_f32 v49, v49
 v_rcp_f32 v50, v50
 v_rcp_f32 v51, v51
 v_rcp_f32 v52, v52
 v_rcp_f32 v53, v53
 v_rcp_f32 v54, v54
 v_mul_f32 v8, v8, v48
 v_mul_f32 v9, v9, v49
 v_mul_f32 v10, v10, v50
 v_mul_f32 v11, v11, v51
 v_mul_f32 v12, v12, v52
 v_mul_f32 v13, v13, v53
 v_mul_f32 v14, v14, v54
 v_cvt_pk_bf16_f32 v8, v8, v8
 v_cvt_pk_bf16_f32 v9, v9, v9
 v_cvt_pk_bf16_f32 v10, v10, v10
 v_cvt_pk_bf16_f32 v11, v11, v11
 v_cvt_pk_bf16_f32 v12, v12, v12
 v_cvt_pk_bf16_f32 v13, v13, v13
 v_cvt_pk_bf16_f32 v14, v14, v14
 v_lshlrev_b32 v8, 16, v8
 v_lshlrev_b32 v9, 16, v9
 v_lshlrev_b32 v10, 16, v10
 v_lshlrev_b32 v11, 16, v11
 v_lshlrev_b32 v12, 16, v12
 v_lshlrev_b32 v13, 16, v13
 v_lshlrev_b32 v14, 16, v14
 s_waitcnt vmcnt(6)
 v_lshlrev_b32 v64, 16, v16
 v_and_b32 v65, 0xffff0000, v16
 v_mul_f32 v56, v64, v8
 v_mul_f32 v57, v65, v8
 v_lshlrev_b32 v64, 16, v17
 v_and_b32 v65, 0xffff0000, v17
 v_mul_f32 v58, v64, v8
 v_mul_f32 v59, v65, v8
 v_lshlrev_b32 v64, 16, v18
 v_and_b32 v65, 0xffff0000, v18
 v_mul_f32 v60, v64, v8
 v_mul_f32 v61, v65, v8
 v_lshlrev_b32 v64, 16, v19
 v_and_b32 v65, 0xffff0000, v19
 v_mul_f32 v62, v64, v8
 v_mul_f32 v63, v65, v8
 s_waitcnt vmcnt(5)
 v_lshlrev_b32 v64, 16, v20
 v_and_b32 v65, 0xffff0000, v20
 v_fmac_f32 v56, v64, v9
 v_fmac_f32 v57, v65, v9
 v_lshlrev_b32 v64, 16, v21
 v_and_b32 v65, 0xffff0000, v21
 v_fmac_f32 v58, v64, v9
 v_fmac_f32 v59, v65, v9
 v_lshlrev_b32 v64, 16, v22
 v_and_b32 v65, 0xffff0000, v22
 v_fmac_f32 v60, v64, v9
 v_fmac_f32 v61, v65, v9
 v_lshlrev_b32 v64, 16, v23
 v_and_b32 v65, 0xffff0000, v23
 v_fmac_f32 v62, v64, v9
 v_fmac_f32 v63, v65, v9
 s_waitcnt vmcnt(4)
 v_lshlrev_b32 v64, 16, v24
 v_and_b32 v65, 0xffff0000, v24
 v_fmac_f32 v56, v64, v10
 v_fmac_f32 v57, v65, v10
 v_lshlrev_b32 v64, 16, v25
 v_and_b32 v65, 0xffff0000, v25
 v_fmac_f32 v58, v64, v10
 v_fmac_f32 v59, v65, v10
 v_lshlrev_b32 v64, 16, v26
 v_and_b32 v65, 0xffff0000, v26
 v_fmac_f32 v60, v64, v10
 v_fmac_f32 v61, v65, v10
 v_lshlrev_b32 v64, 16, v27
 v_and_b32 v65, 0xffff0000, v27
 v_fmac_f32 v62, v64, v10
 v_fmac_f32 v63, v65, v10
 s_waitcnt vmcnt(3)
 v_lshlrev_b32 v64, 16, v28
 v_and_b32 v65, 0xffff0000, v28
 v_fmac_f32 v56, v64, v11
 v_fmac_f32 v57, v65, v11
 v_lshlrev_b32 v64, 16, v29
 v_and_b32 v65, 0xffff0000, v29
 v_fmac_f32 v58, v64, v11
 v_fmac_f32 v59, v65, v11
 v_lshlrev_b32 v64, 16, v30
 v_and_b32 v65, 0xffff0000, v30
 v_fmac_f32 v60, v64, v11
 v_fmac_f32 v61, v65, v11
 v_lshlrev_b32 v64, 16, v31
 v_and_b32 v65, 0xffff0000, v31
 v_fmac_f32 v62, v64, v11
 v_fmac_f32 v63, v65, v11
 s_waitcnt vmcnt(2)
 v_lshlrev_b32 v64, 16, v32
 v_and_b32 v65, 0xffff0000, v32
 v_fmac_f32 v56, v64, v12
 v_fmac_f32 v57, v65, v12
 v_lshlrev_b32 v64, 16, v33
 v_and_b32 v65, 0xffff0000, v33
 v_fmac_f32 v58, v64, v12
 v_fmac_f32 v59, v65, v12
 v_lshlrev_b32 v64, 16, v34
 v_and_b32 v65, 0xffff0000, v34
 v_fmac_f32 v60, v64, v12
 v_fmac_f32 v61, v65, v12
 v_lshlrev_b32 v64, 16, v35
 v_and_b32 v65, 0xffff0000, v35
 v_fmac_f32 v62, v64, v12
 v_fmac_f32 v63, v65, v12
 s_waitcnt vmcnt(1)
 v_lshlrev_b32 v64, 16, v36
 v_and_b32 v65, 0xffff0000, v36
 v_fmac_f32 v56, v64, v13
 v_fmac_f32 v57, v65, v13
 v_lshlrev_b32 v64, 16, v37
 v_and_b32 v65, 0xffff0000, v37
 v_fmac_f32 v58, v64, v13
 v_fmac_f32 v59, v65, v13
 v_lshlrev_b32 v64, 16, v38
 v_and_b32 v65, 0xffff0000, v38
 v_fmac_f32 v60, v64, v13
 v_fmac_f32 v61, v65, v13
 v_lshlrev_b32 v64, 16, v39
 v_and_b32 v65, 0xffff0000, v39
 v_fmac_f32 v62, v64, v13
 v_fmac_f32 v63, v65, v13
 s_waitcnt vmcnt(0)
 v_lshlrev_b32 v64, 16, v40
 v_and_b32 v65, 0xffff0000, v40
 v_fmac_f32 v56, v64, v14
 v_fmac_f32 v57, v65, v14
 v_lshlrev_b32 v64, 16, v41
 v_and_b32 v65, 0xffff0000, v41
 v_fmac_f32 v58, v64, v14
 v_fmac_f32 v59, v65, v14
 v_lshlrev_b32 v64, 16, v42
 v_and_b32 v65, 0xffff0000, v42
 v_fmac_f32 v60, v64, v14
 v_fmac_f32 v61, v65, v14
 v_lshlrev_b32 v64, 16, v43
 v_and_b32 v65, 0xffff0000, v43
 v_fmac_f32 v62, v64, v14
 v_fmac_f32 v63, v65, v14
 v_add_f32_dpp v56, v56, v56 row_ror:4 row_mask:0xf bank_mask:0xf
 v_add_f32_dpp v57, v57, v57 row_ror:4 row_mask:0xf bank_mask:0xf
 v_add_f32_dpp v58, v58, v58 row_ror:4 row_mask:0xf bank_mask:0xf
 v_add_f32_dpp v59, v59, v59 row_ror:4 row_mask:0xf bank_mask:0xf
 v_add_f32_dpp v60, v60, v60 row_ror:4 row_mask:0xf bank_mask:0xf
 v_add_f32_dpp v61, v61, v61 row_ror:4 row_mask:0xf bank_mask:0xf
 v_add_f32_dpp v62, v62, v62 row_ror:4 row_mask:0xf bank_mask:0xf
 v_add_f32_dpp v63, v63, v63 row_ror:4 row_mask:0xf bank_mask:0xf
 v_add_f32_dpp v56, v56, v56 row_ror:8 row_mask:0xf bank_mask:0xf
 v_add_f32_dpp v57, v57, v57 row_ror:8 row_mask:0xf bank_mask:0xf
 v_add_f32_dpp v58, v58, v58 row_ror:8 row_mask:0xf bank_mask:0xf
 v_add_f32_dpp v59, v59, v59 row_ror:8 row_mask:0xf bank_mask:0xf
 v_add_f32_dpp v60, v60, v60 row_ror:8 row_mask:0xf bank_mask:0xf
 v_add_f32_dpp v61, v61, v61 row_ror:8 row_mask:0xf bank_mask:0xf
 v_add_f32_dpp v62, v62, v62 row_ror:8 row_mask:0xf bank_mask:0xf
 v_add_f32_dpp v63, v63, v63 row_ror:8 row_mask:0xf bank_mask:0xf
 v_lshrrev_b32 v5, 4, v0
 v_lshlrev_b32 v5, 7, v5
 v_lshl_add_u32 v5, v2, 5, v5
 v_add_u32 v5, 121856, v5
 v_and_b32 v6, 12, v0
 v_cmp_eq_u32 vcc, 0, v6
 s_and_saveexec_b64 s[24:25], vcc
 ds_write_b128 v5, v[56:59]
 ds_write_b128 v5, v[60:63] offset:16
 s_mov_b64 exec, s[24:25]
 s_waitcnt lgkmcnt(0)
 s_barrier
 v_cmp_gt_u32 vcc, 32, v0
 s_and_saveexec_b64 s[24:25], vcc
 s_cbranch_execz K0_END
 v_lshlrev_b32 v5, 2, v0
 v_add_u32 v6, 121856, v5
 ds_read_b32 v16, v6 offset:0
 ds_read_b32 v17, v6 offset:128
 ds_read_b32 v18, v6 offset:256
 ds_read_b32 v19, v6 offset:384
 ds_read_b32 v20, v6 offset:512
 ds_read_b32 v21, v6 offset:640
 ds_read_b32 v22, v6 offset:768
 ds_read_b32 v23, v6 offset:896
 ds_read_b32 v24, v6 offset:1024
 ds_read_b32 v25, v6 offset:1152
 ds_read_b32 v26, v6 offset:1280
 ds_read_b32 v27, v6 offset:1408
 ds_read_b32 v28, v6 offset:1536
 ds_read_b32 v29, v6 offset:1664
 ds_read_b32 v30, v6 offset:1792
 ds_read_b32 v31, v6 offset:1920
 s_waitcnt lgkmcnt(14)
 v_add_f32 v16, v16, v17
 s_waitcnt lgkmcnt(13)
 v_add_f32 v16, v16, v18
 s_waitcnt lgkmcnt(12)
 v_add_f32 v16, v16, v19
 s_waitcnt lgkmcnt(11)
 v_add_f32 v16, v16, v20
 s_waitcnt lgkmcnt(10)
 v_add_f32 v16, v16, v21
 s_waitcnt lgkmcnt(9)
 v_add_f32 v16, v16, v22
 s_waitcnt lgkmcnt(8)
 v_add_f32 v16, v16, v23
 s_waitcnt lgkmcnt(7)
 v_add_f32 v16, v16, v24
 s_waitcnt lgkmcnt(6)
 v_add_f32 v16, v16, v25
 s_waitcnt lgkmcnt(5)
 v_add_f32 v16, v16, v26
 s_waitcnt lgkmcnt(4)
 v_add_f32 v16, v16, v27
 s_waitcnt lgkmcnt(3)
 v_add_f32 v16, v16, v28
 s_waitcnt lgkmcnt(2)
 v_add_f32 v16, v16, v29
 s_waitcnt lgkmcnt(1)
 v_add_f32 v16, v16, v30
 s_waitcnt lgkmcnt(0)
 v_add_f32 v16, v16, v31
 v_cvt_pk_bf16_f32 v16, v16, v16
 v_lshlrev_b32 v16, 16, v16
 s_mov_b32 s26, 0
 s_sub_u32 s27, s2, 14
 s_cmp_lt_u32 s27, 14
 s_cselect_b32 s26, 1.0, s26
 s_sub_u32 s27, s2, 56
 s_cmp_lt_u32 s27, 14
 s_cselect_b32 s26, 1.0, s26
 v_add_f32 v16, s26, v16
 v_cvt_pk_bf16_f32 v16, v16, v16
 v_lshlrev_b32 v16, 16, v16
 s_cmp_lt_u32 s2, 28
 s_cselect_b32 s26, 0x3db8aa3b, 1.0
 v_mul_f32 v16, s26, v16
 s_lshl_b32 s10, s2, 7
 buffer_store_dword v16, v5, s[20:23], s10 offen offset:0 sc1
 s_branch K0_END
K0_LN:
 s_load_dwordx2 s[6:7], s[0:1], 0
 s_waitcnt lgkmcnt(0)
 s_mov_b32 s20, s4
 s_mov_b32 s21, s5
 s_mov_b32 s22, 0x2300000
 s_mov_b32 s23, 0x00020000
 s_cmp_eq_u32 s2, 148
 s_cbranch_scc1 K0_ZERO
 s_mov_b32 s12, s6
 s_mov_b32 s13, s7
 s_mov_b32 s14, 0x1c0000
 s_mov_b32 s15, 0x00020000
 s_sub_u32 s10, s2, 84
 s_mul_i32 s10, s10, 28672
 v_lshrrev_b32 v1, 3, v0
 v_and_b32 v2, 7, v0
 v_mul_u32_u24 v3, 896, v1
 v_lshl_add_u32 v3, v2, 4, v3
 buffer_load_dwordx4 v[4:7], v3, s[12:15], s10 offen offset:0
 buffer_load_dwordx4 v[8:11], v3, s[12:15], s10 offen offset:128
 buffer_load_dwordx4 v[12:15], v3, s[12:15], s10 offen offset:256
 buffer_load_dwordx4 v[16:19], v3, s[12:15], s10 offen offset:384
 buffer_load_dwordx4 v[20:23], v3, s[12:15], s10 offen offset:512
 buffer_load_dwordx4 v[24:27], v3, s[12:15], s10 offen offset:640
 buffer_load_dwordx4 v[28:31], v3, s[12:15], s10 offen offset:768
 s_sub_u32 s24, s2, 84
 s_lshl_b32 s24, s24, 12
 s_add_u32 s24, s24, 33554432
 v_lshlrev_b32 v88, 4, v0
 v_mov_b32 v92, -1
 v_mov_b32 v93, -1
 v_mov_b32 v94, -1
 v_mov_b32 v95, -1
 buffer_store_dwordx4 v[92:95], v88, s[20:23], s24 offen sc1
 s_waitcnt vmcnt(7)
 v_lshlrev_b32 v32, 16, v4
 v_and_b32 v33, 0xffff0000, v4
 v_lshlrev_b32 v34, 16, v5
 v_and_b32 v35, 0xffff0000, v5
 v_lshlrev_b32 v36, 16, v6
 v_and_b32 v37, 0xffff0000, v6
 v_lshlrev_b32 v38, 16, v7
 v_and_b32 v39, 0xffff0000, v7
 s_waitcnt vmcnt(6)
 v_lshlrev_b32 v40, 16, v8
 v_and_b32 v41, 0xffff0000, v8
 v_lshlrev_b32 v42, 16, v9
 v_and_b32 v43, 0xffff0000, v9
 v_lshlrev_b32 v44, 16, v10
 v_and_b32 v45, 0xffff0000, v10
 v_lshlrev_b32 v46, 16, v11
 v_and_b32 v47, 0xffff0000, v11
 s_waitcnt vmcnt(5)
 v_lshlrev_b32 v48, 16, v12
 v_and_b32 v49, 0xffff0000, v12
 v_lshlrev_b32 v50, 16, v13
 v_and_b32 v51, 0xffff0000, v13
 v_lshlrev_b32 v52, 16, v14
 v_and_b32 v53, 0xffff0000, v14
 v_lshlrev_b32 v54, 16, v15
 v_and_b32 v55, 0xffff0000, v15
 s_waitcnt vmcnt(4)
 v_lshlrev_b32 v56, 16, v16
 v_and_b32 v57, 0xffff0000, v16
 v_lshlrev_b32 v58, 16, v17
 v_and_b32 v59, 0xffff0000, v17
 v_lshlrev_b32 v60, 16, v18
 v_and_b32 v61, 0xffff0000, v18
 v_lshlrev_b32 v62, 16, v19
 v_and_b32 v63, 0xffff0000, v19
 s_waitcnt vmcnt(3)
 v_lshlrev_b32 v64, 16, v20
 v_and_b32 v65, 0xffff0000, v20
 v_lshlrev_b32 v66, 16, v21
 v_and_b32 v67, 0xffff0000, v21
 v_lshlrev_b32 v68, 16, v22
 v_and_b32 v69, 0xffff0000, v22
 v_lshlrev_b32 v70, 16, v23
 v_and_b32 v71, 0xffff0000, v23
 s_waitcnt vmcnt(2)
 v_lshlrev_b32 v72, 16, v24
 v_and_b32 v73, 0xffff0000, v24
 v_lshlrev_b32 v74, 16, v25
 v_and_b32 v75, 0xffff0000, v25
 v_lshlrev_b32 v76, 16, v26
 v_and_b32 v77, 0xffff0000, v26
 v_lshlrev_b32 v78, 16, v27
 v_and_b32 v79, 0xffff0000, v27
 s_waitcnt vmcnt(1)
 v_lshlrev_b32 v80, 16, v28
 v_and_b32 v81, 0xffff0000, v28
 v_lshlrev_b32 v82, 16, v29
 v_and_b32 v83, 0xffff0000, v29
 v_lshlrev_b32 v84, 16, v30
 v_and_b32 v85, 0xffff0000, v30
 v_lshlrev_b32 v86, 16, v31
 v_and_b32 v87, 0xffff0000, v31
 v_pk_add_f32 v[90:91], v[32:33], v[34:35]
 v_pk_add_f32 v[90:91], v[90:91], v[36:37]
 v_pk_add_f32 v[90:91], v[90:91], v[38:39]
 v_pk_add_f32 v[90:91], v[90:91], v[40:41]
 v_pk_add_f32 v[90:91], v[90:91], v[42:43]
 v_pk_add_f32 v[90:91], v[90:91], v[44:45]
 v_pk_add_f32 v[90:91], v[90:91], v[46:47]
 v_pk_add_f32 v[90:91], v[90:91], v[48:49]
 v_pk_add_f32 v[90:91], v[90:91], v[50:51]
 v_pk_add_f32 v[90:91], v[90:91], v[52:53]
 v_pk_add_f32 v[90:91], v[90:91], v[54:55]
 v_pk_add_f32 v[90:91], v[90:91], v[56:57]
 v_pk_add_f32 v[90:91], v[90:91], v[58:59]
 v_pk_add_f32 v[90:91], v[90:91], v[60:61]
 v_pk_add_f32 v[90:91], v[90:91], v[62:63]
 v_pk_add_f32 v[90:91], v[90:91], v[64:65]
 v_pk_add_f32 v[90:91], v[90:91], v[66:67]
 v_pk_add_f32 v[90:91], v[90:91], v[68:69]
 v_pk_add_f32 v[90:91], v[90:91], v[70:71]
 v_pk_add_f32 v[90:91], v[90:91], v[72:73]
 v_pk_add_f32 v[90:91], v[90:91], v[74:75]
 v_pk_add_f32 v[90:91], v[90:91], v[76:77]
 v_pk_add_f32 v[90:91], v[90:91], v[78:79]
 v_pk_add_f32 v[90:91], v[90:91], v[80:81]
 v_pk_add_f32 v[90:91], v[90:91], v[82:83]
 v_pk_add_f32 v[90:91], v[90:91], v[84:85]
 v_pk_add_f32 v[90:91], v[90:91], v[86:87]
 v_add_f32 v90, v90, v91
 s_nop 1
 v_add_f32_dpp v90, v90, v90 quad_perm:[1,0,3,2] row_mask:0xf bank_mask:0xf
 s_nop 1
 v_add_f32_dpp v90, v90, v90 quad_perm:[2,3,0,1] row_mask:0xf bank_mask:0xf
 s_nop 1
 v_add_f32_dpp v90, v90, v90 row_half_mirror row_mask:0xf bank_mask:0xf
 v_mul_f32 v90, 0xbb124925, v90
 v_mov_b32 v91, v90
 v_pk_add_f32 v[32:33], v[32:33], v[90:91]
 v_pk_add_f32 v[34:35], v[34:35], v[90:91]
 v_pk_add_f32 v[36:37], v[36:37], v[90:91]
 v_pk_add_f32 v[38:39], v[38:39], v[90:91]
 v_pk_add_f32 v[40:41], v[40:41], v[90:91]
 v_pk_add_f32 v[42:43], v[42:43], v[90:91]
 v_pk_add_f32 v[44:45], v[44:45], v[90:91]
 v_pk_add_f32 v[46:47], v[46:47], v[90:91]
 v_pk_add_f32 v[48:49], v[48:49], v[90:91]
 v_pk_add_f32 v[50:51], v[50:51], v[90:91]
 v_pk_add_f32 v[52:53], v[52:53], v[90:91]
 v_pk_add_f32 v[54:55], v[54:55], v[90:91]
 v_pk_add_f32 v[56:57], v[56:57], v[90:91]
 v_pk_add_f32 v[58:59], v[58:59], v[90:91]
 v_pk_add_f32 v[60:61], v[60:61], v[90:91]
 v_pk_add_f32 v[62:63], v[62:63], v[90:91]
 v_pk_add_f32 v[64:65], v[64:65], v[90:91]
 v_pk_add_f32 v[66:67], v[66:67], v[90:91]
 v_pk_add_f32 v[68:69], v[68:69], v[90:91]
 v_pk_add_f32 v[70:71], v[70:71], v[90:91]
 v_pk_add_f32 v[72:73], v[72:73], v[90:91]
 v_pk_add_f32 v[74:75], v[74:75], v[90:91]
 v_pk_add_f32 v[76:77], v[76:77], v[90:91]
 v_pk_add_f32 v[78:79], v[78:79], v[90:91]
 v_pk_add_f32 v[80:81], v[80:81], v[90:91]
 v_pk_add_f32 v[82:83], v[82:83], v[90:91]
 v_pk_add_f32 v[84:85], v[84:85], v[90:91]
 v_pk_add_f32 v[86:87], v[86:87], v[90:91]
 v_pk_mul_f32 v[92:93], v[32:33], v[32:33]
 v_pk_fma_f32 v[92:93], v[34:35], v[34:35], v[92:93]
 v_pk_fma_f32 v[92:93], v[36:37], v[36:37], v[92:93]
 v_pk_fma_f32 v[92:93], v[38:39], v[38:39], v[92:93]
 v_pk_fma_f32 v[92:93], v[40:41], v[40:41], v[92:93]
 v_pk_fma_f32 v[92:93], v[42:43], v[42:43], v[92:93]
 v_pk_fma_f32 v[92:93], v[44:45], v[44:45], v[92:93]
 v_pk_fma_f32 v[92:93], v[46:47], v[46:47], v[92:93]
 v_pk_fma_f32 v[92:93], v[48:49], v[48:49], v[92:93]
 v_pk_fma_f32 v[92:93], v[50:51], v[50:51], v[92:93]
 v_pk_fma_f32 v[92:93], v[52:53], v[52:53], v[92:93]
 v_pk_fma_f32 v[92:93], v[54:55], v[54:55], v[92:93]
 v_pk_fma_f32 v[92:93], v[56:57], v[56:57], v[92:93]
 v_pk_fma_f32 v[92:93], v[58:59], v[58:59], v[92:93]
 v_pk_fma_f32 v[92:93], v[60:61], v[60:61], v[92:93]
 v_pk_fma_f32 v[92:93], v[62:63], v[62:63], v[92:93]
 v_pk_fma_f32 v[92:93], v[64:65], v[64:65], v[92:93]
 v_pk_fma_f32 v[92:93], v[66:67], v[66:67], v[92:93]
 v_pk_fma_f32 v[92:93], v[68:69], v[68:69], v[92:93]
 v_pk_fma_f32 v[92:93], v[70:71], v[70:71], v[92:93]
 v_pk_fma_f32 v[92:93], v[72:73], v[72:73], v[92:93]
 v_pk_fma_f32 v[92:93], v[74:75], v[74:75], v[92:93]
 v_pk_fma_f32 v[92:93], v[76:77], v[76:77], v[92:93]
 v_pk_fma_f32 v[92:93], v[78:79], v[78:79], v[92:93]
 v_pk_fma_f32 v[92:93], v[80:81], v[80:81], v[92:93]
 v_pk_fma_f32 v[92:93], v[82:83], v[82:83], v[92:93]
 v_pk_fma_f32 v[92:93], v[84:85], v[84:85], v[92:93]
 v_pk_fma_f32 v[92:93], v[86:87], v[86:87], v[92:93]
 v_add_f32 v92, v92, v93
 s_nop 1
 v_add_f32_dpp v92, v92, v92 quad_perm:[1,0,3,2] row_mask:0xf bank_mask:0xf
 s_nop 1
 v_add_f32_dpp v92, v92, v92 quad_perm:[2,3,0,1] row_mask:0xf bank_mask:0xf
 s_nop 1
 v_add_f32_dpp v92, v92, v92 row_half_mirror row_mask:0xf bank_mask:0xf
 v_mov_b32 v93, 0x3727c5ac
 v_fmac_f32 v93, 0x3b124925, v92
 v_rsq_f32 v92, v93
 s_nop 0
 v_mov_b32 v93, v92
 v_pk_mul_f32 v[32:33], v[32:33], v[92:93]
 v_pk_mul_f32 v[34:35], v[34:35], v[92:93]
 v_pk_mul_f32 v[36:37], v[36:37], v[92:93]
 v_pk_mul_f32 v[38:39], v[38:39], v[92:93]
 v_pk_mul_f32 v[40:41], v[40:41], v[92:93]
 v_pk_mul_f32 v[42:43], v[42:43], v[92:93]
 v_pk_mul_f32 v[44:45], v[44:45], v[92:93]
 v_pk_mul_f32 v[46:47], v[46:47], v[92:93]
 v_pk_mul_f32 v[48:49], v[48:49], v[92:93]
 v_pk_mul_f32 v[50:51], v[50:51], v[92:93]
 v_pk_mul_f32 v[52:53], v[52:53], v[92:93]
 v_pk_mul_f32 v[54:55], v[54:55], v[92:93]
 v_pk_mul_f32 v[56:57], v[56:57], v[92:93]
 v_pk_mul_f32 v[58:59], v[58:59], v[92:93]
 v_pk_mul_f32 v[60:61], v[60:61], v[92:93]
 v_pk_mul_f32 v[62:63], v[62:63], v[92:93]
 v_pk_mul_f32 v[64:65], v[64:65], v[92:93]
 v_pk_mul_f32 v[66:67], v[66:67], v[92:93]
 v_pk_mul_f32 v[68:69], v[68:69], v[92:93]
 v_pk_mul_f32 v[70:71], v[70:71], v[92:93]
 v_pk_mul_f32 v[72:73], v[72:73], v[92:93]
 v_pk_mul_f32 v[74:75], v[74:75], v[92:93]
 v_pk_mul_f32 v[76:77], v[76:77], v[92:93]
 v_pk_mul_f32 v[78:79], v[78:79], v[92:93]
 v_pk_mul_f32 v[80:81], v[80:81], v[92:93]
 v_pk_mul_f32 v[82:83], v[82:83], v[92:93]
 v_pk_mul_f32 v[84:85], v[84:85], v[92:93]
 v_pk_mul_f32 v[86:87], v[86:87], v[92:93]
 v_cvt_pk_bf16_f32 v4, v32, v33
 v_cvt_pk_bf16_f32 v5, v34, v35
 v_cvt_pk_bf16_f32 v6, v36, v37
 v_cvt_pk_bf16_f32 v7, v38, v39
 v_cvt_pk_bf16_f32 v8, v40, v41
 v_cvt_pk_bf16_f32 v9, v42, v43
 v_cvt_pk_bf16_f32 v10, v44, v45
 v_cvt_pk_bf16_f32 v11, v46, v47
 v_cvt_pk_bf16_f32 v12, v48, v49
 v_cvt_pk_bf16_f32 v13, v50, v51
 v_cvt_pk_bf16_f32 v14, v52, v53
 v_cvt_pk_bf16_f32 v15, v54, v55
 v_cvt_pk_bf16_f32 v16, v56, v57
 v_cvt_pk_bf16_f32 v17, v58, v59
 v_cvt_pk_bf16_f32 v18, v60, v61
 v_cvt_pk_bf16_f32 v19, v62, v63
 v_cvt_pk_bf16_f32 v20, v64, v65
 v_cvt_pk_bf16_f32 v21, v66, v67
 v_cvt_pk_bf16_f32 v22, v68, v69
 v_cvt_pk_bf16_f32 v23, v70, v71
 v_cvt_pk_bf16_f32 v24, v72, v73
 v_cvt_pk_bf16_f32 v25, v74, v75
 v_cvt_pk_bf16_f32 v26, v76, v77
 v_cvt_pk_bf16_f32 v27, v78, v79
 v_cvt_pk_bf16_f32 v28, v80, v81
 v_cvt_pk_bf16_f32 v29, v82, v83
 v_cvt_pk_bf16_f32 v30, v84, v85
 v_cvt_pk_bf16_f32 v31, v86, v87
 s_add_u32 s10, s10, 262144
 v_lshlrev_b32 v3, 9, v2
 v_lshl_add_u32 v3, v1, 4, v3
 buffer_store_dwordx4 v[4:7], v3, s[20:23], s10 offen sc1
 s_add_u32 s10, s10, 4096
 buffer_store_dwordx4 v[8:11], v3, s[20:23], s10 offen sc1
 s_add_u32 s10, s10, 4096
 buffer_store_dwordx4 v[12:15], v3, s[20:23], s10 offen sc1
 s_add_u32 s10, s10, 4096
 buffer_store_dwordx4 v[16:19], v3, s[20:23], s10 offen sc1
 s_add_u32 s10, s10, 4096
 buffer_store_dwordx4 v[20:23], v3, s[20:23], s10 offen sc1
 s_add_u32 s10, s10, 4096
 buffer_store_dwordx4 v[24:27], v3, s[20:23], s10 offen sc1
 s_add_u32 s10, s10, 4096
 buffer_store_dwordx4 v[28:31], v3, s[20:23], s10 offen sc1
 s_branch K0_END
 s_waitcnt vmcnt(0)
K0_ZERO:
 v_lshlrev_b32 v1, 5, v0
 v_mov_b32 v4, 0
 v_mov_b32 v5, 0
 v_mov_b32 v6, 0
 v_mov_b32 v7, 0
 s_mov_b32 s10, 16384
 s_branch K0_END
K0_PF:
 s_load_dwordx2 s[4:5], s[0:1], 112
 s_load_dwordx2 s[6:7], s[0:1], 48
 v_lshrrev_b32 v1, 6, v0
 v_and_b32 v0, 63, v0
 v_readfirstlane_b32 s16, v1
 s_sub_u32 s3, s2, 149
 s_and_b32 s17, s3, 7
 s_lshr_b32 s18, s3, 3
 v_lshrrev_b32 v1, 4, v0
 v_mul_u32_u24 v2, 28672, v1
 v_and_b32 v3, 15, v0
 v_lshlrev_b32 v4, 4, v3
 v_add_u32 v5, 1792, v4
 v_add_u32 v4, -32, v4
 v_cmp_gt_u32 vcc, 14, v3
 s_nop 1
 v_cndmask_b32 v4, v4, v5, vcc
 v_add_u32 v2, v2, v4
 v_add_u32 v3, 0, v0
 v_mul_u32_u24 v4, 171, v3
 v_lshrrev_b32 v4, 11, v4
 v_mul_u32_u24 v5, 12, v4
 v_sub_u32 v5, v3, v5
 v_mul_u32_u24 v4, 3584, v4
 v_lshl_add_u32 v6, v5, 4, v4
 v_add_u32 v3, 64, v0
 v_mul_u32_u24 v4, 171, v3
 v_lshrrev_b32 v4, 11, v4
 v_mul_u32_u24 v5, 12, v4
 v_sub_u32 v5, v3, v5
 v_mul_u32_u24 v4, 3584, v4
 v_lshl_add_u32 v7, v5, 4, v4
 v_add_u32 v3, 128, v0
 v_mul_u32_u24 v4, 171, v3
 v_lshrrev_b32 v4, 11, v4
 v_mul_u32_u24 v5, 12, v4
 v_sub_u32 v5, v3, v5
 v_mul_u32_u24 v4, 3584, v4
 v_lshl_add_u32 v8, v5, 4, v4
 v_lshlrev_b32 v1, 4, v0
 s_mul_i32 s19, s18, 229376
 s_mul_i32 s20, s17, 224
 s_add_u32 s19, s19, s20
 s_lshr_b32 s20, s16, 1
 s_lshl_b32 s20, s20, 5
 s_and_b32 s21, s16, 1
 s_lshl_b32 s21, s21, 2
 s_add_u32 s20, s20, s21
 s_mul_i32 s20, s20, 3584
 s_add_u32 s20, s20, s19
 s_mul_i32 s21, s16, 57344
 s_add_u32 s21, s21, s19
 s_mul_i32 s22, s17, 7
 s_add_u32 s22, s22, s18
 s_lshl_b32 s22, s22, 2
 s_add_u32 s22, s22, s16
 s_mul_i32 s23, s22, 3072
 s_add_u32 s23, s23, 35520512
 s_lshl_b32 s22, s22, 12
 s_add_u32 s22, s22, 34603008
 s_waitcnt lgkmcnt(0)
 s_mov_b32 s8, s4
 s_mov_b32 s9, s5
 s_mov_b32 s10, 0x2300000
 s_mov_b32 s11, 0x00020000
 s_mov_b32 s12, s6
 s_mov_b32 s13, s7
 s_mov_b32 s14, 0x188000
 s_mov_b32 s15, 0x00020000
 buffer_load_dwordx4 v[12:15], v2, s[12:15], s20 offen
 s_add_u32 s20, s20, 3584
 buffer_load_dwordx4 v[16:19], v2, s[12:15], s20 offen
 s_add_u32 s20, s20, 3584
 buffer_load_dwordx4 v[20:23], v2, s[12:15], s20 offen
 s_add_u32 s20, s20, 3584
 buffer_load_dwordx4 v[24:27], v2, s[12:15], s20 offen
 buffer_load_dwordx4 v[28:31], v6, s[12:15], s21 offen
 buffer_load_dwordx4 v[32:35], v7, s[12:15], s21 offen
 buffer_load_dwordx4 v[36:39], v8, s[12:15], s21 offen
 s_waitcnt vmcnt(6)
 buffer_store_dwordx4 v[12:15], v1, s[8:11], s22 offen offset:0 sc1
 s_waitcnt vmcnt(6)
 buffer_store_dwordx4 v[16:19], v1, s[8:11], s22 offen offset:1024 sc1
 s_waitcnt vmcnt(6)
 buffer_store_dwordx4 v[20:23], v1, s[8:11], s22 offen offset:2048 sc1
 s_waitcnt vmcnt(6)
 buffer_store_dwordx4 v[24:27], v1, s[8:11], s22 offen offset:3072 sc1
 s_waitcnt vmcnt(6)
 buffer_store_dwordx4 v[28:31], v1, s[8:11], s23 offen offset:0 sc1
 s_waitcnt vmcnt(6)
 buffer_store_dwordx4 v[32:35], v1, s[8:11], s23 offen offset:1024 sc1
 s_waitcnt vmcnt(6)
 buffer_store_dwordx4 v[36:39], v1, s[8:11], s23 offen offset:2048 sc1
K0_END:
 s_mov_b64 exec, -1
 s_waitcnt lgkmcnt(0)
 s_load_dword s64, s[40:41], 32768
 v_mov_b32 v0, v255
 v_lshrrev_b32 v27, 6, v0
 v_and_b32 v0, 63, v0
 v_readfirstlane_b32 s3, v27
 s_and_b32 s6, s2, 3
 s_lshl_b32 s6, s6, 1
 s_bfe_u32 s7, s2, 0x10003
 s_add_u32 s4, s6, s7
 s_bfe_u32 s6, s2, 0x10002
 s_lshl_b32 s6, s6, 4
 s_lshr_b32 s7, s2, 4
 s_add_u32 s5, s6, s7
 v_lshlrev_b32 v19, 4, v0
 s_lshl_b32 s6, s2, 2
 s_add_u32 s6, s6, s3
 s_lshl_b32 s6, s6, 12
 v_lshl_add_u32 v24, v0, 6, s6
 s_lshr_b32 s7, s3, 1
 s_lshl_b32 s6, s5, 1
 s_add_u32 s6, s6, s7
 s_mul_i32 s39, s6, 28672
 s_and_b32 s6, s3, 1
 s_lshl_b32 s7, s6, 10
 s_add_u32 s39, s39, s7
 s_add_u32 s39, s39, 262144
 s_lshl_b32 s57, s6, 6
 v_lshrrev_b32 v27, 3, v0
 v_lshlrev_b32 v27, 7, v27
 v_and_b32 v28, 4, v0
 v_lshl_add_u32 v27, v28, 3, v27
 v_and_b32 v28, 1, v0
 v_lshl_add_u32 v27, v28, 4, v27
 v_and_b32 v28, 2, v0
 v_mul_u32_u24 v28, 896, v28
 v_sub_u32 v25, v27, v28
 v_add_u32 v25, 1792, v25
 s_lshl_b32 s58, s3, 11
 s_add_u32 s58, s58, 155648
 s_mov_b32 s24, s40
 s_mov_b32 s25, s41
 s_mov_b32 s26, 0x2300000
 s_mov_b32 s27, 0x00020000
 s_mov_b32 s8, s48
 s_mov_b32 s9, s49
 s_mov_b32 s10, 0x380000
 s_mov_b32 s11, 0x00020000
 s_mov_b32 s12, s44
 s_mov_b32 s13, s45
 s_mov_b32 s14, 0x800000
 s_mov_b32 s15, 0x00020000
 s_mov_b32 s16, s46
 s_mov_b32 s17, s47
 s_mov_b32 s18, 0x800000
 s_mov_b32 s19, 0x00020000
 s_mov_b32 s20, s50
 s_mov_b32 s21, s51
 s_mov_b32 s22, 0x380000
 s_mov_b32 s23, 0x00020000
 v_lshrrev_b32 v27, 5, v0
 v_and_b32 v29, 31, v0
 v_lshlrev_b32 v30, 4, v29
 v_lshl_add_u32 v10, v27, 16, v30
 v_add_u32 v11, 8192, v10
 v_add_u32 v12, 16384, v10
 v_add_u32 v13, 24576, v10
 v_lshl_add_u32 v14, v27, 13, v30
 v_lshl_add_u32 v15, v27, 12, v30
 v_min_u32 v28, 55, v0
 v_lshlrev_b32 v16, 4, v28
 s_and_b32 s6, s3, 1
 s_lshr_b32 s7, s3, 1
 s_lshl_b32 s28, s6, 15
 s_lshl_b32 s36, s4, 10
 s_add_u32 s28, s28, s36
 s_lshl_b32 s36, s7, 9
 s_add_u32 s28, s28, s36
 s_lshl_b32 s36, s4, 20
 s_add_u32 s36, s36, 786432
 s_lshl_b32 s37, s3, 11
 s_add_u32 s29, s36, s37
 s_lshl_b32 s37, s7, 13
 s_add_u32 s30, s36, s37
 s_lshl_b32 s37, s6, 11
 s_add_u32 s30, s30, s37
 s_lshl_b32 s36, s4, 9
 s_lshl_b32 s37, s3, 2
 s_add_u32 s36, s36, s37
 s_mul_i32 s31, s36, 896
 s_add_u32 s38, s31, 229376
 s_mul_i32 s32, s3, 4352
 s_mul_i32 s33, s3, 4160
 s_mov_b32 s34, 0x3db8aa3b
 s_waitcnt lgkmcnt(0)
 s_mul_i32 s65, s64, 0x9e3779b1
 s_add_u32 s65, s65, 0x7f4a7c15
 s_sub_u32 s6, s2, 84
 s_cmp_lt_u32 s6, 64
 s_cselect_b32 s7, 0, 0x40000000
 s_add_u32 s6, s6, 28
 s_and_b32 s6, s6, 127
 s_cmp_lt_u32 s2, 28
 s_cselect_b32 s6, s2, s6
 s_cselect_b32 s7, 0, s7
 s_lshl_b32 s6, s6, 7
 s_add_u32 s6, s6, s7
 s_add_u32 s6, s6, 16384
 v_lshl_add_u32 v27, v0, 2, s6
 v_lshrrev_b32 v28, 5, v0
 v_lshl_add_u32 v27, v28, 27, v27
 v_mov_b32 v28, s65
 s_lshl_b32 s6, s5, 1
 s_add_u32 s6, s6, 28
 v_mov_b32 v29, s6
 v_cmp_le_u32 vcc, 46, v0
 s_nop 1
 v_addc_co_u32 v29, vcc, 0, v29, vcc
 v_cmp_gt_u32 vcc, 28, v0
 s_nop 1
 v_cndmask_b32 v29, v29, v0, vcc
 v_lshlrev_b32 v29, 7, v29
 s_movk_i32 s6, 0x4000
 s_movk_i32 s7, 16384
 s_bfe_u32 s66, s2, 0x20003
 s_waitcnt vmcnt(0)
 s_barrier
 s_cmp_eq_u32 s3, s66
 s_cbranch_scc1 K1_PW
 s_add_u32 m0, s32, 0
 s_nop 0
 buffer_load_dwordx4 v10, s[8:11], s28 offen lds
 s_add_u32 m0, s32, 1088
 s_nop 0
 buffer_load_dwordx4 v11, s[8:11], s28 offen lds
 s_add_u32 m0, s32, 2176
 s_nop 0
 buffer_load_dwordx4 v12, s[8:11], s28 offen lds
 s_add_u32 m0, s32, 3264
 s_nop 0
 buffer_load_dwordx4 v13, s[8:11], s28 offen lds
 s_add_u32 s28, s28, 131072
 s_add_u32 m0, s32, 17408
 s_nop 0
 buffer_load_dwordx4 v10, s[8:11], s28 offen lds
 s_add_u32 m0, s32, 18496
 s_nop 0
 buffer_load_dwordx4 v11, s[8:11], s28 offen lds
 s_add_u32 m0, s32, 19584
 s_nop 0
 buffer_load_dwordx4 v12, s[8:11], s28 offen lds
 s_add_u32 m0, s32, 20672
 s_nop 0
 buffer_load_dwordx4 v13, s[8:11], s28 offen lds
 s_add_u32 s28, s28, 131072
 s_add_u32 m0, s32, 34816
 s_nop 0
 buffer_load_dwordx4 v10, s[8:11], s28 offen lds
 s_add_u32 m0, s32, 35904
 s_nop 0
 buffer_load_dwordx4 v11, s[8:11], s28 offen lds
 s_add_u32 m0, s32, 36992
 s_nop 0
 buffer_load_dwordx4 v12, s[8:11], s28 offen lds
 s_add_u32 m0, s32, 38080
 s_nop 0
 buffer_load_dwordx4 v13, s[8:11], s28 offen lds
 s_add_u32 s28, s28, 131072
 s_add_u32 m0, s32, 52224
 s_nop 0
 buffer_load_dwordx4 v10, s[8:11], s28 offen lds
 s_add_u32 m0, s32, 53312
 s_nop 0
 buffer_load_dwordx4 v11, s[8:11], s28 offen lds
 s_add_u32 m0, s32, 54400
 s_nop 0
 buffer_load_dwordx4 v12, s[8:11], s28 offen lds
 s_add_u32 m0, s32, 55488
 s_nop 0
 buffer_load_dwordx4 v13, s[8:11], s28 offen lds
 s_add_u32 s28, s28, 131072
 s_add_u32 m0, s32, 69632
 s_nop 0
 buffer_load_dwordx4 v10, s[8:11], s28 offen lds
 s_add_u32 m0, s32, 70720
 s_nop 0
 buffer_load_dwordx4 v11, s[8:11], s28 offen lds
 s_add_u32 m0, s32, 71808
 s_nop 0
 buffer_load_dwordx4 v12, s[8:11], s28 offen lds
 s_add_u32 m0, s32, 72896
 s_nop 0
 buffer_load_dwordx4 v13, s[8:11], s28 offen lds
 s_add_u32 s28, s28, 131072
 s_add_u32 m0, s32, 87040
 s_nop 0
 buffer_load_dwordx4 v10, s[8:11], s28 offen lds
 s_add_u32 m0, s32, 88128
 s_nop 0
 buffer_load_dwordx4 v11, s[8:11], s28 offen lds
 s_add_u32 m0, s32, 89216
 s_nop 0
 buffer_load_dwordx4 v12, s[8:11], s28 offen lds
 s_add_u32 m0, s32, 90304
 s_nop 0
 buffer_load_dwordx4 v13, s[8:11], s28 offen lds
 s_add_u32 s28, s28, 131072
 s_add_u32 m0, s32, 104448
 s_nop 0
 buffer_load_dwordx4 v10, s[8:11], s28 offen lds
 s_add_u32 m0, s32, 105536
 s_nop 0
 buffer_load_dwordx4 v11, s[8:11], s28 offen lds
 s_add_u32 m0, s32, 106624
 s_nop 0
 buffer_load_dwordx4 v12, s[8:11], s28 offen lds
 s_add_u32 m0, s32, 107712
 s_nop 0
 buffer_load_dwordx4 v13, s[8:11], s28 offen lds
 s_add_u32 s28, s28, 131072
 s_add_u32 m0, s32, 121856
 s_nop 0
 buffer_load_dwordx4 v10, s[8:11], s28 offen lds
 s_add_u32 m0, s32, 122944
 s_nop 0
 buffer_load_dwordx4 v11, s[8:11], s28 offen lds
 s_add_u32 m0, s32, 124032
 s_nop 0
 buffer_load_dwordx4 v12, s[8:11], s28 offen lds
 s_add_u32 m0, s32, 125120
 s_nop 0
 buffer_load_dwordx4 v13, s[8:11], s28 offen lds
 s_barrier
 s_branch K1_GO2
K1_PW:
 buffer_store_dword v28, v27, s[24:27], 0 offen sc1
K1_POLL:
 buffer_load_dword v30, v29, s[24:27], s7 offen sc1
 s_waitcnt vmcnt(0)
 v_cmp_ne_u32 vcc, s65, v30
 s_sub_u32 s6, s6, 1
 s_cbranch_scc1 K1_GO
 s_and_b64 exec, exec, vcc
 s_cbranch_scc1 K1_POLL
K1_GO:
 s_mov_b64 exec, -1
 s_barrier
 s_add_u32 m0, s32, 0
 s_nop 0
 buffer_load_dwordx4 v10, s[8:11], s28 offen lds
 s_add_u32 m0, s32, 1088
 s_nop 0
 buffer_load_dwordx4 v11, s[8:11], s28 offen lds
 s_add_u32 m0, s32, 2176
 s_nop 0
 buffer_load_dwordx4 v12, s[8:11], s28 offen lds
 s_add_u32 m0, s32, 3264
 s_nop 0
 buffer_load_dwordx4 v13, s[8:11], s28 offen lds
 s_add_u32 s28, s28, 131072
 s_add_u32 m0, s32, 17408
 s_nop 0
 buffer_load_dwordx4 v10, s[8:11], s28 offen lds
 s_add_u32 m0, s32, 18496
 s_nop 0
 buffer_load_dwordx4 v11, s[8:11], s28 offen lds
 s_add_u32 m0, s32, 19584
 s_nop 0
 buffer_load_dwordx4 v12, s[8:11], s28 offen lds
 s_add_u32 m0, s32, 20672
 s_nop 0
 buffer_load_dwordx4 v13, s[8:11], s28 offen lds
 s_add_u32 s28, s28, 131072
 s_add_u32 m0, s32, 34816
 s_nop 0
 buffer_load_dwordx4 v10, s[8:11], s28 offen lds
 s_add_u32 m0, s32, 35904
 s_nop 0
 buffer_load_dwordx4 v11, s[8:11], s28 offen lds
 s_add_u32 m0, s32, 36992
 s_nop 0
 buffer_load_dwordx4 v12, s[8:11], s28 offen lds
 s_add_u32 m0, s32, 38080
 s_nop 0
 buffer_load_dwordx4 v13, s[8:11], s28 offen lds
 s_add_u32 s28, s28, 131072
 s_add_u32 m0, s32, 52224
 s_nop 0
 buffer_load_dwordx4 v10, s[8:11], s28 offen lds
 s_add_u32 m0, s32, 53312
 s_nop 0
 buffer_load_dwordx4 v11, s[8:11], s28 offen lds
 s_add_u32 m0, s32, 54400
 s_nop 0
 buffer_load_dwordx4 v12, s[8:11], s28 offen lds
 s_add_u32 m0, s32, 55488
 s_nop 0
 buffer_load_dwordx4 v13, s[8:11], s28 offen lds
 s_add_u32 s28, s28, 131072
 s_add_u32 m0, s32, 69632
 s_nop 0
 buffer_load_dwordx4 v10, s[8:11], s28 offen lds
 s_add_u32 m0, s32, 70720
 s_nop 0
 buffer_load_dwordx4 v11, s[8:11], s28 offen lds
 s_add_u32 m0, s32, 71808
 s_nop 0
 buffer_load_dwordx4 v12, s[8:11], s28 offen lds
 s_add_u32 m0, s32, 72896
 s_nop 0
 buffer_load_dwordx4 v13, s[8:11], s28 offen lds
 s_add_u32 s28, s28, 131072
 s_add_u32 m0, s32, 87040
 s_nop 0
 buffer_load_dwordx4 v10, s[8:11], s28 offen lds
 s_add_u32 m0, s32, 88128
 s_nop 0
 buffer_load_dwordx4 v11, s[8:11], s28 offen lds
 s_add_u32 m0, s32, 89216
 s_nop 0
 buffer_load_dwordx4 v12, s[8:11], s28 offen lds
 s_add_u32 m0, s32, 90304
 s_nop 0
 buffer_load_dwordx4 v13, s[8:11], s28 offen lds
 s_add_u32 s28, s28, 131072
 s_add_u32 m0, s32, 104448
 s_nop 0
 buffer_load_dwordx4 v10, s[8:11], s28 offen lds
 s_add_u32 m0, s32, 105536
 s_nop 0
 buffer_load_dwordx4 v11, s[8:11], s28 offen lds
 s_add_u32 m0, s32, 106624
 s_nop 0
 buffer_load_dwordx4 v12, s[8:11], s28 offen lds
 s_add_u32 m0, s32, 107712
 s_nop 0
 buffer_load_dwordx4 v13, s[8:11], s28 offen lds
 s_add_u32 s28, s28, 131072
 s_add_u32 m0, s32, 121856
 s_nop 0
 buffer_load_dwordx4 v10, s[8:11], s28 offen lds
 s_add_u32 m0, s32, 122944
 s_nop 0
 buffer_load_dwordx4 v11, s[8:11], s28 offen lds
 s_add_u32 m0, s32, 124032
 s_nop 0
 buffer_load_dwordx4 v12, s[8:11], s28 offen lds
 s_add_u32 m0, s32, 125120
 s_nop 0
 buffer_load_dwordx4 v13, s[8:11], s28 offen lds
K1_GO2:
 s_mov_b32 m0, s58
 v_lshrrev_b32 v27, 5, v0
 buffer_load_dwordx4 v25, s[24:27], s57 offen offset:0 sc1 lds
 buffer_load_dwordx4 v25, s[24:27], s57 offen offset:1024 sc1 lds
 v_lshl_add_u32 v31, v27, 6, s58
 buffer_load_dwordx4 v[160:163], v19, s[24:27], s39 offen offset:0 sc1
 buffer_load_dwordx4 v[164:167], v19, s[24:27], s39 offen offset:2048 sc1
 s_add_u32 s39, s39, 4096
 buffer_load_dwordx4 v[168:171], v19, s[24:27], s39 offen offset:0 sc1
 buffer_load_dwordx4 v[172:175], v19, s[24:27], s39 offen offset:2048 sc1
 s_add_u32 s39, s39, 4096
 buffer_load_dwordx4 v[176:179], v19, s[24:27], s39 offen offset:0 sc1
 buffer_load_dwordx4 v[180:183], v19, s[24:27], s39 offen offset:2048 sc1
 s_add_u32 s39, s39, 4096
 buffer_load_dwordx4 v[184:187], v19, s[24:27], s39 offen offset:0 sc1
 buffer_load_dwordx4 v[188:191], v19, s[24:27], s39 offen offset:2048 sc1
 v_bfe_u32 v27, v0, 2, 2
 v_mul_u32_u24 v4, 1088, v27
 v_lshrrev_b32 v27, 5, v0
 v_lshl_add_u32 v4, v27, 9, v4
 v_and_b32 v27, 1, v0
 v_lshlrev_b32 v27, 4, v27
 v_and_b32 v28, 2, v0
 v_lshl_add_u32 v27, v28, 2, v27
 v_and_b32 v28, 16, v0
 v_lshl_add_u32 v27, v28, 1, v27
 v_add_u32 v4, v4, v27
 s_and_b32 s6, s3, 1
 s_mul_i32 s6, s6, 8704
 v_add_u32 v1, s6, v4
 s_and_b32 s6, s3, 1
 s_mul_i32 s7, s6, 17408
 v_add_u32 v20, s7, v1
 s_sub_u32 s7, 17408, s7
 v_add_u32 v22, s7, v1
 v_add_u32 v21, 69632, v20
 v_add_u32 v23, 69632, v22
 v_and_b32 v27, 3, v0
 v_and_b32 v28, 4, v0
 v_lshl_add_u32 v27, v28, 1, v27
 v_and_b32 v28, 8, v0
 v_lshrrev_b32 v28, 1, v28
 v_add_u32 v27, v27, v28
 v_mul_u32_u24 v7, 1040, v27
 v_and_b32 v28, 16, v0
 v_lshl_add_u32 v7, v28, 5, v7
 v_lshrrev_b32 v28, 5, v0
 v_lshl_add_u32 v7, v28, 4, v7
 v_lshrrev_b32 v27, 5, v0
 v_mul_u32_u24 v27, 8192, v27
 v_add_u32 v27, v27, v4
 s_and_b32 s6, s3, 1
 s_mul_i32 s7, s6, 17856
 v_add_u32 v1, s7, v27
 s_mul_i32 s7, s6, -16960
 s_add_u32 s7, s7, 17408
 v_add_u32 v3, s7, v27
 v_add_u32 v2, 69632, v1
 v_add_u32 v25, 69632, v3
 v_add_u32 v5, 52224, v4
 v_add_u32 v6, 104448, v4
 v_add_u32 v8, 52224, v7
 v_add_u32 v9, 104448, v7
 s_lshl_b32 s6, s3, 12
 s_add_u32 s6, s6, 139264
 v_add_u32 v17, s6, v19
 v_xor_b32 v18, 4096, v17
 s_lshr_b32 s6, s3, 1
 s_lshl_b32 s7, s5, 1
 s_add_u32 s6, s6, s7
 s_lshl_b32 s6, s6, 3
 s_add_u32 s6, s6, s4
 s_mul_i32 s35, s6, 28672
 s_and_b32 s6, s3, 1
 s_mul_i32 s6, s6, 14336
 s_add_u32 s35, s35, s6
 s_add_u32 s35, s35, 18874368
 s_waitcnt vmcnt(8)
 ds_read_b128 v[216:219], v31 offset:0
 ds_read_b128 v[220:223], v31 offset:16
 ds_read_b128 v[224:227], v31 offset:32
 ds_read_b128 v[228:231], v31 offset:48
 ds_read_b128 v[232:235], v31 offset:128
 ds_read_b128 v[236:239], v31 offset:144
 ds_read_b128 v[240:243], v31 offset:160
 ds_read_b128 v[244:247], v31 offset:176
 s_waitcnt vmcnt(7)
 v_lshlrev_b32 v248, 16, v160
 v_and_b32 v249, 0xffff0000, v160
 v_lshlrev_b32 v250, 16, v161
 v_and_b32 v251, 0xffff0000, v161
 v_lshlrev_b32 v252, 16, v162
 v_and_b32 v253, 0xffff0000, v162
 v_lshlrev_b32 v254, 16, v163
 v_and_b32 v255, 0xffff0000, v163
 s_waitcnt lgkmcnt(5)
 v_fma_f32 v248, v248, v216, v224
 v_fma_f32 v249, v249, v217, v225
 v_fma_f32 v250, v250, v218, v226
 v_fma_f32 v251, v251, v219, v227
 s_waitcnt lgkmcnt(4)
 v_fma_f32 v252, v252, v220, v228
 v_fma_f32 v253, v253, v221, v229
 v_fma_f32 v254, v254, v222, v230
 v_fma_f32 v255, v255, v223, v231
 v_cvt_pk_bf16_f32 v160, v248, v249
 v_cvt_pk_bf16_f32 v161, v250, v251
 v_cvt_pk_bf16_f32 v162, v252, v253
 v_cvt_pk_bf16_f32 v163, v254, v255
 ds_write_b128 v17, v[160:163] offset:0
 s_waitcnt lgkmcnt(0)
 s_barrier
 ds_read_b128 a[0:3], v18 offset:0
 ds_read_b64_tr_b16 a[192:193], v20 offset:0
 ds_read_b64_tr_b16 a[194:195], v20 offset:4352
 ds_read_b64_tr_b16 a[196:197], v20 offset:64
 ds_read_b64_tr_b16 a[198:199], v20 offset:4416
 ds_read_b64_tr_b16 a[200:201], v20 offset:128
 ds_read_b64_tr_b16 a[202:203], v20 offset:4480
 ds_read_b64_tr_b16 a[204:205], v20 offset:192
 ds_read_b64_tr_b16 a[206:207], v20 offset:4544
 s_waitcnt lgkmcnt(4)
 v_mfma_f32_32x32x16_bf16 v[32:47], a[192:195], v[160:163], 0
 s_add_u32 s39, s39, 4096
 ds_read_b64_tr_b16 a[208:209], v20 offset:256
 buffer_load_dwordx4 v[192:195], v19, s[24:27], s39 offen offset:0 sc1
 ds_read_b64_tr_b16 a[210:211], v20 offset:4608
 v_mfma_f32_32x32x16_bf16 v[48:63], a[196:199], v[160:163], 0
 ds_read_b64_tr_b16 a[212:213], v20 offset:320
 ds_read_b64_tr_b16 a[214:215], v20 offset:4672
 s_waitcnt vmcnt(7)
 v_lshlrev_b32 v248, 16, v164
 v_and_b32 v249, 0xffff0000, v164
 v_lshlrev_b32 v250, 16, v165
 s_waitcnt lgkmcnt(4)
 v_mfma_f32_32x32x16_bf16 v[64:79], a[200:203], v[160:163], 0
 ds_read_b64_tr_b16 a[216:217], v20 offset:384
 buffer_load_dwordx4 v[196:199], v19, s[24:27], s39 offen offset:2048 sc1
 ds_read_b64_tr_b16 a[218:219], v20 offset:4736
 v_and_b32 v251, 0xffff0000, v165
 v_mfma_f32_32x32x16_bf16 v[80:95], a[204:207], v[160:163], 0
 ds_read_b64_tr_b16 a[220:221], v20 offset:448
 ds_read_b64_tr_b16 a[222:223], v20 offset:4800
 v_lshlrev_b32 v252, 16, v166
 v_and_b32 v253, 0xffff0000, v166
 v_lshlrev_b32 v254, 16, v167
 s_waitcnt lgkmcnt(4)
 v_mfma_f32_32x32x16_bf16 v[96:111], a[208:211], v[160:163], 0
 s_add_u32 s39, s39, 4096
 ds_read_b64_tr_b16 a[192:193], v22 offset:0
 buffer_load_dwordx4 v[200:203], v19, s[24:27], s39 offen offset:0 sc1
 ds_read_b64_tr_b16 a[194:195], v22 offset:4352
 v_mfma_f32_32x32x16_bf16 v[112:127], a[212:215], v[160:163], 0
 ds_read_b64_tr_b16 a[196:197], v22 offset:64
 ds_read_b64_tr_b16 a[198:199], v22 offset:4416
 v_and_b32 v255, 0xffff0000, v167
 v_fma_f32 v248, v248, v232, v240
 v_fma_f32 v249, v249, v233, v241
 s_waitcnt lgkmcnt(4)
 v_mfma_f32_32x32x16_bf16 v[128:143], a[216:219], v[160:163], 0
 ds_read_b64_tr_b16 a[200:201], v22 offset:128
 buffer_load_dwordx4 v[204:207], v19, s[24:27], s39 offen offset:2048 sc1
 ds_read_b64_tr_b16 a[202:203], v22 offset:4480
 v_fma_f32 v250, v250, v234, v242
 v_mfma_f32_32x32x16_bf16 v[144:159], a[220:223], v[160:163], 0
 ds_read_b64_tr_b16 a[204:205], v22 offset:192
 ds_read_b64_tr_b16 a[206:207], v22 offset:4544
 v_fma_f32 v251, v251, v235, v243
 v_fma_f32 v252, v252, v236, v244
 v_fma_f32 v253, v253, v237, v245
 s_waitcnt lgkmcnt(4)
 v_mfma_f32_32x32x16_bf16 v[32:47], a[192:195], a[0:3], v[32:47]
 s_add_u32 s39, s39, 4096
 ds_read_b64_tr_b16 a[208:209], v22 offset:256
 buffer_load_dwordx4 v[208:211], v19, s[24:27], s39 offen offset:0 sc1
 ds_read_b64_tr_b16 a[210:211], v22 offset:4608
 ds_read_b64_tr_b16 a[212:213], v22 offset:320
 ds_read_b64_tr_b16 a[214:215], v22 offset:4672
 v_fma_f32 v254, v254, v238, v246
 v_fma_f32 v255, v255, v239, v247
 ds_read_b128 v[216:219], v31 offset:256
 ds_read_b128 v[220:223], v31 offset:272
 ds_read_b128 v[224:227], v31 offset:288
 ds_read_b128 v[228:231], v31 offset:304
 v_cvt_pk_bf16_f32 v164, v248, v249
 v_cvt_pk_bf16_f32 v165, v250, v251
 v_cvt_pk_bf16_f32 v166, v252, v253
 v_cvt_pk_bf16_f32 v167, v254, v255
 ds_write_b128 v17, v[164:167] offset:1024
 v_mfma_f32_32x32x16_bf16 v[48:63], a[196:199], a[0:3], v[48:63]
 ds_read_b64_tr_b16 a[216:217], v22 offset:384
 ds_read_b64_tr_b16 a[218:219], v22 offset:4736
 ds_read_b64_tr_b16 a[220:221], v22 offset:448
 ds_read_b64_tr_b16 a[222:223], v22 offset:4800
 s_waitcnt lgkmcnt(13)
 v_mfma_f32_32x32x16_bf16 v[64:79], a[200:203], a[0:3], v[64:79]
 buffer_load_dwordx4 v[212:215], v19, s[24:27], s39 offen offset:2048 sc1
 s_waitcnt vmcnt(11)
 v_lshlrev_b32 v248, 16, v168
 v_and_b32 v249, 0xffff0000, v168
 v_lshlrev_b32 v250, 16, v169
 v_mfma_f32_32x32x16_bf16 v[80:95], a[204:207], a[0:3], v[80:95]
 v_and_b32 v251, 0xffff0000, v169
 v_lshlrev_b32 v252, 16, v170
 v_and_b32 v253, 0xffff0000, v170
 v_lshlrev_b32 v254, 16, v171
 v_and_b32 v255, 0xffff0000, v171
 s_waitcnt lgkmcnt(9)
 v_mfma_f32_32x32x16_bf16 v[96:111], a[208:211], a[0:3], v[96:111]
 s_waitcnt lgkmcnt(0)
 s_barrier
 ds_read_b128 a[4:7], v18 offset:1024
 s_add_u32 s28, s28, 131072
 s_add_u32 m0, s32, 0
 ds_read_b64_tr_b16 a[192:193], v20 offset:34816
 buffer_load_dwordx4 v10, s[8:11], s28 offen lds
 ds_read_b64_tr_b16 a[194:195], v20 offset:39168
 v_mfma_f32_32x32x16_bf16 v[112:127], a[212:215], a[0:3], v[112:127]
 ds_read_b64_tr_b16 a[196:197], v20 offset:34880
 ds_read_b64_tr_b16 a[198:199], v20 offset:39232
 v_fma_f32 v248, v248, v216, v224
 v_fma_f32 v249, v249, v217, v225
 v_fma_f32 v250, v250, v218, v226
 v_mfma_f32_32x32x16_bf16 v[128:143], a[216:219], a[0:3], v[128:143]
 s_add_u32 m0, s32, 1088
 ds_read_b64_tr_b16 a[200:201], v20 offset:34944
 buffer_load_dwordx4 v11, s[8:11], s28 offen lds
 ds_read_b64_tr_b16 a[202:203], v20 offset:39296
 v_mfma_f32_32x32x16_bf16 v[144:159], a[220:223], a[0:3], v[144:159]
 ds_read_b64_tr_b16 a[204:205], v20 offset:35008
 ds_read_b64_tr_b16 a[206:207], v20 offset:39360
 v_fma_f32 v251, v251, v219, v227
 v_fma_f32 v252, v252, v220, v228
 v_fma_f32 v253, v253, v221, v229
 s_waitcnt lgkmcnt(4)
 v_mfma_f32_32x32x16_bf16 v[32:47], a[192:195], v[164:167], v[32:47]
 s_add_u32 m0, s32, 2176
 ds_read_b64_tr_b16 a[208:209], v20 offset:35072
 buffer_load_dwordx4 v12, s[8:11], s28 offen lds
 ds_read_b64_tr_b16 a[210:211], v20 offset:39424
 v_mfma_f32_32x32x16_bf16 v[48:63], a[196:199], v[164:167], v[48:63]
 ds_read_b64_tr_b16 a[212:213], v20 offset:35136
 ds_read_b64_tr_b16 a[214:215], v20 offset:39488
 v_fma_f32 v254, v254, v222, v230
 v_fma_f32 v255, v255, v223, v231
 ds_read_b128 v[232:235], v31 offset:384
 s_waitcnt lgkmcnt(5)
 v_mfma_f32_32x32x16_bf16 v[64:79], a[200:203], v[164:167], v[64:79]
 s_add_u32 m0, s32, 3264
 ds_read_b64_tr_b16 a[216:217], v20 offset:35200
 buffer_load_dwordx4 v13, s[8:11], s28 offen lds
 ds_read_b64_tr_b16 a[218:219], v20 offset:39552
 v_mfma_f32_32x32x16_bf16 v[80:95], a[204:207], v[164:167], v[80:95]
 ds_read_b64_tr_b16 a[220:221], v20 offset:35264
 ds_read_b64_tr_b16 a[222:223], v20 offset:39616
 ds_read_b128 v[236:239], v31 offset:400
 ds_read_b128 v[240:243], v31 offset:416
 ds_read_b128 v[244:247], v31 offset:432
 s_waitcnt lgkmcnt(8)
 v_mfma_f32_32x32x16_bf16 v[96:111], a[208:211], v[164:167], v[96:111]
 s_add_u32 s28, s28, 131072
 s_add_u32 m0, s32, 17408
 ds_read_b64_tr_b16 a[192:193], v22 offset:34816
 buffer_load_dwordx4 v10, s[8:11], s28 offen lds
 ds_read_b64_tr_b16 a[194:195], v22 offset:39168
 v_mfma_f32_32x32x16_bf16 v[112:127], a[212:215], v[164:167], v[112:127]
 ds_read_b64_tr_b16 a[196:197], v22 offset:34880
 ds_read_b64_tr_b16 a[198:199], v22 offset:39232
 v_cvt_pk_bf16_f32 v168, v248, v249
 v_cvt_pk_bf16_f32 v169, v250, v251
 v_cvt_pk_bf16_f32 v170, v252, v253
 s_waitcnt lgkmcnt(7)
 v_mfma_f32_32x32x16_bf16 v[128:143], a[216:219], v[164:167], v[128:143]
 s_add_u32 m0, s32, 18496
 ds_read_b64_tr_b16 a[200:201], v22 offset:34944
 buffer_load_dwordx4 v11, s[8:11], s28 offen lds
 ds_read_b64_tr_b16 a[202:203], v22 offset:39296
 v_mfma_f32_32x32x16_bf16 v[144:159], a[220:223], v[164:167], v[144:159]
 ds_read_b64_tr_b16 a[204:205], v22 offset:35008
 ds_read_b64_tr_b16 a[206:207], v22 offset:39360
 v_cvt_pk_bf16_f32 v171, v254, v255
 ds_write_b128 v17, v[168:171] offset:2048
 s_waitcnt lgkmcnt(5)
 v_mfma_f32_32x32x16_bf16 v[32:47], a[192:195], a[4:7], v[32:47]
 s_add_u32 m0, s32, 19584
 ds_read_b64_tr_b16 a[208:209], v22 offset:35072
 buffer_load_dwordx4 v12, s[8:11], s28 offen lds
 ds_read_b64_tr_b16 a[210:211], v22 offset:39424
 ds_read_b64_tr_b16 a[212:213], v22 offset:35136
 ds_read_b64_tr_b16 a[214:215], v22 offset:39488
 v_mfma_f32_32x32x16_bf16 v[48:63], a[196:199], a[4:7], v[48:63]
 ds_read_b64_tr_b16 a[216:217], v22 offset:35200
 ds_read_b64_tr_b16 a[218:219], v22 offset:39552
 ds_read_b64_tr_b16 a[220:221], v22 offset:35264
 ds_read_b64_tr_b16 a[222:223], v22 offset:39616
 s_waitcnt lgkmcnt(9)
 v_mfma_f32_32x32x16_bf16 v[64:79], a[200:203], a[4:7], v[64:79]
 s_add_u32 m0, s32, 20672
 s_nop 0
 buffer_load_dwordx4 v13, s[8:11], s28 offen lds
 s_waitcnt vmcnt(18)
 v_lshlrev_b32 v248, 16, v172
 v_and_b32 v249, 0xffff0000, v172
 v_mfma_f32_32x32x16_bf16 v[80:95], a[204:207], a[4:7], v[80:95]
 v_lshlrev_b32 v250, 16, v173
 v_and_b32 v251, 0xffff0000, v173
 v_lshlrev_b32 v252, 16, v174
 v_and_b32 v253, 0xffff0000, v174
 v_lshlrev_b32 v254, 16, v175
 s_waitcnt lgkmcnt(4)
 v_mfma_f32_32x32x16_bf16 v[96:111], a[208:211], a[4:7], v[96:111]
 s_waitcnt lgkmcnt(0)
 s_barrier
 ds_read_b128 a[8:11], v18 offset:2048
 s_add_u32 s28, s28, 131072
 s_add_u32 m0, s32, 34816
 ds_read_b64_tr_b16 a[192:193], v21 offset:0
 buffer_load_dwordx4 v10, s[8:11], s28 offen lds
 ds_read_b64_tr_b16 a[194:195], v21 offset:4352
 v_mfma_f32_32x32x16_bf16 v[112:127], a[212:215], a[4:7], v[112:127]
 ds_read_b64_tr_b16 a[196:197], v21 offset:64
 ds_read_b64_tr_b16 a[198:199], v21 offset:4416
 v_and_b32 v255, 0xffff0000, v175
 v_fma_f32 v248, v248, v232, v240
 v_fma_f32 v249, v249, v233, v241
 v_mfma_f32_32x32x16_bf16 v[128:143], a[216:219], a[4:7], v[128:143]
 s_add_u32 m0, s32, 35904
 ds_read_b64_tr_b16 a[200:201], v21 offset:128
 buffer_load_dwordx4 v11, s[8:11], s28 offen lds
 ds_read_b64_tr_b16 a[202:203], v21 offset:4480
 v_mfma_f32_32x32x16_bf16 v[144:159], a[220:223], a[4:7], v[144:159]
 ds_read_b64_tr_b16 a[204:205], v21 offset:192
 ds_read_b64_tr_b16 a[206:207], v21 offset:4544
 v_fma_f32 v250, v250, v234, v242
 v_fma_f32 v251, v251, v235, v243
 v_fma_f32 v252, v252, v236, v244
 s_waitcnt lgkmcnt(4)
 v_mfma_f32_32x32x16_bf16 v[32:47], a[192:195], v[168:171], v[32:47]
 s_add_u32 m0, s32, 36992
 ds_read_b64_tr_b16 a[208:209], v21 offset:256
 buffer_load_dwordx4 v12, s[8:11], s28 offen lds
 ds_read_b64_tr_b16 a[210:211], v21 offset:4608
 v_mfma_f32_32x32x16_bf16 v[48:63], a[196:199], v[168:171], v[48:63]
 ds_read_b64_tr_b16 a[212:213], v21 offset:320
 ds_read_b64_tr_b16 a[214:215], v21 offset:4672
 v_fma_f32 v253, v253, v237, v245
 v_fma_f32 v254, v254, v238, v246
 v_fma_f32 v255, v255, v239, v247
 s_waitcnt lgkmcnt(4)
 v_mfma_f32_32x32x16_bf16 v[64:79], a[200:203], v[168:171], v[64:79]
 s_add_u32 m0, s32, 38080
 ds_read_b64_tr_b16 a[216:217], v21 offset:384
 buffer_load_dwordx4 v13, s[8:11], s28 offen lds
 ds_read_b64_tr_b16 a[218:219], v21 offset:4736
 v_mfma_f32_32x32x16_bf16 v[80:95], a[204:207], v[168:171], v[80:95]
 ds_read_b64_tr_b16 a[220:221], v21 offset:448
 ds_read_b64_tr_b16 a[222:223], v21 offset:4800
 ds_read_b128 v[216:219], v31 offset:512
 ds_read_b128 v[220:223], v31 offset:528
 ds_read_b128 v[224:227], v31 offset:544
 s_waitcnt lgkmcnt(7)
 v_mfma_f32_32x32x16_bf16 v[96:111], a[208:211], v[168:171], v[96:111]
 s_add_u32 s28, s28, 131072
 s_add_u32 m0, s32, 52224
 ds_read_b64_tr_b16 a[192:193], v23 offset:0
 buffer_load_dwordx4 v10, s[8:11], s28 offen lds
 ds_read_b64_tr_b16 a[194:195], v23 offset:4352
 v_mfma_f32_32x32x16_bf16 v[112:127], a[212:215], v[168:171], v[112:127]
 ds_read_b64_tr_b16 a[196:197], v23 offset:64
 ds_read_b64_tr_b16 a[198:199], v23 offset:4416
 ds_read_b128 v[228:231], v31 offset:560
 v_cvt_pk_bf16_f32 v172, v248, v249
 v_cvt_pk_bf16_f32 v173, v250, v251
 s_waitcnt lgkmcnt(8)
 v_mfma_f32_32x32x16_bf16 v[128:143], a[216:219], v[168:171], v[128:143]
 s_add_u32 m0, s32, 53312
 ds_read_b64_tr_b16 a[200:201], v23 offset:128
 buffer_load_dwordx4 v11, s[8:11], s28 offen lds
 ds_read_b64_tr_b16 a[202:203], v23 offset:4480
 v_mfma_f32_32x32x16_bf16 v[144:159], a[220:223], v[168:171], v[144:159]
 ds_read_b64_tr_b16 a[204:205], v23 offset:192
 ds_read_b64_tr_b16 a[206:207], v23 offset:4544
 v_cvt_pk_bf16_f32 v174, v252, v253
 v_cvt_pk_bf16_f32 v175, v254, v255
 ds_write_b128 v17, v[172:175] offset:3072
 s_waitcnt lgkmcnt(6)
 v_mfma_f32_32x32x16_bf16 v[32:47], a[192:195], a[8:11], v[32:47]
 s_add_u32 m0, s32, 54400
 ds_read_b64_tr_b16 a[208:209], v23 offset:256
 buffer_load_dwordx4 v12, s[8:11], s28 offen lds
 ds_read_b64_tr_b16 a[210:211], v23 offset:4608
 ds_read_b64_tr_b16 a[212:213], v23 offset:320
 ds_read_b64_tr_b16 a[214:215], v23 offset:4672
 v_mfma_f32_32x32x16_bf16 v[48:63], a[196:199], a[8:11], v[48:63]
 ds_read_b64_tr_b16 a[216:217], v23 offset:384
 ds_read_b64_tr_b16 a[218:219], v23 offset:4736
 ds_read_b64_tr_b16 a[220:221], v23 offset:448
 ds_read_b64_tr_b16 a[222:223], v23 offset:4800
 s_waitcnt lgkmcnt(9)
 v_mfma_f32_32x32x16_bf16 v[64:79], a[200:203], a[8:11], v[64:79]
 s_add_u32 m0, s32, 55488
 s_nop 0
 buffer_load_dwordx4 v13, s[8:11], s28 offen lds
 s_waitcnt vmcnt(25)
 v_lshlrev_b32 v248, 16, v176
 v_and_b32 v249, 0xffff0000, v176
 v_mfma_f32_32x32x16_bf16 v[80:95], a[204:207], a[8:11], v[80:95]
 v_lshlrev_b32 v250, 16, v177
 v_and_b32 v251, 0xffff0000, v177
 v_lshlrev_b32 v252, 16, v178
 v_and_b32 v253, 0xffff0000, v178
 v_lshlrev_b32 v254, 16, v179
 s_waitcnt lgkmcnt(4)
 v_mfma_f32_32x32x16_bf16 v[96:111], a[208:211], a[8:11], v[96:111]
 s_waitcnt lgkmcnt(0)
 s_barrier
 ds_read_b128 a[12:15], v18 offset:3072
 s_add_u32 s28, s28, 131072
 s_add_u32 m0, s32, 69632
 ds_read_b64_tr_b16 a[192:193], v21 offset:34816
 buffer_load_dwordx4 v10, s[8:11], s28 offen lds
 ds_read_b64_tr_b16 a[194:195], v21 offset:39168
 v_mfma_f32_32x32x16_bf16 v[112:127], a[212:215], a[8:11], v[112:127]
 ds_read_b64_tr_b16 a[196:197], v21 offset:34880
 ds_read_b64_tr_b16 a[198:199], v21 offset:39232
 v_and_b32 v255, 0xffff0000, v179
 v_fma_f32 v248, v248, v216, v224
 v_fma_f32 v249, v249, v217, v225
 v_mfma_f32_32x32x16_bf16 v[128:143], a[216:219], a[8:11], v[128:143]
 s_add_u32 m0, s32, 70720
 ds_read_b64_tr_b16 a[200:201], v21 offset:34944
 buffer_load_dwordx4 v11, s[8:11], s28 offen lds
 ds_read_b64_tr_b16 a[202:203], v21 offset:39296
 v_mfma_f32_32x32x16_bf16 v[144:159], a[220:223], a[8:11], v[144:159]
 ds_read_b64_tr_b16 a[204:205], v21 offset:35008
 ds_read_b64_tr_b16 a[206:207], v21 offset:39360
 v_fma_f32 v250, v250, v218, v226
 v_fma_f32 v251, v251, v219, v227
 v_fma_f32 v252, v252, v220, v228
 s_waitcnt lgkmcnt(4)
 v_mfma_f32_32x32x16_bf16 v[32:47], a[192:195], v[172:175], v[32:47]
 s_add_u32 m0, s32, 71808
 ds_read_b64_tr_b16 a[208:209], v21 offset:35072
 buffer_load_dwordx4 v12, s[8:11], s28 offen lds
 ds_read_b64_tr_b16 a[210:211], v21 offset:39424
 v_mfma_f32_32x32x16_bf16 v[48:63], a[196:199], v[172:175], v[48:63]
 ds_read_b64_tr_b16 a[212:213], v21 offset:35136
 ds_read_b64_tr_b16 a[214:215], v21 offset:39488
 v_fma_f32 v253, v253, v221, v229
 v_fma_f32 v254, v254, v222, v230
 v_fma_f32 v255, v255, v223, v231
 s_waitcnt lgkmcnt(4)
 v_mfma_f32_32x32x16_bf16 v[64:79], a[200:203], v[172:175], v[64:79]
 s_add_u32 m0, s32, 72896
 ds_read_b64_tr_b16 a[216:217], v21 offset:35200
 buffer_load_dwordx4 v13, s[8:11], s28 offen lds
 ds_read_b64_tr_b16 a[218:219], v21 offset:39552
 v_mfma_f32_32x32x16_bf16 v[80:95], a[204:207], v[172:175], v[80:95]
 ds_read_b64_tr_b16 a[220:221], v21 offset:35264
 ds_read_b64_tr_b16 a[222:223], v21 offset:39616
 ds_read_b128 v[232:235], v31 offset:640
 ds_read_b128 v[236:239], v31 offset:656
 ds_read_b128 v[240:243], v31 offset:672
 s_waitcnt lgkmcnt(7)
 v_mfma_f32_32x32x16_bf16 v[96:111], a[208:211], v[172:175], v[96:111]
 s_add_u32 s28, s28, 131072
 s_add_u32 m0, s32, 87040
 ds_read_b64_tr_b16 a[192:193], v23 offset:34816
 buffer_load_dwordx4 v10, s[8:11], s28 offen lds
 ds_read_b64_tr_b16 a[194:195], v23 offset:39168
 v_mfma_f32_32x32x16_bf16 v[112:127], a[212:215], v[172:175], v[112:127]
 ds_read_b64_tr_b16 a[196:197], v23 offset:34880
 ds_read_b64_tr_b16 a[198:199], v23 offset:39232
 ds_read_b128 v[244:247], v31 offset:688
 v_cvt_pk_bf16_f32 v176, v248, v249
 v_cvt_pk_bf16_f32 v177, v250, v251
 s_waitcnt lgkmcnt(8)
 v_mfma_f32_32x32x16_bf16 v[128:143], a[216:219], v[172:175], v[128:143]
 s_add_u32 m0, s32, 88128
 ds_read_b64_tr_b16 a[200:201], v23 offset:34944
 buffer_load_dwordx4 v11, s[8:11], s28 offen lds
 ds_read_b64_tr_b16 a[202:203], v23 offset:39296
 v_mfma_f32_32x32x16_bf16 v[144:159], a[220:223], v[172:175], v[144:159]
 ds_read_b64_tr_b16 a[204:205], v23 offset:35008
 ds_read_b64_tr_b16 a[206:207], v23 offset:39360
 v_cvt_pk_bf16_f32 v178, v252, v253
 v_cvt_pk_bf16_f32 v179, v254, v255
 ds_write_b128 v17, v[176:179] offset:0
 s_waitcnt lgkmcnt(6)
 v_mfma_f32_32x32x16_bf16 v[32:47], a[192:195], a[12:15], v[32:47]
 s_add_u32 m0, s32, 89216
 ds_read_b64_tr_b16 a[208:209], v23 offset:35072
 buffer_load_dwordx4 v12, s[8:11], s28 offen lds
 ds_read_b64_tr_b16 a[210:211], v23 offset:39424
 ds_read_b64_tr_b16 a[212:213], v23 offset:35136
 ds_read_b64_tr_b16 a[214:215], v23 offset:39488
 v_mfma_f32_32x32x16_bf16 v[48:63], a[196:199], a[12:15], v[48:63]
 ds_read_b64_tr_b16 a[216:217], v23 offset:35200
 ds_read_b64_tr_b16 a[218:219], v23 offset:39552
 ds_read_b64_tr_b16 a[220:221], v23 offset:35264
 ds_read_b64_tr_b16 a[222:223], v23 offset:39616
 s_waitcnt lgkmcnt(9)
 v_mfma_f32_32x32x16_bf16 v[64:79], a[200:203], a[12:15], v[64:79]
 s_add_u32 m0, s32, 90304
 s_nop 0
 buffer_load_dwordx4 v13, s[8:11], s28 offen lds
 s_waitcnt vmcnt(32)
 v_lshlrev_b32 v248, 16, v180
 v_and_b32 v249, 0xffff0000, v180
 v_mfma_f32_32x32x16_bf16 v[80:95], a[204:207], a[12:15], v[80:95]
 v_lshlrev_b32 v250, 16, v181
 v_and_b32 v251, 0xffff0000, v181
 v_lshlrev_b32 v252, 16, v182
 v_and_b32 v253, 0xffff0000, v182
 v_lshlrev_b32 v254, 16, v183
 s_waitcnt lgkmcnt(4)
 v_mfma_f32_32x32x16_bf16 v[96:111], a[208:211], a[12:15], v[96:111]
 s_waitcnt vmcnt(16) lgkmcnt(0)
 s_barrier
 ds_read_b128 a[16:19], v18 offset:0
 s_add_u32 s28, s28, 131072
 s_add_u32 m0, s32, 104448
 ds_read_b64_tr_b16 a[192:193], v20 offset:0
 buffer_load_dwordx4 v10, s[8:11], s28 offen lds
 ds_read_b64_tr_b16 a[194:195], v20 offset:4352
 v_mfma_f32_32x32x16_bf16 v[112:127], a[212:215], a[12:15], v[112:127]
 ds_read_b64_tr_b16 a[196:197], v20 offset:64
 ds_read_b64_tr_b16 a[198:199], v20 offset:4416
 v_and_b32 v255, 0xffff0000, v183
 v_fma_f32 v248, v248, v232, v240
 v_fma_f32 v249, v249, v233, v241
 v_mfma_f32_32x32x16_bf16 v[128:143], a[216:219], a[12:15], v[128:143]
 s_add_u32 m0, s32, 105536
 ds_read_b64_tr_b16 a[200:201], v20 offset:128
 buffer_load_dwordx4 v11, s[8:11], s28 offen lds
 ds_read_b64_tr_b16 a[202:203], v20 offset:4480
 v_mfma_f32_32x32x16_bf16 v[144:159], a[220:223], a[12:15], v[144:159]
 ds_read_b64_tr_b16 a[204:205], v20 offset:192
 ds_read_b64_tr_b16 a[206:207], v20 offset:4544
 v_fma_f32 v250, v250, v234, v242
 v_fma_f32 v251, v251, v235, v243
 v_fma_f32 v252, v252, v236, v244
 s_waitcnt lgkmcnt(4)
 v_mfma_f32_32x32x16_bf16 v[32:47], a[192:195], v[176:179], v[32:47]
 s_add_u32 m0, s32, 106624
 ds_read_b64_tr_b16 a[208:209], v20 offset:256
 buffer_load_dwordx4 v12, s[8:11], s28 offen lds
 ds_read_b64_tr_b16 a[210:211], v20 offset:4608
 v_mfma_f32_32x32x16_bf16 v[48:63], a[196:199], v[176:179], v[48:63]
 ds_read_b64_tr_b16 a[212:213], v20 offset:320
 ds_read_b64_tr_b16 a[214:215], v20 offset:4672
 v_fma_f32 v253, v253, v237, v245
 v_fma_f32 v254, v254, v238, v246
 v_fma_f32 v255, v255, v239, v247
 s_waitcnt lgkmcnt(4)
 v_mfma_f32_32x32x16_bf16 v[64:79], a[200:203], v[176:179], v[64:79]
 s_add_u32 m0, s32, 107712
 ds_read_b64_tr_b16 a[216:217], v20 offset:384
 buffer_load_dwordx4 v13, s[8:11], s28 offen lds
 ds_read_b64_tr_b16 a[218:219], v20 offset:4736
 v_mfma_f32_32x32x16_bf16 v[80:95], a[204:207], v[176:179], v[80:95]
 ds_read_b64_tr_b16 a[220:221], v20 offset:448
 ds_read_b64_tr_b16 a[222:223], v20 offset:4800
 ds_read_b128 v[216:219], v31 offset:768
 ds_read_b128 v[220:223], v31 offset:784
 ds_read_b128 v[224:227], v31 offset:800
 s_waitcnt lgkmcnt(7)
 v_mfma_f32_32x32x16_bf16 v[96:111], a[208:211], v[176:179], v[96:111]
 s_add_u32 s28, s28, 131072
 s_add_u32 m0, s32, 121856
 ds_read_b64_tr_b16 a[192:193], v22 offset:0
 buffer_load_dwordx4 v10, s[8:11], s28 offen lds
 ds_read_b64_tr_b16 a[194:195], v22 offset:4352
 v_mfma_f32_32x32x16_bf16 v[112:127], a[212:215], v[176:179], v[112:127]
 ds_read_b64_tr_b16 a[196:197], v22 offset:64
 ds_read_b64_tr_b16 a[198:199], v22 offset:4416
 ds_read_b128 v[228:231], v31 offset:816
 v_cvt_pk_bf16_f32 v180, v248, v249
 v_cvt_pk_bf16_f32 v181, v250, v251
 s_waitcnt lgkmcnt(8)
 v_mfma_f32_32x32x16_bf16 v[128:143], a[216:219], v[176:179], v[128:143]
 s_add_u32 m0, s32, 122944
 ds_read_b64_tr_b16 a[200:201], v22 offset:128
 buffer_load_dwordx4 v11, s[8:11], s28 offen lds
 ds_read_b64_tr_b16 a[202:203], v22 offset:4480
 v_mfma_f32_32x32x16_bf16 v[144:159], a[220:223], v[176:179], v[144:159]
 ds_read_b64_tr_b16 a[204:205], v22 offset:192
 ds_read_b64_tr_b16 a[206:207], v22 offset:4544
 v_cvt_pk_bf16_f32 v182, v252, v253
 v_cvt_pk_bf16_f32 v183, v254, v255
 ds_write_b128 v17, v[180:183] offset:1024
 s_waitcnt lgkmcnt(6)
 v_mfma_f32_32x32x16_bf16 v[32:47], a[192:195], a[16:19], v[32:47]
 s_add_u32 m0, s32, 124032
 ds_read_b64_tr_b16 a[208:209], v22 offset:256
 buffer_load_dwordx4 v12, s[8:11], s28 offen lds
 ds_read_b64_tr_b16 a[210:211], v22 offset:4608
 ds_read_b64_tr_b16 a[212:213], v22 offset:320
 ds_read_b64_tr_b16 a[214:215], v22 offset:4672
 v_mfma_f32_32x32x16_bf16 v[48:63], a[196:199], a[16:19], v[48:63]
 ds_read_b64_tr_b16 a[216:217], v22 offset:384
 ds_read_b64_tr_b16 a[218:219], v22 offset:4736
 ds_read_b64_tr_b16 a[220:221], v22 offset:448
 ds_read_b64_tr_b16 a[222:223], v22 offset:4800
 s_waitcnt lgkmcnt(9)
 v_mfma_f32_32x32x16_bf16 v[64:79], a[200:203], a[16:19], v[64:79]
 s_add_u32 m0, s32, 125120
 s_nop 0
 buffer_load_dwordx4 v13, s[8:11], s28 offen lds
 v_lshlrev_b32 v248, 16, v184
 v_and_b32 v249, 0xffff0000, v184
 v_mfma_f32_32x32x16_bf16 v[80:95], a[204:207], a[16:19], v[80:95]
 v_lshlrev_b32 v250, 16, v185
 v_and_b32 v251, 0xffff0000, v185
 v_lshlrev_b32 v252, 16, v186
 v_and_b32 v253, 0xffff0000, v186
 v_lshlrev_b32 v254, 16, v187
 s_waitcnt lgkmcnt(4)
 v_mfma_f32_32x32x16_bf16 v[96:111], a[208:211], a[16:19], v[96:111]
 s_waitcnt vmcnt(16) lgkmcnt(0)
 s_barrier
 ds_read_b128 a[20:23], v18 offset:1024
 s_add_u32 s28, s28, 131072
 s_add_u32 m0, s32, 0
 ds_read_b64_tr_b16 a[192:193], v20 offset:34816
 buffer_load_dwordx4 v10, s[8:11], s28 offen lds
 ds_read_b64_tr_b16 a[194:195], v20 offset:39168
 v_mfma_f32_32x32x16_bf16 v[112:127], a[212:215], a[16:19], v[112:127]
 ds_read_b64_tr_b16 a[196:197], v20 offset:34880
 ds_read_b64_tr_b16 a[198:199], v20 offset:39232
 v_and_b32 v255, 0xffff0000, v187
 v_fma_f32 v248, v248, v216, v224
 v_fma_f32 v249, v249, v217, v225
 v_mfma_f32_32x32x16_bf16 v[128:143], a[216:219], a[16:19], v[128:143]
 s_add_u32 m0, s32, 1088
 ds_read_b64_tr_b16 a[200:201], v20 offset:34944
 buffer_load_dwordx4 v11, s[8:11], s28 offen lds
 ds_read_b64_tr_b16 a[202:203], v20 offset:39296
 v_mfma_f32_32x32x16_bf16 v[144:159], a[220:223], a[16:19], v[144:159]
 ds_read_b64_tr_b16 a[204:205], v20 offset:35008
 ds_read_b64_tr_b16 a[206:207], v20 offset:39360
 v_fma_f32 v250, v250, v218, v226
 v_fma_f32 v251, v251, v219, v227
 v_fma_f32 v252, v252, v220, v228
 s_waitcnt lgkmcnt(4)
 v_mfma_f32_32x32x16_bf16 v[32:47], a[192:195], v[180:183], v[32:47]
 s_add_u32 m0, s32, 2176
 ds_read_b64_tr_b16 a[208:209], v20 offset:35072
 buffer_load_dwordx4 v12, s[8:11], s28 offen lds
 ds_read_b64_tr_b16 a[210:211], v20 offset:39424
 v_mfma_f32_32x32x16_bf16 v[48:63], a[196:199], v[180:183], v[48:63]
 ds_read_b64_tr_b16 a[212:213], v20 offset:35136
 ds_read_b64_tr_b16 a[214:215], v20 offset:39488
 v_fma_f32 v253, v253, v221, v229
 v_fma_f32 v254, v254, v222, v230
 v_fma_f32 v255, v255, v223, v231
 s_waitcnt lgkmcnt(4)
 v_mfma_f32_32x32x16_bf16 v[64:79], a[200:203], v[180:183], v[64:79]
 s_add_u32 m0, s32, 3264
 ds_read_b64_tr_b16 a[216:217], v20 offset:35200
 buffer_load_dwordx4 v13, s[8:11], s28 offen lds
 ds_read_b64_tr_b16 a[218:219], v20 offset:39552
 v_mfma_f32_32x32x16_bf16 v[80:95], a[204:207], v[180:183], v[80:95]
 ds_read_b64_tr_b16 a[220:221], v20 offset:35264
 ds_read_b64_tr_b16 a[222:223], v20 offset:39616
 ds_read_b128 v[232:235], v31 offset:896
 ds_read_b128 v[236:239], v31 offset:912
 ds_read_b128 v[240:243], v31 offset:928
 s_waitcnt lgkmcnt(7)
 v_mfma_f32_32x32x16_bf16 v[96:111], a[208:211], v[180:183], v[96:111]
 s_add_u32 s28, s28, 131072
 s_add_u32 m0, s32, 17408
 ds_read_b64_tr_b16 a[192:193], v22 offset:34816
 buffer_load_dwordx4 v10, s[8:11], s28 offen lds
 ds_read_b64_tr_b16 a[194:195], v22 offset:39168
 v_mfma_f32_32x32x16_bf16 v[112:127], a[212:215], v[180:183], v[112:127]
 ds_read_b64_tr_b16 a[196:197], v22 offset:34880
 ds_read_b64_tr_b16 a[198:199], v22 offset:39232
 ds_read_b128 v[244:247], v31 offset:944
 v_cvt_pk_bf16_f32 v184, v248, v249
 v_cvt_pk_bf16_f32 v185, v250, v251
 s_waitcnt lgkmcnt(8)
 v_mfma_f32_32x32x16_bf16 v[128:143], a[216:219], v[180:183], v[128:143]
 s_add_u32 m0, s32, 18496
 ds_read_b64_tr_b16 a[200:201], v22 offset:34944
 buffer_load_dwordx4 v11, s[8:11], s28 offen lds
 ds_read_b64_tr_b16 a[202:203], v22 offset:39296
 v_mfma_f32_32x32x16_bf16 v[144:159], a[220:223], v[180:183], v[144:159]
 ds_read_b64_tr_b16 a[204:205], v22 offset:35008
 ds_read_b64_tr_b16 a[206:207], v22 offset:39360
 v_cvt_pk_bf16_f32 v186, v252, v253
 v_cvt_pk_bf16_f32 v187, v254, v255
 ds_write_b128 v17, v[184:187] offset:2048
 s_waitcnt lgkmcnt(6)
 v_mfma_f32_32x32x16_bf16 v[32:47], a[192:195], a[20:23], v[32:47]
 s_add_u32 m0, s32, 19584
 ds_read_b64_tr_b16 a[208:209], v22 offset:35072
 buffer_load_dwordx4 v12, s[8:11], s28 offen lds
 ds_read_b64_tr_b16 a[210:211], v22 offset:39424
 ds_read_b64_tr_b16 a[212:213], v22 offset:35136
 ds_read_b64_tr_b16 a[214:215], v22 offset:39488
 v_mfma_f32_32x32x16_bf16 v[48:63], a[196:199], a[20:23], v[48:63]
 ds_read_b64_tr_b16 a[216:217], v22 offset:35200
 ds_read_b64_tr_b16 a[218:219], v22 offset:39552
 ds_read_b64_tr_b16 a[220:221], v22 offset:35264
 ds_read_b64_tr_b16 a[222:223], v22 offset:39616
 s_waitcnt lgkmcnt(9)
 v_mfma_f32_32x32x16_bf16 v[64:79], a[200:203], a[20:23], v[64:79]
 s_add_u32 m0, s32, 20672
 s_nop 0
 buffer_load_dwordx4 v13, s[8:11], s28 offen lds
 v_lshlrev_b32 v248, 16, v188
 v_and_b32 v249, 0xffff0000, v188
 v_mfma_f32_32x32x16_bf16 v[80:95], a[204:207], a[20:23], v[80:95]
 v_lshlrev_b32 v250, 16, v189
 v_and_b32 v251, 0xffff0000, v189
 v_lshlrev_b32 v252, 16, v190
 v_and_b32 v253, 0xffff0000, v190
 v_lshlrev_b32 v254, 16, v191
 s_waitcnt lgkmcnt(4)
 v_mfma_f32_32x32x16_bf16 v[96:111], a[208:211], a[20:23], v[96:111]
 s_waitcnt vmcnt(16) lgkmcnt(0)
 s_barrier
 ds_read_b128 a[24:27], v18 offset:2048
 s_add_u32 s28, s28, 131072
 s_add_u32 m0, s32, 34816
 ds_read_b64_tr_b16 a[192:193], v21 offset:0
 buffer_load_dwordx4 v10, s[8:11], s28 offen lds
 ds_read_b64_tr_b16 a[194:195], v21 offset:4352
 v_mfma_f32_32x32x16_bf16 v[112:127], a[212:215], a[20:23], v[112:127]
 ds_read_b64_tr_b16 a[196:197], v21 offset:64
 ds_read_b64_tr_b16 a[198:199], v21 offset:4416
 v_and_b32 v255, 0xffff0000, v191
 v_fma_f32 v248, v248, v232, v240
 v_fma_f32 v249, v249, v233, v241
 v_mfma_f32_32x32x16_bf16 v[128:143], a[216:219], a[20:23], v[128:143]
 s_add_u32 m0, s32, 35904
 ds_read_b64_tr_b16 a[200:201], v21 offset:128
 buffer_load_dwordx4 v11, s[8:11], s28 offen lds
 ds_read_b64_tr_b16 a[202:203], v21 offset:4480
 v_mfma_f32_32x32x16_bf16 v[144:159], a[220:223], a[20:23], v[144:159]
 ds_read_b64_tr_b16 a[204:205], v21 offset:192
 ds_read_b64_tr_b16 a[206:207], v21 offset:4544
 v_fma_f32 v250, v250, v234, v242
 v_fma_f32 v251, v251, v235, v243
 v_fma_f32 v252, v252, v236, v244
 s_waitcnt lgkmcnt(4)
 v_mfma_f32_32x32x16_bf16 v[32:47], a[192:195], v[184:187], v[32:47]
 s_add_u32 m0, s32, 36992
 ds_read_b64_tr_b16 a[208:209], v21 offset:256
 buffer_load_dwordx4 v12, s[8:11], s28 offen lds
 ds_read_b64_tr_b16 a[210:211], v21 offset:4608
 v_mfma_f32_32x32x16_bf16 v[48:63], a[196:199], v[184:187], v[48:63]
 ds_read_b64_tr_b16 a[212:213], v21 offset:320
 ds_read_b64_tr_b16 a[214:215], v21 offset:4672
 v_fma_f32 v253, v253, v237, v245
 v_fma_f32 v254, v254, v238, v246
 v_fma_f32 v255, v255, v239, v247
 s_waitcnt lgkmcnt(4)
 v_mfma_f32_32x32x16_bf16 v[64:79], a[200:203], v[184:187], v[64:79]
 s_add_u32 m0, s32, 38080
 ds_read_b64_tr_b16 a[216:217], v21 offset:384
 buffer_load_dwordx4 v13, s[8:11], s28 offen lds
 ds_read_b64_tr_b16 a[218:219], v21 offset:4736
 v_mfma_f32_32x32x16_bf16 v[80:95], a[204:207], v[184:187], v[80:95]
 ds_read_b64_tr_b16 a[220:221], v21 offset:448
 ds_read_b64_tr_b16 a[222:223], v21 offset:4800
 ds_read_b128 v[216:219], v31 offset:1024
 ds_read_b128 v[220:223], v31 offset:1040
 ds_read_b128 v[224:227], v31 offset:1056
 s_waitcnt lgkmcnt(7)
 v_mfma_f32_32x32x16_bf16 v[96:111], a[208:211], v[184:187], v[96:111]
 s_add_u32 s28, s28, 131072
 s_add_u32 m0, s32, 52224
 ds_read_b64_tr_b16 a[192:193], v23 offset:0
 buffer_load_dwordx4 v10, s[8:11], s28 offen lds
 ds_read_b64_tr_b16 a[194:195], v23 offset:4352
 v_mfma_f32_32x32x16_bf16 v[112:127], a[212:215], v[184:187], v[112:127]
 ds_read_b64_tr_b16 a[196:197], v23 offset:64
 ds_read_b64_tr_b16 a[198:199], v23 offset:4416
 ds_read_b128 v[228:231], v31 offset:1072
 v_cvt_pk_bf16_f32 v188, v248, v249
 v_cvt_pk_bf16_f32 v189, v250, v251
 s_waitcnt lgkmcnt(8)
 v_mfma_f32_32x32x16_bf16 v[128:143], a[216:219], v[184:187], v[128:143]
 s_add_u32 m0, s32, 53312
 ds_read_b64_tr_b16 a[200:201], v23 offset:128
 buffer_load_dwordx4 v11, s[8:11], s28 offen lds
 ds_read_b64_tr_b16 a[202:203], v23 offset:4480
 v_mfma_f32_32x32x16_bf16 v[144:159], a[220:223], v[184:187], v[144:159]
 ds_read_b64_tr_b16 a[204:205], v23 offset:192
 ds_read_b64_tr_b16 a[206:207], v23 offset:4544
 v_cvt_pk_bf16_f32 v190, v252, v253
 v_cvt_pk_bf16_f32 v191, v254, v255
 ds_write_b128 v17, v[188:191] offset:3072
 s_waitcnt lgkmcnt(6)
 v_mfma_f32_32x32x16_bf16 v[32:47], a[192:195], a[24:27], v[32:47]
 s_add_u32 m0, s32, 54400
 ds_read_b64_tr_b16 a[208:209], v23 offset:256
 buffer_load_dwordx4 v12, s[8:11], s28 offen lds
 ds_read_b64_tr_b16 a[210:211], v23 offset:4608
 ds_read_b64_tr_b16 a[212:213], v23 offset:320
 ds_read_b64_tr_b16 a[214:215], v23 offset:4672
 v_mfma_f32_32x32x16_bf16 v[48:63], a[196:199], a[24:27], v[48:63]
 ds_read_b64_tr_b16 a[216:217], v23 offset:384
 ds_read_b64_tr_b16 a[218:219], v23 offset:4736
 ds_read_b64_tr_b16 a[220:221], v23 offset:448
 ds_read_b64_tr_b16 a[222:223], v23 offset:4800
 s_waitcnt lgkmcnt(9)
 v_mfma_f32_32x32x16_bf16 v[64:79], a[200:203], a[24:27], v[64:79]
 s_add_u32 m0, s32, 55488
 s_nop 0
 buffer_load_dwordx4 v13, s[8:11], s28 offen lds
 v_lshlrev_b32 v248, 16, v192
 v_and_b32 v249, 0xffff0000, v192
 v_mfma_f32_32x32x16_bf16 v[80:95], a[204:207], a[24:27], v[80:95]
 v_lshlrev_b32 v250, 16, v193
 v_and_b32 v251, 0xffff0000, v193
 v_lshlrev_b32 v252, 16, v194
 v_and_b32 v253, 0xffff0000, v194
 v_lshlrev_b32 v254, 16, v195
 s_waitcnt lgkmcnt(4)
 v_mfma_f32_32x32x16_bf16 v[96:111], a[208:211], a[24:27], v[96:111]
 s_waitcnt vmcnt(16) lgkmcnt(0)
 s_barrier
 ds_read_b128 a[28:31], v18 offset:3072
 s_add_u32 s28, s28, 131072
 s_add_u32 m0, s32, 69632
 ds_read_b64_tr_b16 a[192:193], v21 offset:34816
 buffer_load_dwordx4 v10, s[8:11], s28 offen lds
 ds_read_b64_tr_b16 a[194:195], v21 offset:39168
 v_mfma_f32_32x32x16_bf16 v[112:127], a[212:215], a[24:27], v[112:127]
 ds_read_b64_tr_b16 a[196:197], v21 offset:34880
 ds_read_b64_tr_b16 a[198:199], v21 offset:39232
 v_and_b32 v255, 0xffff0000, v195
 v_fma_f32 v248, v248, v216, v224
 v_fma_f32 v249, v249, v217, v225
 v_mfma_f32_32x32x16_bf16 v[128:143], a[216:219], a[24:27], v[128:143]
 s_add_u32 m0, s32, 70720
 ds_read_b64_tr_b16 a[200:201], v21 offset:34944
 buffer_load_dwordx4 v11, s[8:11], s28 offen lds
 ds_read_b64_tr_b16 a[202:203], v21 offset:39296
 v_mfma_f32_32x32x16_bf16 v[144:159], a[220:223], a[24:27], v[144:159]
 ds_read_b64_tr_b16 a[204:205], v21 offset:35008
 ds_read_b64_tr_b16 a[206:207], v21 offset:39360
 v_fma_f32 v250, v250, v218, v226
 v_fma_f32 v251, v251, v219, v227
 v_fma_f32 v252, v252, v220, v228
 s_waitcnt lgkmcnt(4)
 v_mfma_f32_32x32x16_bf16 v[32:47], a[192:195], v[188:191], v[32:47]
 s_add_u32 m0, s32, 71808
 ds_read_b64_tr_b16 a[208:209], v21 offset:35072
 buffer_load_dwordx4 v12, s[8:11], s28 offen lds
 ds_read_b64_tr_b16 a[210:211], v21 offset:39424
 v_mfma_f32_32x32x16_bf16 v[48:63], a[196:199], v[188:191], v[48:63]
 ds_read_b64_tr_b16 a[212:213], v21 offset:35136
 ds_read_b64_tr_b16 a[214:215], v21 offset:39488
 v_fma_f32 v253, v253, v221, v229
 v_fma_f32 v254, v254, v222, v230
 v_fma_f32 v255, v255, v223, v231
 s_waitcnt lgkmcnt(4)
 v_mfma_f32_32x32x16_bf16 v[64:79], a[200:203], v[188:191], v[64:79]
 s_add_u32 m0, s32, 72896
 ds_read_b64_tr_b16 a[216:217], v21 offset:35200
 buffer_load_dwordx4 v13, s[8:11], s28 offen lds
 ds_read_b64_tr_b16 a[218:219], v21 offset:39552
 v_mfma_f32_32x32x16_bf16 v[80:95], a[204:207], v[188:191], v[80:95]
 ds_read_b64_tr_b16 a[220:221], v21 offset:35264
 ds_read_b64_tr_b16 a[222:223], v21 offset:39616
 ds_read_b128 v[232:235], v31 offset:1152
 ds_read_b128 v[236:239], v31 offset:1168
 ds_read_b128 v[240:243], v31 offset:1184
 s_waitcnt lgkmcnt(7)
 v_mfma_f32_32x32x16_bf16 v[96:111], a[208:211], v[188:191], v[96:111]
 s_add_u32 s28, s28, 131072
 s_add_u32 m0, s32, 87040
 ds_read_b64_tr_b16 a[192:193], v23 offset:34816
 buffer_load_dwordx4 v10, s[8:11], s28 offen lds
 ds_read_b64_tr_b16 a[194:195], v23 offset:39168
 v_mfma_f32_32x32x16_bf16 v[112:127], a[212:215], v[188:191], v[112:127]
 ds_read_b64_tr_b16 a[196:197], v23 offset:34880
 ds_read_b64_tr_b16 a[198:199], v23 offset:39232
 ds_read_b128 v[244:247], v31 offset:1200
 v_cvt_pk_bf16_f32 v192, v248, v249
 v_cvt_pk_bf16_f32 v193, v250, v251
 s_waitcnt lgkmcnt(8)
 v_mfma_f32_32x32x16_bf16 v[128:143], a[216:219], v[188:191], v[128:143]
 s_add_u32 m0, s32, 88128
 ds_read_b64_tr_b16 a[200:201], v23 offset:34944
 buffer_load_dwordx4 v11, s[8:11], s28 offen lds
 ds_read_b64_tr_b16 a[202:203], v23 offset:39296
 v_mfma_f32_32x32x16_bf16 v[144:159], a[220:223], v[188:191], v[144:159]
 ds_read_b64_tr_b16 a[204:205], v23 offset:35008
 ds_read_b64_tr_b16 a[206:207], v23 offset:39360
 v_cvt_pk_bf16_f32 v194, v252, v253
 v_cvt_pk_bf16_f32 v195, v254, v255
 ds_write_b128 v17, v[192:195] offset:0
 s_waitcnt lgkmcnt(6)
 v_mfma_f32_32x32x16_bf16 v[32:47], a[192:195], a[28:31], v[32:47]
 s_add_u32 m0, s32, 89216
 ds_read_b64_tr_b16 a[208:209], v23 offset:35072
 buffer_load_dwordx4 v12, s[8:11], s28 offen lds
 ds_read_b64_tr_b16 a[210:211], v23 offset:39424
 ds_read_b64_tr_b16 a[212:213], v23 offset:35136
 ds_read_b64_tr_b16 a[214:215], v23 offset:39488
 v_mfma_f32_32x32x16_bf16 v[48:63], a[196:199], a[28:31], v[48:63]
 ds_read_b64_tr_b16 a[216:217], v23 offset:35200
 ds_read_b64_tr_b16 a[218:219], v23 offset:39552
 ds_read_b64_tr_b16 a[220:221], v23 offset:35264
 ds_read_b64_tr_b16 a[222:223], v23 offset:39616
 s_waitcnt lgkmcnt(9)
 v_mfma_f32_32x32x16_bf16 v[64:79], a[200:203], a[28:31], v[64:79]
 s_add_u32 m0, s32, 90304
 s_nop 0
 buffer_load_dwordx4 v13, s[8:11], s28 offen lds
 v_lshlrev_b32 v248, 16, v196
 v_and_b32 v249, 0xffff0000, v196
 v_mfma_f32_32x32x16_bf16 v[80:95], a[204:207], a[28:31], v[80:95]
 v_lshlrev_b32 v250, 16, v197
 v_and_b32 v251, 0xffff0000, v197
 v_lshlrev_b32 v252, 16, v198
 v_and_b32 v253, 0xffff0000, v198
 v_lshlrev_b32 v254, 16, v199
 s_waitcnt lgkmcnt(4)
 v_mfma_f32_32x32x16_bf16 v[96:111], a[208:211], a[28:31], v[96:111]
 s_waitcnt vmcnt(16) lgkmcnt(0)
 s_barrier
 ds_read_b128 a[32:35], v18 offset:0
 s_add_u32 s28, s28, 131072
 s_add_u32 m0, s32, 104448
 ds_read_b64_tr_b16 a[192:193], v20 offset:0
 buffer_load_dwordx4 v10, s[8:11], s28 offen lds
 ds_read_b64_tr_b16 a[194:195], v20 offset:4352
 v_mfma_f32_32x32x16_bf16 v[112:127], a[212:215], a[28:31], v[112:127]
 ds_read_b64_tr_b16 a[196:197], v20 offset:64
 ds_read_b64_tr_b16 a[198:199], v20 offset:4416
 v_and_b32 v255, 0xffff0000, v199
 v_fma_f32 v248, v248, v232, v240
 v_fma_f32 v249, v249, v233, v241
 v_mfma_f32_32x32x16_bf16 v[128:143], a[216:219], a[28:31], v[128:143]
 s_add_u32 m0, s32, 105536
 ds_read_b64_tr_b16 a[200:201], v20 offset:128
 buffer_load_dwordx4 v11, s[8:11], s28 offen lds
 ds_read_b64_tr_b16 a[202:203], v20 offset:4480
 v_mfma_f32_32x32x16_bf16 v[144:159], a[220:223], a[28:31], v[144:159]
 ds_read_b64_tr_b16 a[204:205], v20 offset:192
 ds_read_b64_tr_b16 a[206:207], v20 offset:4544
 v_fma_f32 v250, v250, v234, v242
 v_fma_f32 v251, v251, v235, v243
 v_fma_f32 v252, v252, v236, v244
 s_waitcnt lgkmcnt(4)
 v_mfma_f32_32x32x16_bf16 v[32:47], a[192:195], v[192:195], v[32:47]
 s_add_u32 m0, s32, 106624
 ds_read_b64_tr_b16 a[208:209], v20 offset:256
 buffer_load_dwordx4 v12, s[8:11], s28 offen lds
 ds_read_b64_tr_b16 a[210:211], v20 offset:4608
 v_mfma_f32_32x32x16_bf16 v[48:63], a[196:199], v[192:195], v[48:63]
 ds_read_b64_tr_b16 a[212:213], v20 offset:320
 ds_read_b64_tr_b16 a[214:215], v20 offset:4672
 v_fma_f32 v253, v253, v237, v245
 v_fma_f32 v254, v254, v238, v246
 v_fma_f32 v255, v255, v239, v247
 s_waitcnt lgkmcnt(4)
 v_mfma_f32_32x32x16_bf16 v[64:79], a[200:203], v[192:195], v[64:79]
 s_add_u32 m0, s32, 107712
 ds_read_b64_tr_b16 a[216:217], v20 offset:384
 buffer_load_dwordx4 v13, s[8:11], s28 offen lds
 ds_read_b64_tr_b16 a[218:219], v20 offset:4736
 v_mfma_f32_32x32x16_bf16 v[80:95], a[204:207], v[192:195], v[80:95]
 ds_read_b64_tr_b16 a[220:221], v20 offset:448
 ds_read_b64_tr_b16 a[222:223], v20 offset:4800
 ds_read_b128 v[216:219], v31 offset:1280
 ds_read_b128 v[220:223], v31 offset:1296
 ds_read_b128 v[224:227], v31 offset:1312
 s_waitcnt lgkmcnt(7)
 v_mfma_f32_32x32x16_bf16 v[96:111], a[208:211], v[192:195], v[96:111]
 s_add_u32 s28, s28, 131072
 s_add_u32 m0, s32, 121856
 ds_read_b64_tr_b16 a[192:193], v22 offset:0
 buffer_load_dwordx4 v10, s[8:11], s28 offen lds
 ds_read_b64_tr_b16 a[194:195], v22 offset:4352
 v_mfma_f32_32x32x16_bf16 v[112:127], a[212:215], v[192:195], v[112:127]
 ds_read_b64_tr_b16 a[196:197], v22 offset:64
 ds_read_b64_tr_b16 a[198:199], v22 offset:4416
 ds_read_b128 v[228:231], v31 offset:1328
 v_cvt_pk_bf16_f32 v196, v248, v249
 v_cvt_pk_bf16_f32 v197, v250, v251
 s_waitcnt lgkmcnt(8)
 v_mfma_f32_32x32x16_bf16 v[128:143], a[216:219], v[192:195], v[128:143]
 s_add_u32 m0, s32, 122944
 ds_read_b64_tr_b16 a[200:201], v22 offset:128
 buffer_load_dwordx4 v11, s[8:11], s28 offen lds
 ds_read_b64_tr_b16 a[202:203], v22 offset:4480
 v_mfma_f32_32x32x16_bf16 v[144:159], a[220:223], v[192:195], v[144:159]
 ds_read_b64_tr_b16 a[204:205], v22 offset:192
 ds_read_b64_tr_b16 a[206:207], v22 offset:4544
 v_cvt_pk_bf16_f32 v198, v252, v253
 v_cvt_pk_bf16_f32 v199, v254, v255
 ds_write_b128 v17, v[196:199] offset:1024
 s_waitcnt lgkmcnt(6)
 v_mfma_f32_32x32x16_bf16 v[32:47], a[192:195], a[32:35], v[32:47]
 s_add_u32 m0, s32, 124032
 ds_read_b64_tr_b16 a[208:209], v22 offset:256
 buffer_load_dwordx4 v12, s[8:11], s28 offen lds
 ds_read_b64_tr_b16 a[210:211], v22 offset:4608
 ds_read_b64_tr_b16 a[212:213], v22 offset:320
 ds_read_b64_tr_b16 a[214:215], v22 offset:4672
 v_mfma_f32_32x32x16_bf16 v[48:63], a[196:199], a[32:35], v[48:63]
 ds_read_b64_tr_b16 a[216:217], v22 offset:384
 ds_read_b64_tr_b16 a[218:219], v22 offset:4736
 ds_read_b64_tr_b16 a[220:221], v22 offset:448
 ds_read_b64_tr_b16 a[222:223], v22 offset:4800
 s_waitcnt lgkmcnt(9)
 v_mfma_f32_32x32x16_bf16 v[64:79], a[200:203], a[32:35], v[64:79]
 s_add_u32 m0, s32, 125120
 s_nop 0
 buffer_load_dwordx4 v13, s[8:11], s28 offen lds
 v_lshlrev_b32 v248, 16, v200
 v_and_b32 v249, 0xffff0000, v200
 v_mfma_f32_32x32x16_bf16 v[80:95], a[204:207], a[32:35], v[80:95]
 v_lshlrev_b32 v250, 16, v201
 v_and_b32 v251, 0xffff0000, v201
 v_lshlrev_b32 v252, 16, v202
 v_and_b32 v253, 0xffff0000, v202
 v_lshlrev_b32 v254, 16, v203
 s_waitcnt lgkmcnt(4)
 v_mfma_f32_32x32x16_bf16 v[96:111], a[208:211], a[32:35], v[96:111]
 s_waitcnt vmcnt(16) lgkmcnt(0)
 s_barrier
 ds_read_b128 a[36:39], v18 offset:1024
 s_add_u32 s28, s28, 131072
 s_add_u32 m0, s32, 0
 ds_read_b64_tr_b16 a[192:193], v20 offset:34816
 buffer_load_dwordx4 v10, s[8:11], s28 offen lds
 ds_read_b64_tr_b16 a[194:195], v20 offset:39168
 v_mfma_f32_32x32x16_bf16 v[112:127], a[212:215], a[32:35], v[112:127]
 ds_read_b64_tr_b16 a[196:197], v20 offset:34880
 ds_read_b64_tr_b16 a[198:199], v20 offset:39232
 v_and_b32 v255, 0xffff0000, v203
 v_fma_f32 v248, v248, v216, v224
 v_fma_f32 v249, v249, v217, v225
 v_mfma_f32_32x32x16_bf16 v[128:143], a[216:219], a[32:35], v[128:143]
 s_add_u32 m0, s32, 1088
 ds_read_b64_tr_b16 a[200:201], v20 offset:34944
 buffer_load_dwordx4 v11, s[8:11], s28 offen lds
 ds_read_b64_tr_b16 a[202:203], v20 offset:39296
 v_mfma_f32_32x32x16_bf16 v[144:159], a[220:223], a[32:35], v[144:159]
 ds_read_b64_tr_b16 a[204:205], v20 offset:35008
 ds_read_b64_tr_b16 a[206:207], v20 offset:39360
 v_fma_f32 v250, v250, v218, v226
 v_fma_f32 v251, v251, v219, v227
 v_fma_f32 v252, v252, v220, v228
 s_waitcnt lgkmcnt(4)
 v_mfma_f32_32x32x16_bf16 v[32:47], a[192:195], v[196:199], v[32:47]
 s_add_u32 m0, s32, 2176
 ds_read_b64_tr_b16 a[208:209], v20 offset:35072
 buffer_load_dwordx4 v12, s[8:11], s28 offen lds
 ds_read_b64_tr_b16 a[210:211], v20 offset:39424
 v_mfma_f32_32x32x16_bf16 v[48:63], a[196:199], v[196:199], v[48:63]
 ds_read_b64_tr_b16 a[212:213], v20 offset:35136
 ds_read_b64_tr_b16 a[214:215], v20 offset:39488
 v_fma_f32 v253, v253, v221, v229
 v_fma_f32 v254, v254, v222, v230
 v_fma_f32 v255, v255, v223, v231
 s_waitcnt lgkmcnt(4)
 v_mfma_f32_32x32x16_bf16 v[64:79], a[200:203], v[196:199], v[64:79]
 s_add_u32 m0, s32, 3264
 ds_read_b64_tr_b16 a[216:217], v20 offset:35200
 buffer_load_dwordx4 v13, s[8:11], s28 offen lds
 ds_read_b64_tr_b16 a[218:219], v20 offset:39552
 v_mfma_f32_32x32x16_bf16 v[80:95], a[204:207], v[196:199], v[80:95]
 ds_read_b64_tr_b16 a[220:221], v20 offset:35264
 ds_read_b64_tr_b16 a[222:223], v20 offset:39616
 ds_read_b128 v[232:235], v31 offset:1408
 ds_read_b128 v[236:239], v31 offset:1424
 ds_read_b128 v[240:243], v31 offset:1440
 s_waitcnt lgkmcnt(7)
 v_mfma_f32_32x32x16_bf16 v[96:111], a[208:211], v[196:199], v[96:111]
 s_add_u32 s28, s28, 131072
 s_add_u32 m0, s32, 17408
 ds_read_b64_tr_b16 a[192:193], v22 offset:34816
 buffer_load_dwordx4 v10, s[8:11], s28 offen lds
 ds_read_b64_tr_b16 a[194:195], v22 offset:39168
 v_mfma_f32_32x32x16_bf16 v[112:127], a[212:215], v[196:199], v[112:127]
 ds_read_b64_tr_b16 a[196:197], v22 offset:34880
 ds_read_b64_tr_b16 a[198:199], v22 offset:39232
 ds_read_b128 v[244:247], v31 offset:1456
 v_cvt_pk_bf16_f32 v200, v248, v249
 v_cvt_pk_bf16_f32 v201, v250, v251
 s_waitcnt lgkmcnt(8)
 v_mfma_f32_32x32x16_bf16 v[128:143], a[216:219], v[196:199], v[128:143]
 s_add_u32 m0, s32, 18496
 ds_read_b64_tr_b16 a[200:201], v22 offset:34944
 buffer_load_dwordx4 v11, s[8:11], s28 offen lds
 ds_read_b64_tr_b16 a[202:203], v22 offset:39296
 v_mfma_f32_32x32x16_bf16 v[144:159], a[220:223], v[196:199], v[144:159]
 ds_read_b64_tr_b16 a[204:205], v22 offset:35008
 ds_read_b64_tr_b16 a[206:207], v22 offset:39360
 v_cvt_pk_bf16_f32 v202, v252, v253
 v_cvt_pk_bf16_f32 v203, v254, v255
 ds_write_b128 v17, v[200:203] offset:2048
 s_waitcnt lgkmcnt(6)
 v_mfma_f32_32x32x16_bf16 v[32:47], a[192:195], a[36:39], v[32:47]
 s_add_u32 m0, s32, 19584
 ds_read_b64_tr_b16 a[208:209], v22 offset:35072
 buffer_load_dwordx4 v12, s[8:11], s28 offen lds
 ds_read_b64_tr_b16 a[210:211], v22 offset:39424
 ds_read_b64_tr_b16 a[212:213], v22 offset:35136
 ds_read_b64_tr_b16 a[214:215], v22 offset:39488
 v_mfma_f32_32x32x16_bf16 v[48:63], a[196:199], a[36:39], v[48:63]
 ds_read_b64_tr_b16 a[216:217], v22 offset:35200
 ds_read_b64_tr_b16 a[218:219], v22 offset:39552
 ds_read_b64_tr_b16 a[220:221], v22 offset:35264
 ds_read_b64_tr_b16 a[222:223], v22 offset:39616
 s_waitcnt lgkmcnt(9)
 v_mfma_f32_32x32x16_bf16 v[64:79], a[200:203], a[36:39], v[64:79]
 s_add_u32 m0, s32, 20672
 s_nop 0
 buffer_load_dwordx4 v13, s[8:11], s28 offen lds
 v_lshlrev_b32 v248, 16, v204
 v_and_b32 v249, 0xffff0000, v204
 v_mfma_f32_32x32x16_bf16 v[80:95], a[204:207], a[36:39], v[80:95]
 v_lshlrev_b32 v250, 16, v205
 v_and_b32 v251, 0xffff0000, v205
 v_lshlrev_b32 v252, 16, v206
 v_and_b32 v253, 0xffff0000, v206
 v_lshlrev_b32 v254, 16, v207
 s_waitcnt lgkmcnt(4)
 v_mfma_f32_32x32x16_bf16 v[96:111], a[208:211], a[36:39], v[96:111]
 s_waitcnt vmcnt(16) lgkmcnt(0)
 s_barrier
 ds_read_b128 a[40:43], v18 offset:2048
 s_add_u32 s28, s28, 131072
 s_add_u32 m0, s32, 34816
 ds_read_b64_tr_b16 a[192:193], v21 offset:0
 buffer_load_dwordx4 v10, s[8:11], s28 offen lds
 ds_read_b64_tr_b16 a[194:195], v21 offset:4352
 v_mfma_f32_32x32x16_bf16 v[112:127], a[212:215], a[36:39], v[112:127]
 ds_read_b64_tr_b16 a[196:197], v21 offset:64
 ds_read_b64_tr_b16 a[198:199], v21 offset:4416
 v_and_b32 v255, 0xffff0000, v207
 v_fma_f32 v248, v248, v232, v240
 v_fma_f32 v249, v249, v233, v241
 v_mfma_f32_32x32x16_bf16 v[128:143], a[216:219], a[36:39], v[128:143]
 s_add_u32 m0, s32, 35904
 ds_read_b64_tr_b16 a[200:201], v21 offset:128
 buffer_load_dwordx4 v11, s[8:11], s28 offen lds
 ds_read_b64_tr_b16 a[202:203], v21 offset:4480
 v_mfma_f32_32x32x16_bf16 v[144:159], a[220:223], a[36:39], v[144:159]
 ds_read_b64_tr_b16 a[204:205], v21 offset:192
 ds_read_b64_tr_b16 a[206:207], v21 offset:4544
 v_fma_f32 v250, v250, v234, v242
 v_fma_f32 v251, v251, v235, v243
 v_fma_f32 v252, v252, v236, v244
 s_waitcnt lgkmcnt(4)
 v_mfma_f32_32x32x16_bf16 v[32:47], a[192:195], v[200:203], v[32:47]
 s_add_u32 m0, s32, 36992
 ds_read_b64_tr_b16 a[208:209], v21 offset:256
 buffer_load_dwordx4 v12, s[8:11], s28 offen lds
 ds_read_b64_tr_b16 a[210:211], v21 offset:4608
 v_mfma_f32_32x32x16_bf16 v[48:63], a[196:199], v[200:203], v[48:63]
 ds_read_b64_tr_b16 a[212:213], v21 offset:320
 ds_read_b64_tr_b16 a[214:215], v21 offset:4672
 v_fma_f32 v253, v253, v237, v245
 v_fma_f32 v254, v254, v238, v246
 v_fma_f32 v255, v255, v239, v247
 s_waitcnt lgkmcnt(4)
 v_mfma_f32_32x32x16_bf16 v[64:79], a[200:203], v[200:203], v[64:79]
 s_add_u32 m0, s32, 38080
 ds_read_b64_tr_b16 a[216:217], v21 offset:384
 buffer_load_dwordx4 v13, s[8:11], s28 offen lds
 ds_read_b64_tr_b16 a[218:219], v21 offset:4736
 v_mfma_f32_32x32x16_bf16 v[80:95], a[204:207], v[200:203], v[80:95]
 ds_read_b64_tr_b16 a[220:221], v21 offset:448
 ds_read_b64_tr_b16 a[222:223], v21 offset:4800
 ds_read_b128 v[216:219], v31 offset:1536
 ds_read_b128 v[220:223], v31 offset:1552
 ds_read_b128 v[224:227], v31 offset:1568
 s_waitcnt lgkmcnt(7)
 v_mfma_f32_32x32x16_bf16 v[96:111], a[208:211], v[200:203], v[96:111]
 s_add_u32 s28, s28, 131072
 s_add_u32 m0, s32, 52224
 ds_read_b64_tr_b16 a[192:193], v23 offset:0
 buffer_load_dwordx4 v10, s[8:11], s28 offen lds
 ds_read_b64_tr_b16 a[194:195], v23 offset:4352
 v_mfma_f32_32x32x16_bf16 v[112:127], a[212:215], v[200:203], v[112:127]
 ds_read_b64_tr_b16 a[196:197], v23 offset:64
 ds_read_b64_tr_b16 a[198:199], v23 offset:4416
 ds_read_b128 v[228:231], v31 offset:1584
 v_cvt_pk_bf16_f32 v204, v248, v249
 v_cvt_pk_bf16_f32 v205, v250, v251
 s_waitcnt lgkmcnt(8)
 v_mfma_f32_32x32x16_bf16 v[128:143], a[216:219], v[200:203], v[128:143]
 s_add_u32 m0, s32, 53312
 ds_read_b64_tr_b16 a[200:201], v23 offset:128
 buffer_load_dwordx4 v11, s[8:11], s28 offen lds
 ds_read_b64_tr_b16 a[202:203], v23 offset:4480
 v_mfma_f32_32x32x16_bf16 v[144:159], a[220:223], v[200:203], v[144:159]
 ds_read_b64_tr_b16 a[204:205], v23 offset:192
 ds_read_b64_tr_b16 a[206:207], v23 offset:4544
 v_cvt_pk_bf16_f32 v206, v252, v253
 v_cvt_pk_bf16_f32 v207, v254, v255
 ds_write_b128 v17, v[204:207] offset:3072
 s_waitcnt lgkmcnt(6)
 v_mfma_f32_32x32x16_bf16 v[32:47], a[192:195], a[40:43], v[32:47]
 s_add_u32 m0, s32, 54400
 ds_read_b64_tr_b16 a[208:209], v23 offset:256
 buffer_load_dwordx4 v12, s[8:11], s28 offen lds
 ds_read_b64_tr_b16 a[210:211], v23 offset:4608
 ds_read_b64_tr_b16 a[212:213], v23 offset:320
 ds_read_b64_tr_b16 a[214:215], v23 offset:4672
 v_mfma_f32_32x32x16_bf16 v[48:63], a[196:199], a[40:43], v[48:63]
 ds_read_b64_tr_b16 a[216:217], v23 offset:384
 ds_read_b64_tr_b16 a[218:219], v23 offset:4736
 ds_read_b64_tr_b16 a[220:221], v23 offset:448
 ds_read_b64_tr_b16 a[222:223], v23 offset:4800
 s_waitcnt lgkmcnt(9)
 v_mfma_f32_32x32x16_bf16 v[64:79], a[200:203], a[40:43], v[64:79]
 s_add_u32 m0, s32, 55488
 s_nop 0
 buffer_load_dwordx4 v13, s[8:11], s28 offen lds
 v_lshlrev_b32 v248, 16, v208
 v_and_b32 v249, 0xffff0000, v208
 v_mfma_f32_32x32x16_bf16 v[80:95], a[204:207], a[40:43], v[80:95]
 v_lshlrev_b32 v250, 16, v209
 v_and_b32 v251, 0xffff0000, v209
 v_lshlrev_b32 v252, 16, v210
 v_and_b32 v253, 0xffff0000, v210
 v_lshlrev_b32 v254, 16, v211
 s_waitcnt lgkmcnt(4)
 v_mfma_f32_32x32x16_bf16 v[96:111], a[208:211], a[40:43], v[96:111]
 s_waitcnt vmcnt(16) lgkmcnt(0)
 s_barrier
 ds_read_b128 a[44:47], v18 offset:3072
 s_add_u32 m0, s33, 69632
 ds_read_b64_tr_b16 a[192:193], v21 offset:34816
 buffer_load_dwordx4 v14, s[12:15], s29 offen offset:0 lds
 ds_read_b64_tr_b16 a[194:195], v21 offset:39168
 v_mfma_f32_32x32x16_bf16 v[112:127], a[212:215], a[40:43], v[112:127]
 ds_read_b64_tr_b16 a[196:197], v21 offset:34880
 ds_read_b64_tr_b16 a[198:199], v21 offset:39232
 v_and_b32 v255, 0xffff0000, v211
 v_fma_f32 v248, v248, v216, v224
 v_fma_f32 v249, v249, v217, v225
 v_mfma_f32_32x32x16_bf16 v[128:143], a[216:219], a[40:43], v[128:143]
 ds_read_b64_tr_b16 a[200:201], v21 offset:34944
 ds_read_b64_tr_b16 a[202:203], v21 offset:39296
 v_fma_f32 v250, v250, v218, v226
 v_fma_f32 v251, v251, v219, v227
 v_fma_f32 v252, v252, v220, v228
 v_mfma_f32_32x32x16_bf16 v[144:159], a[220:223], a[40:43], v[144:159]
 ds_read_b64_tr_b16 a[204:205], v21 offset:35008
 ds_read_b64_tr_b16 a[206:207], v21 offset:39360
 v_fma_f32 v253, v253, v221, v229
 v_fma_f32 v254, v254, v222, v230
 v_fma_f32 v255, v255, v223, v231
 s_waitcnt lgkmcnt(4)
 v_mfma_f32_32x32x16_bf16 v[32:47], a[192:195], v[204:207], v[32:47]
 ds_read_b64_tr_b16 a[208:209], v21 offset:35072
 ds_read_b64_tr_b16 a[210:211], v21 offset:39424
 ds_read_b128 v[232:235], v31 offset:1664
 ds_read_b128 v[236:239], v31 offset:1680
 ds_read_b128 v[240:243], v31 offset:1696
 v_mfma_f32_32x32x16_bf16 v[48:63], a[196:199], v[204:207], v[48:63]
 s_add_u32 m0, s33, 70160
 ds_read_b64_tr_b16 a[212:213], v21 offset:35136
 buffer_load_dwordx4 v14, s[12:15], s29 offen offset:512 lds
 ds_read_b64_tr_b16 a[214:215], v21 offset:39488
 s_waitcnt lgkmcnt(7)
 v_mfma_f32_32x32x16_bf16 v[64:79], a[200:203], v[204:207], v[64:79]
 ds_read_b64_tr_b16 a[216:217], v21 offset:35200
 ds_read_b64_tr_b16 a[218:219], v21 offset:39552
 ds_read_b128 v[244:247], v31 offset:1712
 v_cvt_pk_bf16_f32 v208, v248, v249
 v_cvt_pk_bf16_f32 v209, v250, v251
 v_mfma_f32_32x32x16_bf16 v[80:95], a[204:207], v[204:207], v[80:95]
 ds_read_b64_tr_b16 a[220:221], v21 offset:35264
 ds_read_b64_tr_b16 a[222:223], v21 offset:39616
 v_cvt_pk_bf16_f32 v210, v252, v253
 v_cvt_pk_bf16_f32 v211, v254, v255
 ds_write_b128 v17, v[208:211] offset:0
 s_waitcnt lgkmcnt(6)
 v_mfma_f32_32x32x16_bf16 v[96:111], a[208:211], v[204:207], v[96:111]
 ds_read_b64_tr_b16 a[192:193], v23 offset:34816
 ds_read_b64_tr_b16 a[194:195], v23 offset:39168
 v_mfma_f32_32x32x16_bf16 v[112:127], a[212:215], v[204:207], v[112:127]
 ds_read_b64_tr_b16 a[196:197], v23 offset:34880
 ds_read_b64_tr_b16 a[198:199], v23 offset:39232
 s_waitcnt lgkmcnt(5)
 v_mfma_f32_32x32x16_bf16 v[128:143], a[216:219], v[204:207], v[128:143]
 s_add_u32 m0, s33, 70688
 ds_read_b64_tr_b16 a[200:201], v23 offset:34944
 buffer_load_dwordx4 v14, s[12:15], s29 offen offset:1024 lds
 ds_read_b64_tr_b16 a[202:203], v23 offset:39296
 v_mfma_f32_32x32x16_bf16 v[144:159], a[220:223], v[204:207], v[144:159]
 ds_read_b64_tr_b16 a[204:205], v23 offset:35008
 ds_read_b64_tr_b16 a[206:207], v23 offset:39360
 s_waitcnt lgkmcnt(4)
 v_mfma_f32_32x32x16_bf16 v[32:47], a[192:195], a[44:47], v[32:47]
 ds_read_b64_tr_b16 a[208:209], v23 offset:35072
 ds_read_b64_tr_b16 a[210:211], v23 offset:39424
 ds_read_b64_tr_b16 a[212:213], v23 offset:35136
 ds_read_b64_tr_b16 a[214:215], v23 offset:39488
 v_mfma_f32_32x32x16_bf16 v[48:63], a[196:199], a[44:47], v[48:63]
 ds_read_b64_tr_b16 a[216:217], v23 offset:35200
 ds_read_b64_tr_b16 a[218:219], v23 offset:39552
 ds_read_b64_tr_b16 a[220:221], v23 offset:35264
 ds_read_b64_tr_b16 a[222:223], v23 offset:39616
 s_waitcnt lgkmcnt(8)
 v_mfma_f32_32x32x16_bf16 v[64:79], a[200:203], a[44:47], v[64:79]
 v_lshlrev_b32 v248, 16, v212
 v_and_b32 v249, 0xffff0000, v212
 v_lshlrev_b32 v250, 16, v213
 v_and_b32 v251, 0xffff0000, v213
 v_lshlrev_b32 v252, 16, v214
 v_mfma_f32_32x32x16_bf16 v[80:95], a[204:207], a[44:47], v[80:95]
 s_add_u32 m0, s33, 71216
 s_nop 0
 buffer_load_dwordx4 v14, s[12:15], s29 offen offset:1536 lds
 v_and_b32 v253, 0xffff0000, v214
 v_lshlrev_b32 v254, 16, v215
 s_waitcnt lgkmcnt(4)
 v_mfma_f32_32x32x16_bf16 v[96:111], a[208:211], a[44:47], v[96:111]
 s_waitcnt vmcnt(12) lgkmcnt(0)
 s_barrier
 ds_read_b128 a[48:51], v18 offset:0
 ds_read_b64_tr_b16 a[192:193], v20 offset:0
 ds_read_b64_tr_b16 a[194:195], v20 offset:4352
 v_and_b32 v255, 0xffff0000, v215
 v_mfma_f32_32x32x16_bf16 v[112:127], a[212:215], a[44:47], v[112:127]
 ds_read_b64_tr_b16 a[196:197], v20 offset:64
 ds_read_b64_tr_b16 a[198:199], v20 offset:4416
 v_fma_f32 v248, v248, v232, v240
 v_fma_f32 v249, v249, v233, v241
 v_fma_f32 v250, v250, v234, v242
 v_mfma_f32_32x32x16_bf16 v[128:143], a[216:219], a[44:47], v[128:143]
 s_add_u32 s29, s29, 16384
 s_add_u32 m0, s33, 87040
 ds_read_b64_tr_b16 a[200:201], v20 offset:128
 buffer_load_dwordx4 v14, s[12:15], s29 offen offset:0 lds
 ds_read_b64_tr_b16 a[202:203], v20 offset:4480
 v_mfma_f32_32x32x16_bf16 v[144:159], a[220:223], a[44:47], v[144:159]
 ds_read_b64_tr_b16 a[204:205], v20 offset:192
 ds_read_b64_tr_b16 a[206:207], v20 offset:4544
 v_fma_f32 v251, v251, v235, v243
 v_fma_f32 v252, v252, v236, v244
 v_fma_f32 v253, v253, v237, v245
 s_waitcnt lgkmcnt(4)
 v_mfma_f32_32x32x16_bf16 v[32:47], a[192:195], v[208:211], v[32:47]
 s_add_u32 m0, s33, 87568
 ds_read_b64_tr_b16 a[208:209], v20 offset:256
 buffer_load_dwordx4 v14, s[12:15], s29 offen offset:512 lds
 ds_read_b64_tr_b16 a[210:211], v20 offset:4608
 v_mfma_f32_32x32x16_bf16 v[48:63], a[196:199], v[208:211], v[48:63]
 ds_read_b64_tr_b16 a[212:213], v20 offset:320
 ds_read_b64_tr_b16 a[214:215], v20 offset:4672
 v_fma_f32 v254, v254, v238, v246
 v_fma_f32 v255, v255, v239, v247
 v_cvt_pk_bf16_f32 v212, v248, v249
 s_waitcnt lgkmcnt(4)
 v_mfma_f32_32x32x16_bf16 v[64:79], a[200:203], v[208:211], v[64:79]
 s_add_u32 m0, s33, 88096
 ds_read_b64_tr_b16 a[216:217], v20 offset:384
 buffer_load_dwordx4 v14, s[12:15], s29 offen offset:1024 lds
 ds_read_b64_tr_b16 a[218:219], v20 offset:4736
 v_mfma_f32_32x32x16_bf16 v[80:95], a[204:207], v[208:211], v[80:95]
 ds_read_b64_tr_b16 a[220:221], v20 offset:448
 ds_read_b64_tr_b16 a[222:223], v20 offset:4800
 v_cvt_pk_bf16_f32 v213, v250, v251
 v_cvt_pk_bf16_f32 v214, v252, v253
 v_cvt_pk_bf16_f32 v215, v254, v255
 s_waitcnt lgkmcnt(4)
 v_mfma_f32_32x32x16_bf16 v[96:111], a[208:211], v[208:211], v[96:111]
 s_add_u32 m0, s33, 88624
 ds_read_b64_tr_b16 a[192:193], v22 offset:0
 buffer_load_dwordx4 v14, s[12:15], s29 offen offset:1536 lds
 ds_read_b64_tr_b16 a[194:195], v22 offset:4352
 v_mfma_f32_32x32x16_bf16 v[112:127], a[212:215], v[208:211], v[112:127]
 ds_read_b64_tr_b16 a[196:197], v22 offset:64
 ds_read_b64_tr_b16 a[198:199], v22 offset:4416
 ds_write_b128 v17, v[212:215] offset:1024
 s_waitcnt lgkmcnt(5)
 v_mfma_f32_32x32x16_bf16 v[128:143], a[216:219], v[208:211], v[128:143]
 ds_read_b64_tr_b16 a[200:201], v22 offset:128
 ds_read_b64_tr_b16 a[202:203], v22 offset:4480
 v_mfma_f32_32x32x16_bf16 v[144:159], a[220:223], v[208:211], v[144:159]
 ds_read_b64_tr_b16 a[204:205], v22 offset:192
 ds_read_b64_tr_b16 a[206:207], v22 offset:4544
 s_waitcnt lgkmcnt(5)
 v_mfma_f32_32x32x16_bf16 v[32:47], a[192:195], a[48:51], v[32:47]
 ds_read_b64_tr_b16 a[208:209], v22 offset:256
 ds_read_b64_tr_b16 a[210:211], v22 offset:4608
 ds_read_b64_tr_b16 a[212:213], v22 offset:320
 ds_read_b64_tr_b16 a[214:215], v22 offset:4672
 v_mfma_f32_32x32x16_bf16 v[48:63], a[196:199], a[48:51], v[48:63]
 s_add_u32 s29, s29, 16384
 s_add_u32 m0, s33, 104448
 ds_read_b64_tr_b16 a[216:217], v22 offset:384
 buffer_load_dwordx4 v14, s[12:15], s29 offen offset:0 lds
 ds_read_b64_tr_b16 a[218:219], v22 offset:4736
 ds_read_b64_tr_b16 a[220:221], v22 offset:448
 ds_read_b64_tr_b16 a[222:223], v22 offset:4800
 s_waitcnt lgkmcnt(8)
 v_mfma_f32_32x32x16_bf16 v[64:79], a[200:203], a[48:51], v[64:79]
 v_mfma_f32_32x32x16_bf16 v[80:95], a[204:207], a[48:51], v[80:95]
 s_waitcnt lgkmcnt(4)
 v_mfma_f32_32x32x16_bf16 v[96:111], a[208:211], a[48:51], v[96:111]
 s_waitcnt vmcnt(9) lgkmcnt(0)
 s_barrier
 ds_read_b128 a[52:55], v18 offset:1024
 ds_read_b64_tr_b16 a[192:193], v20 offset:34816
 ds_read_b64_tr_b16 a[194:195], v20 offset:39168
 v_mfma_f32_32x32x16_bf16 v[112:127], a[212:215], a[48:51], v[112:127]
 ds_read_b64_tr_b16 a[196:197], v22 offset:34816
 ds_read_b64_tr_b16 a[198:199], v22 offset:39168
 v_mfma_f32_32x32x16_bf16 v[128:143], a[216:219], a[48:51], v[128:143]
 s_add_u32 m0, s33, 104976
 ds_read_b64_tr_b16 a[200:201], v20 offset:34880
 buffer_load_dwordx4 v14, s[12:15], s29 offen offset:512 lds
 ds_read_b64_tr_b16 a[202:203], v20 offset:39232
 v_mfma_f32_32x32x16_bf16 v[144:159], a[220:223], a[48:51], v[144:159]
 ds_read_b64_tr_b16 a[204:205], v22 offset:34880
 ds_read_b64_tr_b16 a[206:207], v22 offset:39232
 s_waitcnt lgkmcnt(4)
 v_mfma_f32_32x32x16_bf16 v[32:47], a[192:195], v[212:215], v[32:47]
 ds_read_b64_tr_b16 a[208:209], v20 offset:34944
 ds_read_b64_tr_b16 a[210:211], v20 offset:39296
 v_mfma_f32_32x32x16_bf16 v[32:47], a[196:199], a[52:55], v[32:47]
 ds_read_b64_tr_b16 a[212:213], v22 offset:34944
 ds_read_b64_tr_b16 a[214:215], v22 offset:39296
 s_waitcnt lgkmcnt(4)
 v_mfma_f32_32x32x16_bf16 v[48:63], a[200:203], v[212:215], v[48:63]
 ds_read_b64_tr_b16 a[216:217], v20 offset:35008
 ds_read_b64_tr_b16 a[218:219], v20 offset:39360
 v_mfma_f32_32x32x16_bf16 v[48:63], a[204:207], a[52:55], v[48:63]
 s_add_u32 m0, s33, 105504
 ds_read_b64_tr_b16 a[220:221], v22 offset:35008
 buffer_load_dwordx4 v14, s[12:15], s29 offen offset:1024 lds
 ds_read_b64_tr_b16 a[222:223], v22 offset:39360
 s_waitcnt lgkmcnt(4)
 v_mfma_f32_32x32x16_bf16 v[64:79], a[208:211], v[212:215], v[64:79]
 ds_read_b64_tr_b16 a[192:193], v20 offset:35072
 ds_read_b64_tr_b16 a[194:195], v20 offset:39424
 v_cvt_pk_bf16_f32 v32, v32, v33
 v_cvt_pk_bf16_f32 v33, v34, v35
 v_cvt_pk_bf16_f32 v34, v36, v37
 v_mfma_f32_32x32x16_bf16 v[64:79], a[212:215], a[52:55], v[64:79]
 ds_read_b64_tr_b16 a[196:197], v22 offset:35072
 ds_read_b64_tr_b16 a[198:199], v22 offset:39424
 v_cvt_pk_bf16_f32 v35, v38, v39
 v_cvt_pk_bf16_f32 v36, v40, v41
 v_cvt_pk_bf16_f32 v37, v42, v43
 s_waitcnt lgkmcnt(4)
 v_mfma_f32_32x32x16_bf16 v[80:95], a[216:219], v[212:215], v[80:95]
 ds_read_b64_tr_b16 a[200:201], v20 offset:35136
 ds_read_b64_tr_b16 a[202:203], v20 offset:39488
 v_cvt_pk_bf16_f32 v38, v44, v45
 v_cvt_pk_bf16_f32 v39, v46, v47
 v_cvt_pk_bf16_f32 v48, v48, v49
 v_mfma_f32_32x32x16_bf16 v[80:95], a[220:223], a[52:55], v[80:95]
 ds_read_b64_tr_b16 a[204:205], v22 offset:35136
 ds_read_b64_tr_b16 a[206:207], v22 offset:39488
 v_cvt_pk_bf16_f32 v49, v50, v51
 v_cvt_pk_bf16_f32 v50, v52, v53
 v_cvt_pk_bf16_f32 v51, v54, v55
 s_waitcnt lgkmcnt(4)
 v_mfma_f32_32x32x16_bf16 v[96:111], a[192:195], v[212:215], v[96:111]
 s_add_u32 m0, s33, 106032
 ds_read_b64_tr_b16 a[208:209], v20 offset:35200
 buffer_load_dwordx4 v14, s[12:15], s29 offen offset:1536 lds
 ds_read_b64_tr_b16 a[210:211], v20 offset:39552
 ds_read_b64_tr_b16 a[212:213], v22 offset:35200
 ds_read_b64_tr_b16 a[214:215], v22 offset:39552
 v_mfma_f32_32x32x16_bf16 v[96:111], a[196:199], a[52:55], v[96:111]
 ds_read_b64_tr_b16 a[216:217], v20 offset:35264
 ds_read_b64_tr_b16 a[218:219], v20 offset:39616
 ds_read_b64_tr_b16 a[220:221], v22 offset:35264
 ds_read_b64_tr_b16 a[222:223], v22 offset:39616
 v_cvt_pk_bf16_f32 v52, v56, v57
 s_waitcnt lgkmcnt(8)
 v_mfma_f32_32x32x16_bf16 v[112:127], a[200:203], v[212:215], v[112:127]
 v_cvt_pk_bf16_f32 v53, v58, v59
 v_cvt_pk_bf16_f32 v54, v60, v61
 v_cvt_pk_bf16_f32 v55, v62, v63
 v_cvt_pk_bf16_f32 v64, v64, v65
 v_cvt_pk_bf16_f32 v65, v66, v67
 v_mfma_f32_32x32x16_bf16 v[112:127], a[204:207], a[52:55], v[112:127]
 v_cvt_pk_bf16_f32 v66, v68, v69
 v_cvt_pk_bf16_f32 v67, v70, v71
 v_cvt_pk_bf16_f32 v68, v72, v73
 v_cvt_pk_bf16_f32 v69, v74, v75
 v_cvt_pk_bf16_f32 v70, v76, v77
 s_waitcnt lgkmcnt(4)
 v_mfma_f32_32x32x16_bf16 v[128:143], a[208:211], v[212:215], v[128:143]
 s_waitcnt vmcnt(4) lgkmcnt(0)
 s_barrier
 ds_read_b128 a[192:195], v8 offset:17408
 v_cvt_pk_bf16_f32 v71, v78, v79
 v_cvt_pk_bf16_f32 v80, v80, v81
 v_mfma_f32_32x32x16_bf16 v[128:143], a[212:215], a[52:55], v[128:143]
 s_add_u32 s29, s29, 16384
 s_add_u32 m0, s33, 121856
 ds_read_b128 a[196:199], v8 offset:17440
 buffer_load_dwordx4 v14, s[12:15], s29 offen offset:0 lds
 v_mfma_f32_32x32x16_bf16 v[144:159], a[216:219], v[212:215], v[144:159]
 ds_read_b128 a[200:203], v8 offset:17472
 v_cvt_pk_bf16_f32 v81, v82, v83
 v_cvt_pk_bf16_f32 v82, v84, v85
 v_cvt_pk_bf16_f32 v83, v86, v87
 v_cvt_pk_bf16_f32 v84, v88, v89
 v_mfma_f32_32x32x16_bf16 v[144:159], a[220:223], a[52:55], v[144:159]
 ds_read_b128 a[204:207], v8 offset:17504
 v_cvt_pk_bf16_f32 v85, v90, v91
 v_cvt_pk_bf16_f32 v86, v92, v93
 v_cvt_pk_bf16_f32 v87, v94, v95
 v_cvt_pk_bf16_f32 v96, v96, v97
 s_waitcnt lgkmcnt(2)
 v_mfma_f32_32x32x16_bf16 v[160:175], a[192:195], v[32:35], 0
 s_add_u32 m0, s33, 122384
 ds_read_b128 a[208:211], v8 offset:17536
 buffer_load_dwordx4 v14, s[12:15], s29 offen offset:512 lds
 v_cvt_pk_bf16_f32 v97, v98, v99
 v_mfma_f32_32x32x16_bf16 v[160:175], a[196:199], v[36:39], v[160:175]
 ds_read_b128 a[212:215], v8 offset:17568
 v_cvt_pk_bf16_f32 v98, v100, v101
 v_cvt_pk_bf16_f32 v99, v102, v103
 v_cvt_pk_bf16_f32 v100, v104, v105
 v_cvt_pk_bf16_f32 v101, v106, v107
 s_waitcnt lgkmcnt(2)
 v_mfma_f32_32x32x16_bf16 v[160:175], a[200:203], v[48:51], v[160:175]
 s_add_u32 m0, s33, 122912
 ds_read_b128 a[216:219], v8 offset:17600
 buffer_load_dwordx4 v14, s[12:15], s29 offen offset:1024 lds
 v_cvt_pk_bf16_f32 v102, v108, v109
 v_mfma_f32_32x32x16_bf16 v[160:175], a[204:207], v[52:55], v[160:175]
 ds_read_b128 a[220:223], v8 offset:17632
 v_cvt_pk_bf16_f32 v103, v110, v111
 v_cvt_pk_bf16_f32 v112, v112, v113
 v_cvt_pk_bf16_f32 v113, v114, v115
 v_cvt_pk_bf16_f32 v114, v116, v117
 s_waitcnt lgkmcnt(2)
 v_mfma_f32_32x32x16_bf16 v[160:175], a[208:211], v[64:67], v[160:175]
 s_add_u32 m0, s33, 123440
 ds_read_b128 a[192:195], v8 offset:17664
 buffer_load_dwordx4 v14, s[12:15], s29 offen offset:1536 lds
 v_cvt_pk_bf16_f32 v115, v118, v119
 v_mfma_f32_32x32x16_bf16 v[160:175], a[212:215], v[68:71], v[160:175]
 ds_read_b128 a[196:199], v8 offset:17696
 v_cvt_pk_bf16_f32 v116, v120, v121
 v_cvt_pk_bf16_f32 v117, v122, v123
 v_cvt_pk_bf16_f32 v118, v124, v125
 v_cvt_pk_bf16_f32 v119, v126, v127
 s_waitcnt lgkmcnt(2)
 v_mfma_f32_32x32x16_bf16 v[160:175], a[216:219], v[80:83], v[160:175]
 ds_read_b128 a[200:203], v8 offset:17728
 v_cvt_pk_bf16_f32 v128, v128, v129
 v_cvt_pk_bf16_f32 v129, v130, v131
 v_cvt_pk_bf16_f32 v130, v132, v133
 v_cvt_pk_bf16_f32 v131, v134, v135
 v_mfma_f32_32x32x16_bf16 v[160:175], a[220:223], v[84:87], v[160:175]
 s_add_u32 s29, s29, 16384
 s_add_u32 m0, s33, 0
 ds_read_b128 a[204:207], v8 offset:17760
 buffer_load_dwordx4 v14, s[12:15], s29 offen offset:0 lds
 s_waitcnt lgkmcnt(2)
 v_mfma_f32_32x32x16_bf16 v[160:175], a[192:195], v[96:99], v[160:175]
 ds_read_b128 a[208:211], v8 offset:17792
 v_cvt_pk_bf16_f32 v132, v136, v137
 v_cvt_pk_bf16_f32 v133, v138, v139
 v_cvt_pk_bf16_f32 v134, v140, v141
 v_cvt_pk_bf16_f32 v135, v142, v143
 v_mfma_f32_32x32x16_bf16 v[160:175], a[196:199], v[100:103], v[160:175]
 ds_read_b128 a[212:215], v8 offset:17824
 v_cvt_pk_bf16_f32 v144, v144, v145
 v_cvt_pk_bf16_f32 v145, v146, v147
 v_cvt_pk_bf16_f32 v146, v148, v149
 v_cvt_pk_bf16_f32 v147, v150, v151
 s_waitcnt lgkmcnt(2)
 v_mfma_f32_32x32x16_bf16 v[160:175], a[200:203], v[112:115], v[160:175]
 s_add_u32 m0, s33, 528
 ds_read_b128 a[216:219], v8 offset:17856
 buffer_load_dwordx4 v14, s[12:15], s29 offen offset:512 lds
 v_cvt_pk_bf16_f32 v148, v152, v153
 v_mfma_f32_32x32x16_bf16 v[160:175], a[204:207], v[116:119], v[160:175]
 ds_read_b128 a[220:223], v8 offset:17888
 v_cvt_pk_bf16_f32 v149, v154, v155
 v_cvt_pk_bf16_f32 v150, v156, v157
 v_cvt_pk_bf16_f32 v151, v158, v159
 v_accvgpr_write_b32 a128, v32
 s_waitcnt lgkmcnt(2)
 v_mfma_f32_32x32x16_bf16 v[160:175], a[208:211], v[128:131], v[160:175]
 ds_read_b128 a[192:195], v8 offset:34816
 v_accvgpr_write_b32 a129, v33
 v_accvgpr_write_b32 a130, v34
 v_accvgpr_write_b32 a131, v35
 v_accvgpr_write_b32 a132, v36
 v_mfma_f32_32x32x16_bf16 v[160:175], a[212:215], v[132:135], v[160:175]
 s_add_u32 m0, s33, 1056
 ds_read_b128 a[196:199], v8 offset:34848
 buffer_load_dwordx4 v14, s[12:15], s29 offen offset:1024 lds
 v_accvgpr_write_b32 a133, v37
 s_waitcnt lgkmcnt(2)
 v_mfma_f32_32x32x16_bf16 v[160:175], a[216:219], v[144:147], v[160:175]
 ds_read_b128 a[200:203], v8 offset:34880
 v_accvgpr_write_b32 a134, v38
 v_accvgpr_write_b32 a135, v39
 v_accvgpr_write_b32 a136, v48
 v_accvgpr_write_b32 a137, v49
 v_mfma_f32_32x32x16_bf16 v[160:175], a[220:223], v[148:151], v[160:175]
 ds_read_b128 a[204:207], v8 offset:34912
 v_accvgpr_write_b32 a138, v50
 v_accvgpr_write_b32 a139, v51
 v_accvgpr_write_b32 a140, v52
 v_accvgpr_write_b32 a141, v53
 s_waitcnt lgkmcnt(2)
 v_mfma_f32_32x32x16_bf16 v[176:191], a[192:195], v[32:35], 0
 s_add_u32 m0, s33, 1584
 ds_read_b128 a[208:211], v8 offset:34944
 buffer_load_dwordx4 v14, s[12:15], s29 offen offset:1536 lds
 v_accvgpr_write_b32 a142, v54
 v_mfma_f32_32x32x16_bf16 v[176:191], a[196:199], v[36:39], v[176:191]
 ds_read_b128 a[212:215], v8 offset:34976
 v_accvgpr_write_b32 a143, v55
 s_waitcnt lgkmcnt(2)
 v_mfma_f32_32x32x16_bf16 v[176:191], a[200:203], v[48:51], v[176:191]
 ds_read_b128 a[216:219], v8 offset:35008
 v_max3_f32 v20, v160, v161, v162
 v_max_f32 v20, v20, v163
 v_max3_f32 v20, v20, v164, v165
 v_max3_f32 v20, v20, v166, v167
 v_mfma_f32_32x32x16_bf16 v[176:191], a[204:207], v[52:55], v[176:191]
 s_add_u32 s29, s29, 16384
 s_add_u32 m0, s33, 17408
 ds_read_b128 a[220:223], v8 offset:35040
 buffer_load_dwordx4 v14, s[12:15], s29 offen offset:0 lds
 s_waitcnt lgkmcnt(2)
 v_mfma_f32_32x32x16_bf16 v[176:191], a[208:211], v[64:67], v[176:191]
 ds_read_b128 a[192:195], v8 offset:35072
 v_max3_f32 v20, v20, v168, v169
 v_max3_f32 v20, v20, v170, v171
 v_max3_f32 v20, v20, v172, v173
 v_max3_f32 v20, v20, v174, v175
 v_mfma_f32_32x32x16_bf16 v[176:191], a[212:215], v[68:71], v[176:191]
 ds_read_b128 a[196:199], v8 offset:35104
 v_accvgpr_write_b32 a144, v64
 v_accvgpr_write_b32 a145, v65
 v_accvgpr_write_b32 a146, v66
 v_accvgpr_write_b32 a147, v67
 s_waitcnt lgkmcnt(2)
 v_mfma_f32_32x32x16_bf16 v[176:191], a[216:219], v[80:83], v[176:191]
 s_add_u32 m0, s33, 17936
 ds_read_b128 a[200:203], v8 offset:35136
 buffer_load_dwordx4 v14, s[12:15], s29 offen offset:512 lds
 v_accvgpr_write_b32 a148, v68
 v_mfma_f32_32x32x16_bf16 v[176:191], a[220:223], v[84:87], v[176:191]
 ds_read_b128 a[204:207], v8 offset:35168
 v_accvgpr_write_b32 a149, v69
 v_accvgpr_write_b32 a150, v70
 v_accvgpr_write_b32 a151, v71
 v_accvgpr_write_b32 a152, v80
 s_waitcnt lgkmcnt(2)
 v_mfma_f32_32x32x16_bf16 v[176:191], a[192:195], v[96:99], v[176:191]
 ds_read_b128 a[208:211], v8 offset:35200
 ds_read_b128 a[212:215], v8 offset:35232
 v_accvgpr_write_b32 a153, v81
 v_accvgpr_write_b32 a154, v82
 v_accvgpr_write_b32 a155, v83
 v_mfma_f32_32x32x16_bf16 v[176:191], a[196:199], v[100:103], v[176:191]
 s_add_u32 m0, s33, 18464
 ds_read_b128 a[216:219], v8 offset:35264
 buffer_load_dwordx4 v14, s[12:15], s29 offen offset:1024 lds
 ds_read_b128 a[220:223], v8 offset:35296
 s_waitcnt lgkmcnt(4)
 v_mfma_f32_32x32x16_bf16 v[176:191], a[200:203], v[112:115], v[176:191]
 v_accvgpr_write_b32 a156, v84
 v_accvgpr_write_b32 a157, v85
 v_accvgpr_write_b32 a158, v86
 v_accvgpr_write_b32 a159, v87
 v_mfma_f32_32x32x16_bf16 v[176:191], a[204:207], v[116:119], v[176:191]
 s_waitcnt lgkmcnt(2)
 v_mfma_f32_32x32x16_bf16 v[176:191], a[208:211], v[128:131], v[176:191]
 s_waitcnt vmcnt(7) lgkmcnt(0)
 s_barrier
 s_add_u32 m0, s33, 18992
 ds_read_b128 a[192:195], v9 offset:0
 buffer_load_dwordx4 v14, s[12:15], s29 offen offset:1536 lds
 v_mfma_f32_32x32x16_bf16 v[176:191], a[212:215], v[132:135], v[176:191]
 ds_read_b128 a[196:199], v9 offset:32
 v_mfma_f32_32x32x16_bf16 v[176:191], a[216:219], v[144:147], v[176:191]
 ds_read_b128 a[200:203], v9 offset:64
 v_mfma_f32_32x32x16_bf16 v[176:191], a[220:223], v[148:151], v[176:191]
 s_add_u32 s29, s29, 16384
 s_add_u32 m0, s33, 34816
 ds_read_b128 a[204:207], v9 offset:96
 buffer_load_dwordx4 v14, s[12:15], s29 offen offset:0 lds
 s_waitcnt lgkmcnt(2)
 v_mfma_f32_32x32x16_bf16 v[192:207], a[192:195], v[32:35], 0
 ds_read_b128 a[208:211], v9 offset:128
 v_mfma_f32_32x32x16_bf16 v[192:207], a[196:199], v[36:39], v[192:207]
 ds_read_b128 a[212:215], v9 offset:160
 s_waitcnt lgkmcnt(2)
 v_mfma_f32_32x32x16_bf16 v[192:207], a[200:203], v[48:51], v[192:207]
 s_add_u32 m0, s33, 35344
 ds_read_b128 a[216:219], v9 offset:192
 buffer_load_dwordx4 v14, s[12:15], s29 offen offset:512 lds
 v_max3_f32 v20, v20, v176, v177
 v_mfma_f32_32x32x16_bf16 v[192:207], a[204:207], v[52:55], v[192:207]
 ds_read_b128 a[220:223], v9 offset:224
 v_max3_f32 v20, v20, v178, v179
 v_max3_f32 v20, v20, v180, v181
 v_max3_f32 v20, v20, v182, v183
 v_max3_f32 v20, v20, v184, v185
 s_waitcnt lgkmcnt(2)
 v_mfma_f32_32x32x16_bf16 v[192:207], a[208:211], v[64:67], v[192:207]
 ds_read_b128 a[192:195], v9 offset:256
 v_max3_f32 v20, v20, v186, v187
 v_max3_f32 v20, v20, v188, v189
 v_max3_f32 v20, v20, v190, v191
 v_accvgpr_write_b32 a160, v96
 v_mfma_f32_32x32x16_bf16 v[192:207], a[212:215], v[68:71], v[192:207]
 s_add_u32 m0, s33, 35872
 ds_read_b128 a[196:199], v9 offset:288
 buffer_load_dwordx4 v14, s[12:15], s29 offen offset:1024 lds
 v_accvgpr_write_b32 a161, v97
 s_waitcnt lgkmcnt(2)
 v_mfma_f32_32x32x16_bf16 v[192:207], a[216:219], v[80:83], v[192:207]
 ds_read_b128 a[200:203], v9 offset:320
 v_accvgpr_write_b32 a162, v98
 v_accvgpr_write_b32 a163, v99
 v_accvgpr_write_b32 a164, v100
 v_accvgpr_write_b32 a165, v101
 v_mfma_f32_32x32x16_bf16 v[192:207], a[220:223], v[84:87], v[192:207]
 ds_read_b128 a[204:207], v9 offset:352
 v_accvgpr_write_b32 a166, v102
 v_accvgpr_write_b32 a167, v103
 v_accvgpr_write_b32 a168, v112
 v_accvgpr_write_b32 a169, v113
 s_waitcnt lgkmcnt(2)
 v_mfma_f32_32x32x16_bf16 v[192:207], a[192:195], v[96:99], v[192:207]
 s_add_u32 m0, s33, 36400
 ds_read_b128 a[208:211], v9 offset:384
 buffer_load_dwordx4 v14, s[12:15], s29 offen offset:1536 lds
 v_accvgpr_write_b32 a170, v114
 v_mfma_f32_32x32x16_bf16 v[192:207], a[196:199], v[100:103], v[192:207]
 ds_read_b128 a[212:215], v9 offset:416
 v_accvgpr_write_b32 a171, v115
 v_accvgpr_write_b32 a172, v116
 v_accvgpr_write_b32 a173, v117
 v_accvgpr_write_b32 a174, v118
 s_waitcnt lgkmcnt(2)
 v_mfma_f32_32x32x16_bf16 v[192:207], a[200:203], v[112:115], v[192:207]
 s_load_dwordx2 s[52:53], s[0:1], 56
 s_mov_b32 s54, 8388608
 s_mov_b32 s55, 0x00020000
 s_mov_b32 s56, 0
 ds_read_b128 a[216:219], v9 offset:448
 v_mfma_f32_32x32x16_bf16 v[192:207], a[204:207], v[116:119], v[192:207]
 s_add_u32 s29, s29, 16384
 s_add_u32 m0, s33, 52224
 ds_read_b128 a[220:223], v9 offset:480
 buffer_load_dwordx4 v14, s[12:15], s29 offen offset:0 lds
 s_waitcnt lgkmcnt(0)
 v_mfma_f32_32x32x16_bf16 v[192:207], a[208:211], v[128:131], v[192:207]
 ds_read_b128 a[192:195], v9 offset:17408
 v_accvgpr_write_b32 a175, v119
 v_mfma_f32_32x32x16_bf16 v[192:207], a[212:215], v[132:135], v[192:207]
 ds_read_b128 a[196:199], v9 offset:17440
 v_mfma_f32_32x32x16_bf16 v[192:207], a[216:219], v[144:147], v[192:207]
 s_add_u32 m0, s33, 52752
 ds_read_b128 a[200:203], v9 offset:17472
 buffer_load_dwordx4 v14, s[12:15], s29 offen offset:512 lds
 v_mfma_f32_32x32x16_bf16 v[192:207], a[220:223], v[148:151], v[192:207]
 ds_read_b128 a[204:207], v9 offset:17504
 s_waitcnt lgkmcnt(2)
 v_mfma_f32_32x32x16_bf16 v[208:223], a[192:195], v[32:35], 0
 ds_read_b128 a[208:211], v9 offset:17536
 v_mfma_f32_32x32x16_bf16 v[208:223], a[196:199], v[36:39], v[208:223]
 s_add_u32 m0, s33, 53280
 ds_read_b128 a[212:215], v9 offset:17568
 buffer_load_dwordx4 v14, s[12:15], s29 offen offset:1024 lds
 s_waitcnt lgkmcnt(2)
 v_mfma_f32_32x32x16_bf16 v[208:223], a[200:203], v[48:51], v[208:223]
 buffer_load_dword a113, v24, s[52:55], s56 offen
 ds_read_b128 a[216:219], v9 offset:17600
 v_max3_f32 v20, v20, v192, v193
 v_max3_f32 v20, v20, v194, v195
 v_max3_f32 v20, v20, v196, v197
 v_mfma_f32_32x32x16_bf16 v[208:223], a[204:207], v[52:55], v[208:223]
 ds_read_b128 a[220:223], v9 offset:17632
 v_max3_f32 v20, v20, v198, v199
 v_max3_f32 v20, v20, v200, v201
 v_max3_f32 v20, v20, v202, v203
 v_max3_f32 v20, v20, v204, v205
 s_waitcnt lgkmcnt(2)
 v_mfma_f32_32x32x16_bf16 v[208:223], a[208:211], v[64:67], v[208:223]
 s_add_u32 m0, s33, 53808
 ds_read_b128 a[192:195], v9 offset:17664
 buffer_load_dwordx4 v14, s[12:15], s29 offen offset:1536 lds
 v_max3_f32 v20, v20, v206, v207
 v_mfma_f32_32x32x16_bf16 v[208:223], a[212:215], v[68:71], v[208:223]
 ds_read_b128 a[196:199], v9 offset:17696
 v_accvgpr_write_b32 a176, v128
 v_accvgpr_write_b32 a177, v129
 v_accvgpr_write_b32 a178, v130
 v_accvgpr_write_b32 a179, v131
 s_waitcnt lgkmcnt(2)
 v_mfma_f32_32x32x16_bf16 v[208:223], a[216:219], v[80:83], v[208:223]
 s_load_dwordx2 s[52:53], s[0:1], 56
 s_mov_b32 s54, 8388608
 s_mov_b32 s55, 0x00020000
 s_mov_b32 s56, 4194304
 ds_read_b128 a[200:203], v9 offset:17728
 v_mfma_f32_32x32x16_bf16 v[208:223], a[220:223], v[84:87], v[208:223]
 s_add_u32 s29, s29, 16384
 s_add_u32 m0, s33, 69632
 ds_read_b128 a[204:207], v9 offset:17760
 buffer_load_dwordx4 v14, s[12:15], s29 offen offset:0 lds
 s_waitcnt lgkmcnt(0)
 v_mfma_f32_32x32x16_bf16 v[208:223], a[192:195], v[96:99], v[208:223]
 ds_read_b128 a[208:211], v9 offset:17792
 ds_read_b128 a[212:215], v9 offset:17824
 v_accvgpr_write_b32 a180, v132
 v_accvgpr_write_b32 a181, v133
 v_accvgpr_write_b32 a182, v134
 v_mfma_f32_32x32x16_bf16 v[208:223], a[196:199], v[100:103], v[208:223]
 ds_read_b128 a[216:219], v9 offset:17856
 ds_read_b128 a[220:223], v9 offset:17888
 v_accvgpr_write_b32 a183, v135
 v_accvgpr_write_b32 a184, v144
 v_accvgpr_write_b32 a185, v145
 v_mfma_f32_32x32x16_bf16 v[208:223], a[200:203], v[112:115], v[208:223]
 s_add_u32 m0, s33, 70160
 s_nop 0
 buffer_load_dwordx4 v14, s[12:15], s29 offen offset:512 lds
 v_accvgpr_write_b32 a186, v146
 v_accvgpr_write_b32 a187, v147
 v_mfma_f32_32x32x16_bf16 v[208:223], a[204:207], v[116:119], v[208:223]
 v_accvgpr_write_b32 a188, v148
 v_accvgpr_write_b32 a189, v149
 v_accvgpr_write_b32 a190, v150
 v_accvgpr_write_b32 a191, v151
 s_waitcnt lgkmcnt(2)
 v_mfma_f32_32x32x16_bf16 v[208:223], a[208:211], v[128:131], v[208:223]
 s_waitcnt vmcnt(11) lgkmcnt(0)
 s_barrier
 ds_read_b128 a[192:195], v7 offset:0
 v_mfma_f32_32x32x16_bf16 v[208:223], a[212:215], v[132:135], v[208:223]
 s_add_u32 m0, s33, 70688
 ds_read_b128 a[196:199], v7 offset:32
 buffer_load_dwordx4 v14, s[12:15], s29 offen offset:1024 lds
 v_mfma_f32_32x32x16_bf16 v[208:223], a[216:219], v[144:147], v[208:223]
 buffer_load_dword a115, v24, s[52:55], s56 offen
 ds_read_b128 a[200:203], v7 offset:64
 v_mfma_f32_32x32x16_bf16 v[208:223], a[220:223], v[148:151], v[208:223]
 ds_read_b128 a[204:207], v7 offset:96
 s_waitcnt lgkmcnt(2)
 v_mfma_f32_32x32x16_bf16 v[224:239], a[192:195], v[32:35], 0
 s_add_u32 m0, s33, 71216
 ds_read_b128 a[208:211], v7 offset:128
 buffer_load_dwordx4 v14, s[12:15], s29 offen offset:1536 lds
 v_mfma_f32_32x32x16_bf16 v[224:239], a[196:199], v[36:39], v[224:239]
 ds_read_b128 a[212:215], v7 offset:160
 s_waitcnt lgkmcnt(2)
 v_mfma_f32_32x32x16_bf16 v[224:239], a[200:203], v[48:51], v[224:239]
 s_load_dwordx2 s[52:53], s[0:1], 72
 s_mov_b32 s54, 802816
 s_mov_b32 s55, 0x00020000
 s_mov_b32 s56, 0
 ds_read_b128 a[216:219], v7 offset:192
 v_mfma_f32_32x32x16_bf16 v[224:239], a[204:207], v[52:55], v[224:239]
 s_add_u32 s29, s29, 16384
 s_add_u32 m0, s33, 87040
 ds_read_b128 a[220:223], v7 offset:224
 buffer_load_dwordx4 v14, s[12:15], s29 offen offset:0 lds
 s_waitcnt lgkmcnt(0)
 v_mfma_f32_32x32x16_bf16 v[224:239], a[208:211], v[64:67], v[224:239]
 ds_read_b128 a[192:195], v7 offset:256
 v_max3_f32 v20, v20, v208, v209
 v_max3_f32 v20, v20, v210, v211
 v_max3_f32 v20, v20, v212, v213
 v_max3_f32 v20, v20, v214, v215
 v_mfma_f32_32x32x16_bf16 v[224:239], a[212:215], v[68:71], v[224:239]
 ds_read_b128 a[196:199], v7 offset:288
 v_max3_f32 v20, v20, v216, v217
 v_max3_f32 v20, v20, v218, v219
 v_max3_f32 v20, v20, v220, v221
 v_max3_f32 v20, v20, v222, v223
 v_mfma_f32_32x32x16_bf16 v[224:239], a[216:219], v[80:83], v[224:239]
 s_add_u32 m0, s33, 87568
 ds_read_b128 a[200:203], v7 offset:320
 buffer_load_dwordx4 v14, s[12:15], s29 offen offset:512 lds
 v_mfma_f32_32x32x16_bf16 v[224:239], a[220:223], v[84:87], v[224:239]
 ds_read_b128 a[204:207], v7 offset:352
 s_waitcnt lgkmcnt(2)
 v_mfma_f32_32x32x16_bf16 v[224:239], a[192:195], v[96:99], v[224:239]
 ds_read_b128 a[208:211], v7 offset:384
 v_mfma_f32_32x32x16_bf16 v[224:239], a[196:199], v[100:103], v[224:239]
 s_add_u32 m0, s33, 88096
 ds_read_b128 a[212:215], v7 offset:416
 buffer_load_dwordx4 v14, s[12:15], s29 offen offset:1024 lds
 s_waitcnt lgkmcnt(2)
 v_mfma_f32_32x32x16_bf16 v[224:239], a[200:203], v[112:115], v[224:239]
 buffer_load_dword a117, v24, s[52:55], s56 offen
 ds_read_b128 a[216:219], v7 offset:448
 v_mfma_f32_32x32x16_bf16 v[224:239], a[204:207], v[116:119], v[224:239]
 ds_read_b128 a[220:223], v7 offset:480
 s_waitcnt lgkmcnt(2)
 v_mfma_f32_32x32x16_bf16 v[224:239], a[208:211], v[128:131], v[224:239]
 s_add_u32 m0, s33, 88624
 ds_read_b128 a[192:195], v7 offset:17408
 buffer_load_dwordx4 v14, s[12:15], s29 offen offset:1536 lds
 v_mfma_f32_32x32x16_bf16 v[224:239], a[212:215], v[132:135], v[224:239]
 ds_read_b128 a[196:199], v7 offset:17440
 s_waitcnt lgkmcnt(2)
 v_mfma_f32_32x32x16_bf16 v[224:239], a[216:219], v[144:147], v[224:239]
 ds_read_b128 a[200:203], v7 offset:17472
 v_mfma_f32_32x32x16_bf16 v[224:239], a[220:223], v[148:151], v[224:239]
 s_add_u32 s29, s29, 16384
 s_add_u32 m0, s33, 104448
 ds_read_b128 a[204:207], v7 offset:17504
 buffer_load_dwordx4 v14, s[12:15], s29 offen offset:0 lds
 s_waitcnt lgkmcnt(2)
 v_mfma_f32_32x32x16_bf16 v[240:255], a[192:195], a[128:131], 0
 ds_read_b128 a[208:211], v7 offset:17536
 v_mfma_f32_32x32x16_bf16 v[240:255], a[196:199], a[132:135], v[240:255]
 ds_read_b128 a[212:215], v7 offset:17568
 s_waitcnt lgkmcnt(2)
 v_mfma_f32_32x32x16_bf16 v[240:255], a[200:203], a[136:139], v[240:255]
 s_add_u32 m0, s33, 104976
 ds_read_b128 a[216:219], v7 offset:17600
 buffer_load_dwordx4 v14, s[12:15], s29 offen offset:512 lds
 v_max3_f32 v20, v20, v224, v225
 v_mfma_f32_32x32x16_bf16 v[240:255], a[204:207], a[140:143], v[240:255]
 ds_read_b128 a[220:223], v7 offset:17632
 v_max3_f32 v20, v20, v226, v227
 v_max3_f32 v20, v20, v228, v229
 v_max3_f32 v20, v20, v230, v231
 v_max3_f32 v20, v20, v232, v233
 s_waitcnt lgkmcnt(2)
 v_mfma_f32_32x32x16_bf16 v[240:255], a[208:211], a[144:147], v[240:255]
 ds_read_b128 a[192:195], v7 offset:17664
 v_max3_f32 v20, v20, v234, v235
 v_max3_f32 v20, v20, v236, v237
 v_max3_f32 v20, v20, v238, v239
 v_mfma_f32_32x32x16_bf16 v[240:255], a[212:215], a[148:151], v[240:255]
 s_add_u32 m0, s33, 105504
 ds_read_b128 a[196:199], v7 offset:17696
 buffer_load_dwordx4 v14, s[12:15], s29 offen offset:1024 lds
 s_waitcnt lgkmcnt(2)
 v_mfma_f32_32x32x16_bf16 v[240:255], a[216:219], a[152:155], v[240:255]
 ds_read_b128 a[200:203], v7 offset:17728
 v_mfma_f32_32x32x16_bf16 v[240:255], a[220:223], a[156:159], v[240:255]
 ds_read_b128 a[204:207], v7 offset:17760
 s_waitcnt lgkmcnt(2)
 v_mfma_f32_32x32x16_bf16 v[240:255], a[192:195], a[160:163], v[240:255]
 s_add_u32 m0, s33, 106032
 ds_read_b128 a[208:211], v7 offset:17792
 buffer_load_dwordx4 v14, s[12:15], s29 offen offset:1536 lds
 ds_read_b128 a[212:215], v7 offset:17824
 v_mfma_f32_32x32x16_bf16 v[240:255], a[196:199], a[164:167], v[240:255]
 ds_read_b128 a[216:219], v7 offset:17856
 ds_read_b128 a[220:223], v7 offset:17888
 s_waitcnt lgkmcnt(4)
 v_mfma_f32_32x32x16_bf16 v[240:255], a[200:203], a[168:171], v[240:255]
 v_mfma_f32_32x32x16_bf16 v[240:255], a[204:207], a[172:175], v[240:255]
 s_add_u32 s29, s29, 16384
 s_add_u32 m0, s33, 121856
 s_nop 0
 buffer_load_dwordx4 v14, s[12:15], s29 offen offset:0 lds
 s_waitcnt lgkmcnt(2)
 v_mfma_f32_32x32x16_bf16 v[240:255], a[208:211], a[176:179], v[240:255]
 s_waitcnt vmcnt(15) lgkmcnt(0)
 s_barrier
 ds_read_b128 a[192:195], v7 offset:34816
 v_mfma_f32_32x32x16_bf16 v[240:255], a[212:215], a[180:183], v[240:255]
 ds_read_b128 a[196:199], v7 offset:34848
 v_mfma_f32_32x32x16_bf16 v[240:255], a[216:219], a[184:187], v[240:255]
 s_add_u32 m0, s33, 122384
 ds_read_b128 a[200:203], v7 offset:34880
 buffer_load_dwordx4 v14, s[12:15], s29 offen offset:512 lds
 v_mfma_f32_32x32x16_bf16 v[240:255], a[220:223], a[188:191], v[240:255]
 ds_read_b128 a[204:207], v7 offset:34912
 s_waitcnt lgkmcnt(2)
 v_mfma_f32_32x32x16_bf16 a[224:239], a[192:195], a[128:131], 0
 ds_read_b128 a[208:211], v7 offset:34944
 v_mfma_f32_32x32x16_bf16 a[224:239], a[196:199], a[132:135], a[224:239]
 s_add_u32 m0, s33, 122912
 ds_read_b128 a[212:215], v7 offset:34976
 buffer_load_dwordx4 v14, s[12:15], s29 offen offset:1024 lds
 s_waitcnt lgkmcnt(2)
 v_mfma_f32_32x32x16_bf16 a[224:239], a[200:203], a[136:139], a[224:239]
 ds_read_b128 a[216:219], v7 offset:35008
 s_nop 0
 v_max3_f32 v20, v20, v240, v241
 v_max3_f32 v20, v20, v242, v243
 v_max3_f32 v20, v20, v244, v245
 v_max3_f32 v20, v20, v246, v247
 v_mfma_f32_32x32x16_bf16 a[224:239], a[204:207], a[140:143], a[224:239]
 ds_read_b128 a[220:223], v7 offset:35040
 v_max3_f32 v20, v20, v248, v249
 v_max3_f32 v20, v20, v250, v251
 v_max3_f32 v20, v20, v252, v253
 v_max3_f32 v20, v20, v254, v255
 s_waitcnt lgkmcnt(2)
 v_mfma_f32_32x32x16_bf16 a[224:239], a[208:211], a[144:147], a[224:239]
 s_add_u32 m0, s33, 123440
 ds_read_b128 a[192:195], v7 offset:35072
 buffer_load_dwordx4 v14, s[12:15], s29 offen offset:1536 lds
 v_mfma_f32_32x32x16_bf16 a[224:239], a[212:215], a[148:151], a[224:239]
 ds_read_b128 a[196:199], v7 offset:35104
 s_waitcnt lgkmcnt(2)
 v_mfma_f32_32x32x16_bf16 a[224:239], a[216:219], a[152:155], a[224:239]
 ds_read_b128 a[200:203], v7 offset:35136
 v_mfma_f32_32x32x16_bf16 a[224:239], a[220:223], a[156:159], a[224:239]
 s_add_u32 s29, s29, 16384
 s_add_u32 m0, s33, 0
 ds_read_b128 a[204:207], v7 offset:35168
 buffer_load_dwordx4 v14, s[12:15], s29 offen offset:0 lds
 s_waitcnt lgkmcnt(2)
 v_mfma_f32_32x32x16_bf16 a[224:239], a[192:195], a[160:163], a[224:239]
 ds_read_b128 a[208:211], v7 offset:35200
 v_mfma_f32_32x32x16_bf16 a[224:239], a[196:199], a[164:167], a[224:239]
 ds_read_b128 a[212:215], v7 offset:35232
 s_waitcnt lgkmcnt(2)
 v_mfma_f32_32x32x16_bf16 a[224:239], a[200:203], a[168:171], a[224:239]
 s_add_u32 m0, s33, 528
 ds_read_b128 a[216:219], v7 offset:35264
 buffer_load_dwordx4 v14, s[12:15], s29 offen offset:512 lds
 v_mfma_f32_32x32x16_bf16 a[224:239], a[204:207], a[172:175], a[224:239]
 ds_read_b128 a[220:223], v7 offset:35296
 s_waitcnt lgkmcnt(2)
 v_mfma_f32_32x32x16_bf16 a[224:239], a[208:211], a[176:179], a[224:239]
 ds_read_b128 a[192:195], v8 offset:0
 v_mfma_f32_32x32x16_bf16 a[224:239], a[212:215], a[180:183], a[224:239]
 s_add_u32 m0, s33, 1056
 ds_read_b128 a[196:199], v8 offset:32
 buffer_load_dwordx4 v14, s[12:15], s29 offen offset:1024 lds
 s_waitcnt lgkmcnt(2)
 v_mfma_f32_32x32x16_bf16 a[224:239], a[216:219], a[184:187], a[224:239]
 ds_read_b128 a[200:203], v8 offset:64
 v_mfma_f32_32x32x16_bf16 a[224:239], a[220:223], a[188:191], a[224:239]
 ds_read_b128 a[204:207], v8 offset:96
 s_waitcnt lgkmcnt(2)
 v_mfma_f32_32x32x16_bf16 a[240:255], a[192:195], a[128:131], 0
 s_add_u32 m0, s33, 1584
 ds_read_b128 a[208:211], v8 offset:128
 buffer_load_dwordx4 v14, s[12:15], s29 offen offset:1536 lds
 v_mfma_f32_32x32x16_bf16 a[240:255], a[196:199], a[132:135], a[240:255]
 ds_read_b128 a[212:215], v8 offset:160
 s_waitcnt lgkmcnt(2)
 v_mfma_f32_32x32x16_bf16 a[240:255], a[200:203], a[136:139], a[240:255]
 ds_read_b128 a[216:219], v8 offset:192
 s_nop 0
 v_accvgpr_read_b32 v27, a224
 v_accvgpr_read_b32 v28, a225
 v_max3_f32 v20, v20, v27, v28
 v_accvgpr_read_b32 v27, a226
 v_mfma_f32_32x32x16_bf16 a[240:255], a[204:207], a[140:143], a[240:255]
 s_add_u32 s29, s29, 16384
 s_add_u32 m0, s33, 17408
 ds_read_b128 a[220:223], v8 offset:224
 buffer_load_dwordx4 v14, s[12:15], s29 offen offset:0 lds
 s_waitcnt lgkmcnt(2)
 v_mfma_f32_32x32x16_bf16 a[240:255], a[208:211], a[144:147], a[240:255]
 ds_read_b128 a[192:195], v8 offset:256
 v_accvgpr_read_b32 v28, a227
 v_max3_f32 v20, v20, v27, v28
 v_accvgpr_read_b32 v27, a228
 v_accvgpr_read_b32 v28, a229
 v_mfma_f32_32x32x16_bf16 a[240:255], a[212:215], a[148:151], a[240:255]
 ds_read_b128 a[196:199], v8 offset:288
 v_max3_f32 v20, v20, v27, v28
 v_accvgpr_read_b32 v27, a230
 v_accvgpr_read_b32 v28, a231
 v_max3_f32 v20, v20, v27, v28
 s_waitcnt lgkmcnt(2)
 v_mfma_f32_32x32x16_bf16 a[240:255], a[216:219], a[152:155], a[240:255]
 s_add_u32 m0, s33, 17936
 ds_read_b128 a[200:203], v8 offset:320
 buffer_load_dwordx4 v14, s[12:15], s29 offen offset:512 lds
 v_accvgpr_read_b32 v27, a232
 v_mfma_f32_32x32x16_bf16 a[240:255], a[220:223], a[156:159], a[240:255]
 ds_read_b128 a[204:207], v8 offset:352
 v_accvgpr_read_b32 v28, a233
 v_max3_f32 v20, v20, v27, v28
 v_accvgpr_read_b32 v27, a234
 v_accvgpr_read_b32 v28, a235
 s_waitcnt lgkmcnt(2)
 v_mfma_f32_32x32x16_bf16 a[240:255], a[192:195], a[160:163], a[240:255]
 ds_read_b128 a[208:211], v8 offset:384
 ds_read_b128 a[212:215], v8 offset:416
 v_max3_f32 v20, v20, v27, v28
 v_accvgpr_read_b32 v27, a236
 v_accvgpr_read_b32 v28, a237
 v_mfma_f32_32x32x16_bf16 a[240:255], a[196:199], a[164:167], a[240:255]
 s_add_u32 m0, s33, 18464
 ds_read_b128 a[216:219], v8 offset:448
 buffer_load_dwordx4 v14, s[12:15], s29 offen offset:1024 lds
 ds_read_b128 a[220:223], v8 offset:480
 s_waitcnt lgkmcnt(4)
 v_mfma_f32_32x32x16_bf16 a[240:255], a[200:203], a[168:171], a[240:255]
 v_max3_f32 v20, v20, v27, v28
 v_accvgpr_read_b32 v27, a238
 v_accvgpr_read_b32 v28, a239
 v_max3_f32 v20, v20, v27, v28
 v_mfma_f32_32x32x16_bf16 a[240:255], a[204:207], a[172:175], a[240:255]
 s_waitcnt lgkmcnt(2)
 v_mfma_f32_32x32x16_bf16 a[240:255], a[208:211], a[176:179], a[240:255]
 s_waitcnt vmcnt(15) lgkmcnt(0)
 s_barrier
 s_add_u32 m0, s33, 18992
 ds_read_b128 a[192:195], v8 offset:17408
 buffer_load_dwordx4 v14, s[12:15], s29 offen offset:1536 lds
 v_mfma_f32_32x32x16_bf16 a[240:255], a[212:215], a[180:183], a[240:255]
 ds_read_b128 a[196:199], v8 offset:17440
 v_mfma_f32_32x32x16_bf16 a[240:255], a[216:219], a[184:187], a[240:255]
 ds_read_b128 a[200:203], v8 offset:17472
 v_mfma_f32_32x32x16_bf16 a[240:255], a[220:223], a[188:191], a[240:255]
 s_add_u32 s29, s29, 16384
 s_add_u32 m0, s33, 34816
 ds_read_b128 a[204:207], v8 offset:17504
 buffer_load_dwordx4 v14, s[12:15], s29 offen offset:0 lds
 s_waitcnt lgkmcnt(2)
 v_mfma_f32_32x32x16_bf16 v[32:47], a[192:195], a[128:131], 0
 ds_read_b128 a[208:211], v8 offset:17536
 v_mfma_f32_32x32x16_bf16 v[32:47], a[196:199], a[132:135], v[32:47]
 ds_read_b128 a[212:215], v8 offset:17568
 s_waitcnt lgkmcnt(2)
 v_mfma_f32_32x32x16_bf16 v[32:47], a[200:203], a[136:139], v[32:47]
 s_add_u32 m0, s33, 35344
 ds_read_b128 a[216:219], v8 offset:17600
 buffer_load_dwordx4 v14, s[12:15], s29 offen offset:512 lds
 v_accvgpr_read_b32 v27, a240
 v_mfma_f32_32x32x16_bf16 v[32:47], a[204:207], a[140:143], v[32:47]
 ds_read_b128 a[220:223], v8 offset:17632
 v_accvgpr_read_b32 v28, a241
 v_max3_f32 v20, v20, v27, v28
 v_accvgpr_read_b32 v27, a242
 v_accvgpr_read_b32 v28, a243
 s_waitcnt lgkmcnt(2)
 v_mfma_f32_32x32x16_bf16 v[32:47], a[208:211], a[144:147], v[32:47]
 ds_read_b128 a[192:195], v8 offset:17664
 v_max3_f32 v20, v20, v27, v28
 v_accvgpr_read_b32 v27, a244
 v_accvgpr_read_b32 v28, a245
 v_max3_f32 v20, v20, v27, v28
 v_mfma_f32_32x32x16_bf16 v[32:47], a[212:215], a[148:151], v[32:47]
 s_add_u32 m0, s33, 35872
 ds_read_b128 a[196:199], v8 offset:17696
 buffer_load_dwordx4 v14, s[12:15], s29 offen offset:1024 lds
 v_accvgpr_read_b32 v27, a246
 s_waitcnt lgkmcnt(2)
 v_mfma_f32_32x32x16_bf16 v[32:47], a[216:219], a[152:155], v[32:47]
 ds_read_b128 a[200:203], v8 offset:17728
 v_accvgpr_read_b32 v28, a247
 v_max3_f32 v20, v20, v27, v28
 v_accvgpr_read_b32 v27, a248
 v_accvgpr_read_b32 v28, a249
 v_mfma_f32_32x32x16_bf16 v[32:47], a[220:223], a[156:159], v[32:47]
 ds_read_b128 a[204:207], v8 offset:17760
 v_max3_f32 v20, v20, v27, v28
 v_accvgpr_read_b32 v27, a250
 v_accvgpr_read_b32 v28, a251
 v_max3_f32 v20, v20, v27, v28
 s_waitcnt lgkmcnt(2)
 v_mfma_f32_32x32x16_bf16 v[32:47], a[192:195], a[160:163], v[32:47]
 s_add_u32 m0, s33, 36400
 ds_read_b128 a[208:211], v8 offset:17792
 buffer_load_dwordx4 v14, s[12:15], s29 offen offset:1536 lds
 v_accvgpr_read_b32 v27, a252
 v_mfma_f32_32x32x16_bf16 v[32:47], a[196:199], a[164:167], v[32:47]
 ds_read_b128 a[212:215], v8 offset:17824
 v_accvgpr_read_b32 v28, a253
 v_max3_f32 v20, v20, v27, v28
 v_accvgpr_read_b32 v27, a254
 v_accvgpr_read_b32 v28, a255
 s_waitcnt lgkmcnt(2)
 v_mfma_f32_32x32x16_bf16 v[32:47], a[200:203], a[168:171], v[32:47]
 ds_read_b128 a[216:219], v8 offset:17856
 v_max3_f32 v20, v20, v27, v28
 v_mfma_f32_32x32x16_bf16 v[32:47], a[204:207], a[172:175], v[32:47]
 s_add_u32 s29, s29, 16384
 s_add_u32 m0, s33, 52224
 ds_read_b128 a[220:223], v8 offset:17888
 buffer_load_dwordx4 v14, s[12:15], s29 offen offset:0 lds
 s_waitcnt lgkmcnt(2)
 v_mfma_f32_32x32x16_bf16 v[32:47], a[208:211], a[176:179], v[32:47]
 ds_read_b128 a[192:195], v8 offset:34816
 v_mfma_f32_32x32x16_bf16 v[32:47], a[212:215], a[180:183], v[32:47]
 ds_read_b128 a[196:199], v8 offset:34848
 s_waitcnt lgkmcnt(2)
 v_mfma_f32_32x32x16_bf16 v[32:47], a[216:219], a[184:187], v[32:47]
 s_add_u32 m0, s33, 52752
 ds_read_b128 a[200:203], v8 offset:34880
 buffer_load_dwordx4 v14, s[12:15], s29 offen offset:512 lds
 v_mfma_f32_32x32x16_bf16 v[32:47], a[220:223], a[188:191], v[32:47]
 ds_read_b128 a[204:207], v8 offset:34912
 s_waitcnt lgkmcnt(2)
 v_mfma_f32_32x32x16_bf16 v[48:63], a[192:195], a[128:131], 0
 ds_read_b128 a[208:211], v8 offset:34944
 v_mfma_f32_32x32x16_bf16 v[48:63], a[196:199], a[132:135], v[48:63]
 s_add_u32 m0, s33, 53280
 ds_read_b128 a[212:215], v8 offset:34976
 buffer_load_dwordx4 v14, s[12:15], s29 offen offset:1024 lds
 s_waitcnt lgkmcnt(2)
 v_mfma_f32_32x32x16_bf16 v[48:63], a[200:203], a[136:139], v[48:63]
 ds_read_b128 a[216:219], v8 offset:35008
 s_nop 0
 v_max3_f32 v20, v20, v32, v33
 v_max3_f32 v20, v20, v34, v35
 v_max3_f32 v20, v20, v36, v37
 v_max3_f32 v20, v20, v38, v39
 v_mfma_f32_32x32x16_bf16 v[48:63], a[204:207], a[140:143], v[48:63]
 ds_read_b128 a[220:223], v8 offset:35040
 v_max3_f32 v20, v20, v40, v41
 v_max3_f32 v20, v20, v42, v43
 v_max3_f32 v20, v20, v44, v45
 v_max3_f32 v20, v20, v46, v47
 s_waitcnt lgkmcnt(2)
 v_mfma_f32_32x32x16_bf16 v[48:63], a[208:211], a[144:147], v[48:63]
 s_add_u32 m0, s33, 53808
 ds_read_b128 a[192:195], v8 offset:35072
 buffer_load_dwordx4 v14, s[12:15], s29 offen offset:1536 lds
 v_mfma_f32_32x32x16_bf16 v[48:63], a[212:215], a[148:151], v[48:63]
 ds_read_b128 a[196:199], v8 offset:35104
 s_waitcnt lgkmcnt(2)
 v_mfma_f32_32x32x16_bf16 v[48:63], a[216:219], a[152:155], v[48:63]
 ds_read_b128 a[200:203], v8 offset:35136
 v_mfma_f32_32x32x16_bf16 v[48:63], a[220:223], a[156:159], v[48:63]
 ds_read_b128 a[204:207], v8 offset:35168
 s_waitcnt lgkmcnt(2)
 v_mfma_f32_32x32x16_bf16 v[48:63], a[192:195], a[160:163], v[48:63]
 ds_read_b128 a[208:211], v8 offset:35200
 ds_read_b128 a[212:215], v8 offset:35232
 v_mfma_f32_32x32x16_bf16 v[48:63], a[196:199], a[164:167], v[48:63]
 ds_read_b128 a[216:219], v8 offset:35264
 ds_read_b128 a[220:223], v8 offset:35296
 s_waitcnt lgkmcnt(4)
 v_mfma_f32_32x32x16_bf16 v[48:63], a[200:203], a[168:171], v[48:63]
 v_mfma_f32_32x32x16_bf16 v[48:63], a[204:207], a[172:175], v[48:63]
 s_waitcnt lgkmcnt(2)
 v_mfma_f32_32x32x16_bf16 v[48:63], a[208:211], a[176:179], v[48:63]
 s_waitcnt vmcnt(16) lgkmcnt(0)
 s_barrier
 s_add_u32 m0, s32, 69632
 ds_read_b128 a[192:195], v9 offset:0
 buffer_load_dwordx4 v15, s[16:19], s30 offen offset:0 lds
 v_mfma_f32_32x32x16_bf16 v[48:63], a[212:215], a[180:183], v[48:63]
 ds_read_b128 a[196:199], v9 offset:32
 v_mfma_f32_32x32x16_bf16 v[48:63], a[216:219], a[184:187], v[48:63]
 ds_read_b128 a[200:203], v9 offset:64
 v_mfma_f32_32x32x16_bf16 v[48:63], a[220:223], a[188:191], v[48:63]
 s_add_u32 m0, s32, 70208
 ds_read_b128 a[204:207], v9 offset:96
 buffer_load_dwordx4 v15, s[16:19], s30 offen offset:512 lds
 s_waitcnt lgkmcnt(2)
 v_mfma_f32_32x32x16_bf16 v[64:79], a[192:195], a[128:131], 0
 ds_read_b128 a[208:211], v9 offset:128
 v_mfma_f32_32x32x16_bf16 v[64:79], a[196:199], a[132:135], v[64:79]
 ds_read_b128 a[212:215], v9 offset:160
 s_waitcnt lgkmcnt(2)
 v_mfma_f32_32x32x16_bf16 v[64:79], a[200:203], a[136:139], v[64:79]
 s_add_u32 m0, s32, 70784
 ds_read_b128 a[216:219], v9 offset:192
 buffer_load_dwordx4 v15, s[16:19], s30 offen offset:1024 lds
 v_max3_f32 v20, v20, v48, v49
 v_mfma_f32_32x32x16_bf16 v[64:79], a[204:207], a[140:143], v[64:79]
 ds_read_b128 a[220:223], v9 offset:224
 v_max3_f32 v20, v20, v50, v51
 v_max3_f32 v20, v20, v52, v53
 v_max3_f32 v20, v20, v54, v55
 v_max3_f32 v20, v20, v56, v57
 s_waitcnt lgkmcnt(2)
 v_mfma_f32_32x32x16_bf16 v[64:79], a[208:211], a[144:147], v[64:79]
 ds_read_b128 a[192:195], v9 offset:256
 v_max3_f32 v20, v20, v58, v59
 v_max3_f32 v20, v20, v60, v61
 v_max3_f32 v20, v20, v62, v63
 v_mfma_f32_32x32x16_bf16 v[64:79], a[212:215], a[148:151], v[64:79]
 s_add_u32 m0, s32, 71360
 ds_read_b128 a[196:199], v9 offset:288
 buffer_load_dwordx4 v15, s[16:19], s30 offen offset:1536 lds
 s_waitcnt lgkmcnt(2)
 v_mfma_f32_32x32x16_bf16 v[64:79], a[216:219], a[152:155], v[64:79]
 ds_read_b128 a[200:203], v9 offset:320
 v_mfma_f32_32x32x16_bf16 v[64:79], a[220:223], a[156:159], v[64:79]
 ds_read_b128 a[204:207], v9 offset:352
 s_waitcnt lgkmcnt(2)
 v_mfma_f32_32x32x16_bf16 v[64:79], a[192:195], a[160:163], v[64:79]
 s_add_u32 s30, s30, 16384
 s_add_u32 m0, s32, 87040
 ds_read_b128 a[208:211], v9 offset:384
 buffer_load_dwordx4 v15, s[16:19], s30 offen offset:0 lds
 v_mfma_f32_32x32x16_bf16 v[64:79], a[196:199], a[164:167], v[64:79]
 ds_read_b128 a[212:215], v9 offset:416
 s_waitcnt lgkmcnt(2)
 v_mfma_f32_32x32x16_bf16 v[64:79], a[200:203], a[168:171], v[64:79]
 ds_read_b128 a[216:219], v9 offset:448
 v_mfma_f32_32x32x16_bf16 v[64:79], a[204:207], a[172:175], v[64:79]
 s_add_u32 m0, s32, 87616
 ds_read_b128 a[220:223], v9 offset:480
 buffer_load_dwordx4 v15, s[16:19], s30 offen offset:512 lds
 s_waitcnt lgkmcnt(2)
 v_mfma_f32_32x32x16_bf16 v[64:79], a[208:211], a[176:179], v[64:79]
 ds_read_b128 a[192:195], v9 offset:17408
 v_mfma_f32_32x32x16_bf16 v[64:79], a[212:215], a[180:183], v[64:79]
 ds_read_b128 a[196:199], v9 offset:17440
 s_waitcnt lgkmcnt(2)
 v_mfma_f32_32x32x16_bf16 v[64:79], a[216:219], a[184:187], v[64:79]
 s_add_u32 m0, s32, 88192
 ds_read_b128 a[200:203], v9 offset:17472
 buffer_load_dwordx4 v15, s[16:19], s30 offen offset:1024 lds
 v_mfma_f32_32x32x16_bf16 v[64:79], a[220:223], a[188:191], v[64:79]
 ds_read_b128 a[204:207], v9 offset:17504
 s_waitcnt lgkmcnt(2)
 v_mfma_f32_32x32x16_bf16 v[80:95], a[192:195], a[128:131], 0
 ds_read_b128 a[208:211], v9 offset:17536
 v_mfma_f32_32x32x16_bf16 v[80:95], a[196:199], a[132:135], v[80:95]
 s_add_u32 m0, s32, 88768
 ds_read_b128 a[212:215], v9 offset:17568
 buffer_load_dwordx4 v15, s[16:19], s30 offen offset:1536 lds
 s_waitcnt lgkmcnt(2)
 v_mfma_f32_32x32x16_bf16 v[80:95], a[200:203], a[136:139], v[80:95]
 ds_read_b128 a[216:219], v9 offset:17600
 s_nop 0
 v_max3_f32 v20, v20, v64, v65
 v_max3_f32 v20, v20, v66, v67
 v_max3_f32 v20, v20, v68, v69
 v_max3_f32 v20, v20, v70, v71
 v_mfma_f32_32x32x16_bf16 v[80:95], a[204:207], a[140:143], v[80:95]
 ds_read_b128 a[220:223], v9 offset:17632
 v_max3_f32 v20, v20, v72, v73
 v_max3_f32 v20, v20, v74, v75
 v_max3_f32 v20, v20, v76, v77
 v_max3_f32 v20, v20, v78, v79
 s_waitcnt lgkmcnt(2)
 v_mfma_f32_32x32x16_bf16 v[80:95], a[208:211], a[144:147], v[80:95]
 ds_read_b128 a[192:195], v9 offset:17664
 v_mfma_f32_32x32x16_bf16 v[80:95], a[212:215], a[148:151], v[80:95]
 ds_read_b128 a[196:199], v9 offset:17696
 s_waitcnt lgkmcnt(2)
 v_mfma_f32_32x32x16_bf16 v[80:95], a[216:219], a[152:155], v[80:95]
 ds_read_b128 a[200:203], v9 offset:17728
 v_mfma_f32_32x32x16_bf16 v[80:95], a[220:223], a[156:159], v[80:95]
 ds_read_b128 a[204:207], v9 offset:17760
 s_waitcnt lgkmcnt(2)
 v_mfma_f32_32x32x16_bf16 v[80:95], a[192:195], a[160:163], v[80:95]
 ds_read_b128 a[208:211], v9 offset:17792
 ds_read_b128 a[212:215], v9 offset:17824
 v_mfma_f32_32x32x16_bf16 v[80:95], a[196:199], a[164:167], v[80:95]
 ds_read_b128 a[216:219], v9 offset:17856
 ds_read_b128 a[220:223], v9 offset:17888
 s_waitcnt lgkmcnt(4)
 v_mfma_f32_32x32x16_bf16 v[80:95], a[200:203], a[168:171], v[80:95]
 v_mfma_f32_32x32x16_bf16 v[80:95], a[204:207], a[172:175], v[80:95]
 s_waitcnt lgkmcnt(2)
 v_mfma_f32_32x32x16_bf16 v[80:95], a[208:211], a[176:179], v[80:95]
 s_waitcnt vmcnt(16) lgkmcnt(0)
 s_barrier
 s_add_u32 s30, s30, 16384
 s_add_u32 m0, s32, 104448
 ds_read_b128 a[192:195], v7 offset:0
 buffer_load_dwordx4 v15, s[16:19], s30 offen offset:0 lds
 v_mfma_f32_32x32x16_bf16 v[80:95], a[212:215], a[180:183], v[80:95]
 ds_read_b128 a[196:199], v7 offset:32
 v_mfma_f32_32x32x16_bf16 v[80:95], a[216:219], a[184:187], v[80:95]
 ds_read_b128 a[200:203], v7 offset:64
 v_mfma_f32_32x32x16_bf16 v[80:95], a[220:223], a[188:191], v[80:95]
 s_add_u32 m0, s32, 105024
 ds_read_b128 a[204:207], v7 offset:96
 buffer_load_dwordx4 v15, s[16:19], s30 offen offset:512 lds
 s_waitcnt lgkmcnt(2)
 v_mfma_f32_32x32x16_bf16 v[96:111], a[192:195], a[128:131], 0
 ds_read_b128 a[208:211], v7 offset:128
 v_mfma_f32_32x32x16_bf16 v[96:111], a[196:199], a[132:135], v[96:111]
 ds_read_b128 a[212:215], v7 offset:160
 s_waitcnt lgkmcnt(2)
 v_mfma_f32_32x32x16_bf16 v[96:111], a[200:203], a[136:139], v[96:111]
 s_add_u32 m0, s32, 105600
 ds_read_b128 a[216:219], v7 offset:192
 buffer_load_dwordx4 v15, s[16:19], s30 offen offset:1024 lds
 v_max3_f32 v20, v20, v80, v81
 v_mfma_f32_32x32x16_bf16 v[96:111], a[204:207], a[140:143], v[96:111]
 ds_read_b128 a[220:223], v7 offset:224
 v_max3_f32 v20, v20, v82, v83
 v_max3_f32 v20, v20, v84, v85
 v_max3_f32 v20, v20, v86, v87
 v_max3_f32 v20, v20, v88, v89
 s_waitcnt lgkmcnt(2)
 v_mfma_f32_32x32x16_bf16 v[96:111], a[208:211], a[144:147], v[96:111]
 ds_read_b128 a[192:195], v7 offset:256
 v_max3_f32 v20, v20, v90, v91
 v_max3_f32 v20, v20, v92, v93
 v_max3_f32 v20, v20, v94, v95
 v_mfma_f32_32x32x16_bf16 v[96:111], a[212:215], a[148:151], v[96:111]
 s_add_u32 m0, s32, 106176
 ds_read_b128 a[196:199], v7 offset:288
 buffer_load_dwordx4 v15, s[16:19], s30 offen offset:1536 lds
 s_waitcnt lgkmcnt(2)
 v_mfma_f32_32x32x16_bf16 v[96:111], a[216:219], a[152:155], v[96:111]
 ds_read_b128 a[200:203], v7 offset:320
 v_mfma_f32_32x32x16_bf16 v[96:111], a[220:223], a[156:159], v[96:111]
 ds_read_b128 a[204:207], v7 offset:352
 s_waitcnt lgkmcnt(2)
 v_mfma_f32_32x32x16_bf16 v[96:111], a[192:195], a[160:163], v[96:111]
 s_add_u32 s30, s30, 16384
 s_add_u32 m0, s32, 121856
 ds_read_b128 a[208:211], v7 offset:384
 buffer_load_dwordx4 v15, s[16:19], s30 offen offset:0 lds
 v_mfma_f32_32x32x16_bf16 v[96:111], a[196:199], a[164:167], v[96:111]
 ds_read_b128 a[212:215], v7 offset:416
 s_waitcnt lgkmcnt(2)
 v_mfma_f32_32x32x16_bf16 v[96:111], a[200:203], a[168:171], v[96:111]
 ds_read_b128 a[216:219], v7 offset:448
 v_mfma_f32_32x32x16_bf16 v[96:111], a[204:207], a[172:175], v[96:111]
 s_add_u32 m0, s32, 122432
 ds_read_b128 a[220:223], v7 offset:480
 buffer_load_dwordx4 v15, s[16:19], s30 offen offset:512 lds
 s_waitcnt lgkmcnt(2)
 v_mfma_f32_32x32x16_bf16 v[96:111], a[208:211], a[176:179], v[96:111]
 ds_read_b128 a[192:195], v7 offset:17408
 v_mfma_f32_32x32x16_bf16 v[96:111], a[212:215], a[180:183], v[96:111]
 ds_read_b128 a[196:199], v7 offset:17440
 s_waitcnt lgkmcnt(2)
 v_mfma_f32_32x32x16_bf16 v[96:111], a[216:219], a[184:187], v[96:111]
 s_add_u32 m0, s32, 123008
 ds_read_b128 a[200:203], v7 offset:17472
 buffer_load_dwordx4 v15, s[16:19], s30 offen offset:1024 lds
 v_mfma_f32_32x32x16_bf16 v[96:111], a[220:223], a[188:191], v[96:111]
 ds_read_b128 a[204:207], v7 offset:17504
 s_waitcnt lgkmcnt(2)
 v_mfma_f32_32x32x16_bf16 v[112:127], a[192:195], a[128:131], 0
 ds_read_b128 a[208:211], v7 offset:17536
 v_mfma_f32_32x32x16_bf16 v[112:127], a[196:199], a[132:135], v[112:127]
 s_add_u32 m0, s32, 123584
 ds_read_b128 a[212:215], v7 offset:17568
 buffer_load_dwordx4 v15, s[16:19], s30 offen offset:1536 lds
 s_waitcnt lgkmcnt(2)
 v_mfma_f32_32x32x16_bf16 v[112:127], a[200:203], a[136:139], v[112:127]
 ds_read_b128 a[216:219], v7 offset:17600
 s_nop 0
 v_max3_f32 v20, v20, v96, v97
 v_max3_f32 v20, v20, v98, v99
 v_max3_f32 v20, v20, v100, v101
 v_max3_f32 v20, v20, v102, v103
 v_mfma_f32_32x32x16_bf16 v[112:127], a[204:207], a[140:143], v[112:127]
 ds_read_b128 a[220:223], v7 offset:17632
 v_max3_f32 v20, v20, v104, v105
 v_max3_f32 v20, v20, v106, v107
 v_max3_f32 v20, v20, v108, v109
 v_max3_f32 v20, v20, v110, v111
 s_waitcnt lgkmcnt(2)
 v_mfma_f32_32x32x16_bf16 v[112:127], a[208:211], a[144:147], v[112:127]
 ds_read_b128 a[192:195], v7 offset:17664
 v_mfma_f32_32x32x16_bf16 v[112:127], a[212:215], a[148:151], v[112:127]
 ds_read_b128 a[196:199], v7 offset:17696
 s_waitcnt lgkmcnt(2)
 v_mfma_f32_32x32x16_bf16 v[112:127], a[216:219], a[152:155], v[112:127]
 ds_read_b128 a[200:203], v7 offset:17728
 v_mfma_f32_32x32x16_bf16 v[112:127], a[220:223], a[156:159], v[112:127]
 ds_read_b128 a[204:207], v7 offset:17760
 s_waitcnt lgkmcnt(2)
 v_mfma_f32_32x32x16_bf16 v[112:127], a[192:195], a[160:163], v[112:127]
 ds_read_b128 a[208:211], v7 offset:17792
 ds_read_b128 a[212:215], v7 offset:17824
 v_mfma_f32_32x32x16_bf16 v[112:127], a[196:199], a[164:167], v[112:127]
 ds_read_b128 a[216:219], v7 offset:17856
 ds_read_b128 a[220:223], v7 offset:17888
 s_waitcnt lgkmcnt(4)
 v_mfma_f32_32x32x16_bf16 v[112:127], a[200:203], a[168:171], v[112:127]
 v_mfma_f32_32x32x16_bf16 v[112:127], a[204:207], a[172:175], v[112:127]
 s_waitcnt lgkmcnt(2)
 v_mfma_f32_32x32x16_bf16 v[112:127], a[208:211], a[176:179], v[112:127]
 s_waitcnt vmcnt(16) lgkmcnt(0)
 s_barrier
 s_add_u32 s30, s30, 16384
 s_add_u32 m0, s32, 0
 ds_read_b128 a[192:195], v7 offset:34816
 buffer_load_dwordx4 v15, s[16:19], s30 offen offset:0 lds
 v_mfma_f32_32x32x16_bf16 v[112:127], a[212:215], a[180:183], v[112:127]
 ds_read_b128 a[196:199], v7 offset:34848
 v_mfma_f32_32x32x16_bf16 v[112:127], a[216:219], a[184:187], v[112:127]
 ds_read_b128 a[200:203], v7 offset:34880
 v_mfma_f32_32x32x16_bf16 v[112:127], a[220:223], a[188:191], v[112:127]
 s_add_u32 m0, s32, 576
 ds_read_b128 a[204:207], v7 offset:34912
 buffer_load_dwordx4 v15, s[16:19], s30 offen offset:512 lds
 s_waitcnt lgkmcnt(2)
 v_mfma_f32_32x32x16_bf16 v[128:143], a[192:195], a[128:131], 0
 ds_read_b128 a[208:211], v7 offset:34944
 v_mfma_f32_32x32x16_bf16 v[128:143], a[196:199], a[132:135], v[128:143]
 ds_read_b128 a[212:215], v7 offset:34976
 s_waitcnt lgkmcnt(2)
 v_mfma_f32_32x32x16_bf16 v[128:143], a[200:203], a[136:139], v[128:143]
 s_add_u32 m0, s32, 1152
 ds_read_b128 a[216:219], v7 offset:35008
 buffer_load_dwordx4 v15, s[16:19], s30 offen offset:1024 lds
 v_max3_f32 v20, v20, v112, v113
 v_mfma_f32_32x32x16_bf16 v[128:143], a[204:207], a[140:143], v[128:143]
 ds_read_b128 a[220:223], v7 offset:35040
 v_max3_f32 v20, v20, v114, v115
 v_max3_f32 v20, v20, v116, v117
 v_max3_f32 v20, v20, v118, v119
 v_max3_f32 v20, v20, v120, v121
 s_waitcnt lgkmcnt(2)
 v_mfma_f32_32x32x16_bf16 v[128:143], a[208:211], a[144:147], v[128:143]
 ds_read_b128 a[192:195], v7 offset:35072
 v_max3_f32 v20, v20, v122, v123
 v_max3_f32 v20, v20, v124, v125
 v_max3_f32 v20, v20, v126, v127
 v_mfma_f32_32x32x16_bf16 v[128:143], a[212:215], a[148:151], v[128:143]
 s_add_u32 m0, s32, 1728
 ds_read_b128 a[196:199], v7 offset:35104
 buffer_load_dwordx4 v15, s[16:19], s30 offen offset:1536 lds
 s_waitcnt lgkmcnt(2)
 v_mfma_f32_32x32x16_bf16 v[128:143], a[216:219], a[152:155], v[128:143]
 ds_read_b128 a[200:203], v7 offset:35136
 v_mfma_f32_32x32x16_bf16 v[128:143], a[220:223], a[156:159], v[128:143]
 ds_read_b128 a[204:207], v7 offset:35168
 s_waitcnt lgkmcnt(2)
 v_mfma_f32_32x32x16_bf16 v[128:143], a[192:195], a[160:163], v[128:143]
 s_add_u32 s30, s30, 16384
 s_add_u32 m0, s32, 17408
 ds_read_b128 a[208:211], v7 offset:35200
 buffer_load_dwordx4 v15, s[16:19], s30 offen offset:0 lds
 v_mfma_f32_32x32x16_bf16 v[128:143], a[196:199], a[164:167], v[128:143]
 ds_read_b128 a[212:215], v7 offset:35232
 s_waitcnt lgkmcnt(2)
 v_mfma_f32_32x32x16_bf16 v[128:143], a[200:203], a[168:171], v[128:143]
 ds_read_b128 a[216:219], v7 offset:35264
 v_mfma_f32_32x32x16_bf16 v[128:143], a[204:207], a[172:175], v[128:143]
 s_add_u32 m0, s32, 17984
 ds_read_b128 a[220:223], v7 offset:35296
 buffer_load_dwordx4 v15, s[16:19], s30 offen offset:512 lds
 s_waitcnt lgkmcnt(2)
 v_mfma_f32_32x32x16_bf16 v[128:143], a[208:211], a[176:179], v[128:143]
 ds_read_b128 a[192:195], v8 offset:0
 v_mfma_f32_32x32x16_bf16 v[128:143], a[212:215], a[180:183], v[128:143]
 ds_read_b128 a[196:199], v8 offset:32
 s_waitcnt lgkmcnt(2)
 v_mfma_f32_32x32x16_bf16 v[128:143], a[216:219], a[184:187], v[128:143]
 s_add_u32 m0, s32, 18560
 ds_read_b128 a[200:203], v8 offset:64
 buffer_load_dwordx4 v15, s[16:19], s30 offen offset:1024 lds
 v_mfma_f32_32x32x16_bf16 v[128:143], a[220:223], a[188:191], v[128:143]
 ds_read_b128 a[204:207], v8 offset:96
 s_waitcnt lgkmcnt(2)
 v_mfma_f32_32x32x16_bf16 v[144:159], a[192:195], a[128:131], 0
 ds_read_b128 a[208:211], v8 offset:128
 v_mfma_f32_32x32x16_bf16 v[144:159], a[196:199], a[132:135], v[144:159]
 s_add_u32 m0, s32, 19136
 ds_read_b128 a[212:215], v8 offset:160
 buffer_load_dwordx4 v15, s[16:19], s30 offen offset:1536 lds
 s_waitcnt lgkmcnt(2)
 v_mfma_f32_32x32x16_bf16 v[144:159], a[200:203], a[136:139], v[144:159]
 ds_read_b128 a[216:219], v8 offset:192
 s_nop 0
 v_max3_f32 v20, v20, v128, v129
 v_max3_f32 v20, v20, v130, v131
 v_max3_f32 v20, v20, v132, v133
 v_max3_f32 v20, v20, v134, v135
 v_mfma_f32_32x32x16_bf16 v[144:159], a[204:207], a[140:143], v[144:159]
 ds_read_b128 a[220:223], v8 offset:224
 v_max3_f32 v20, v20, v136, v137
 v_max3_f32 v20, v20, v138, v139
 v_max3_f32 v20, v20, v140, v141
 v_max3_f32 v20, v20, v142, v143
 s_waitcnt lgkmcnt(2)
 v_mfma_f32_32x32x16_bf16 v[144:159], a[208:211], a[144:147], v[144:159]
 ds_read_b128 a[192:195], v8 offset:256
 v_mfma_f32_32x32x16_bf16 v[144:159], a[212:215], a[148:151], v[144:159]
 ds_read_b128 a[196:199], v8 offset:288
 s_waitcnt lgkmcnt(2)
 v_mfma_f32_32x32x16_bf16 v[144:159], a[216:219], a[152:155], v[144:159]
 ds_read_b128 a[200:203], v8 offset:320
 v_mfma_f32_32x32x16_bf16 v[144:159], a[220:223], a[156:159], v[144:159]
 ds_read_b128 a[204:207], v8 offset:352
 v_mov_b32 v27, 0x3f803f80
 v_accvgpr_write_b32 a144, v27
 v_accvgpr_write_b32 a145, 0
 v_accvgpr_write_b32 a146, 0
 s_waitcnt lgkmcnt(2)
 v_mfma_f32_32x32x16_bf16 v[144:159], a[192:195], a[160:163], v[144:159]
 ds_read_b128 a[208:211], v8 offset:384
 v_accvgpr_write_b32 a147, 0
 v_mov_b32 v29, 0
 v_mov_b32 v30, 0
 v_mov_b32 v31, 0
 v_mfma_f32_32x32x16_bf16 v[144:159], a[196:199], a[164:167], v[144:159]
 ds_read_b128 a[212:215], v8 offset:416
 s_waitcnt lgkmcnt(2)
 v_mfma_f32_32x32x16_bf16 v[144:159], a[200:203], a[168:171], v[144:159]
 ds_read_b128 a[216:219], v8 offset:448
 v_mfma_f32_32x32x16_bf16 v[144:159], a[204:207], a[172:175], v[144:159]
 ds_read_b128 a[220:223], v8 offset:480
 s_waitcnt lgkmcnt(2)
 v_mfma_f32_32x32x16_bf16 v[144:159], a[208:211], a[176:179], v[144:159]
 v_mfma_f32_32x32x16_bf16 v[144:159], a[212:215], a[180:183], v[144:159]
 s_waitcnt lgkmcnt(1)
 v_mfma_f32_32x32x16_bf16 v[144:159], a[216:219], a[184:187], v[144:159]
 s_waitcnt lgkmcnt(0)
 v_mfma_f32_32x32x16_bf16 v[144:159], a[220:223], a[188:191], v[144:159]
 s_waitcnt vmcnt(16)
 s_barrier
 s_add_u32 s30, s30, 16384
 s_add_u32 m0, s32, 34816
 ds_read_b64_tr_b16 a[192:193], v5 offset:17408
 buffer_load_dwordx4 v15, s[16:19], s30 offen offset:0 lds
 ds_read_b64_tr_b16 a[194:195], v5 offset:21760
 s_nop 4
 v_max3_f32 v20, v20, v144, v145
 v_max3_f32 v20, v20, v146, v147
 v_max3_f32 v20, v20, v148, v149
 v_max3_f32 v20, v20, v150, v151
 v_max3_f32 v20, v20, v152, v153
 v_max3_f32 v20, v20, v154, v155
 v_max3_f32 v20, v20, v156, v157
 v_max3_f32 v20, v20, v158, v159
 v_mov_b32 v27, v20
 s_nop 1
 v_permlane32_swap_b32 v20, v27
 v_max_f32 v20, v20, v27
 v_mul_f32 v20, -0.5, v20
 v_and_b32 v27, 0xffff0000, v20
 v_sub_f32 v20, v20, v27
 v_cvt_pk_bf16_f32 v28, v27, v20
 s_nop 1
 v_mfma_f32_32x32x16_bf16 v[160:175], a[144:147], v[28:31], v[160:175]
 ds_read_b64_tr_b16 a[196:197], v5 offset:17472
 ds_read_b64_tr_b16 a[198:199], v5 offset:21824
 v_mfma_f32_32x32x16_bf16 v[176:191], a[144:147], v[28:31], v[176:191]
 ds_read_b64_tr_b16 a[200:201], v5 offset:17536
 ds_read_b64_tr_b16 a[202:203], v5 offset:21888
 v_mfma_f32_32x32x16_bf16 v[192:207], a[144:147], v[28:31], v[192:207]
 s_add_u32 m0, s32, 35392
 ds_read_b64_tr_b16 a[204:205], v5 offset:17600
 buffer_load_dwordx4 v15, s[16:19], s30 offen offset:512 lds
 ds_read_b64_tr_b16 a[206:207], v5 offset:21952
 s_nop 1
 v_exp_f32 v160, v160
 v_exp_f32 v161, v161
 v_exp_f32 v162, v162
 v_mov_b32 v22, v160
 v_exp_f32 v163, v163
 v_mov_b32 v23, v161
 v_cvt_pk_bf16_f32 v160, v160, v161
 v_exp_f32 v164, v164
 v_add_f32 v22, v22, v162
 v_exp_f32 v165, v165
 v_add_f32 v23, v23, v163
 v_cvt_pk_bf16_f32 v161, v162, v163
 v_exp_f32 v166, v166
 v_add_f32 v22, v22, v164
 v_exp_f32 v167, v167
 v_add_f32 v23, v23, v165
 v_cvt_pk_bf16_f32 v162, v164, v165
 v_add_f32 v22, v22, v166
 v_add_f32 v23, v23, v167
 v_cvt_pk_bf16_f32 v163, v166, v167
 s_waitcnt lgkmcnt(4)
 s_nop 0
 v_mfma_f32_32x32x16_bf16 a[0:15], a[192:195], v[160:163], 0
 v_exp_f32 v168, v168
 v_exp_f32 v169, v169
 v_exp_f32 v170, v170
 v_add_f32 v22, v22, v168
 v_mfma_f32_32x32x16_bf16 a[16:31], a[196:199], v[160:163], 0
 ds_read_b64_tr_b16 a[208:209], v5 offset:17664
 ds_read_b64_tr_b16 a[210:211], v5 offset:22016
 v_exp_f32 v171, v171
 v_add_f32 v23, v23, v169
 v_cvt_pk_bf16_f32 v168, v168, v169
 s_waitcnt lgkmcnt(2)
 v_mfma_f32_32x32x16_bf16 a[32:47], a[200:203], v[160:163], 0
 s_add_u32 m0, s32, 35968
 ds_read_b64_tr_b16 a[212:213], v5 offset:17728
 buffer_load_dwordx4 v15, s[16:19], s30 offen offset:1024 lds
 ds_read_b64_tr_b16 a[214:215], v5 offset:22080
 v_exp_f32 v172, v172
 v_mfma_f32_32x32x16_bf16 a[48:63], a[204:207], v[160:163], 0
 ds_read_b64_tr_b16 a[216:217], v5 offset:17792
 ds_read_b64_tr_b16 a[218:219], v5 offset:22144
 v_add_f32 v22, v22, v170
 v_exp_f32 v173, v173
 v_add_f32 v23, v23, v171
 v_cvt_pk_bf16_f32 v169, v170, v171
 v_mfma_f32_32x32x16_bf16 v[208:223], a[144:147], v[28:31], v[208:223]
 ds_read_b64_tr_b16 a[220:221], v5 offset:17856
 ds_read_b64_tr_b16 a[222:223], v5 offset:22208
 v_exp_f32 v174, v174
 v_add_f32 v22, v22, v172
 v_exp_f32 v175, v175
 s_waitcnt lgkmcnt(4)
 v_mfma_f32_32x32x16_bf16 a[64:79], a[208:211], v[160:163], 0
 s_add_u32 m0, s32, 36544
 ds_read_b64_tr_b16 a[192:193], v5 offset:26112
 buffer_load_dwordx4 v15, s[16:19], s30 offen offset:1536 lds
 ds_read_b64_tr_b16 a[194:195], v5 offset:30464
 v_add_f32 v23, v23, v173
 v_cvt_pk_bf16_f32 v170, v172, v173
 v_mfma_f32_32x32x16_bf16 a[80:95], a[212:215], v[160:163], 0
 ds_read_b64_tr_b16 a[196:197], v5 offset:26176
 ds_read_b64_tr_b16 a[198:199], v5 offset:30528
 v_add_f32 v22, v22, v174
 v_add_f32 v23, v23, v175
 v_cvt_pk_bf16_f32 v171, v174, v175
 v_exp_f32 v176, v176
 s_waitcnt lgkmcnt(4)
 v_mfma_f32_32x32x16_bf16 a[96:111], a[216:219], v[160:163], 0
 ds_read_b64_tr_b16 a[200:201], v5 offset:26240
 ds_read_b64_tr_b16 a[202:203], v5 offset:30592
 v_exp_f32 v177, v177
 v_exp_f32 v178, v178
 v_add_f32 v22, v22, v176
 v_mfma_f32_32x32x16_bf16 a[112:127], a[220:223], v[160:163], 0
 s_add_u32 s30, s30, 16384
 s_add_u32 m0, s32, 52224
 ds_read_b64_tr_b16 a[204:205], v5 offset:26304
 buffer_load_dwordx4 v15, s[16:19], s30 offen offset:0 lds
 ds_read_b64_tr_b16 a[206:207], v5 offset:30656
 s_waitcnt lgkmcnt(4)
 v_mfma_f32_32x32x16_bf16 a[0:15], a[192:195], v[168:171], a[0:15]
 ds_read_b64_tr_b16 a[208:209], v5 offset:26368
 ds_read_b64_tr_b16 a[210:211], v5 offset:30720
 v_exp_f32 v179, v179
 v_add_f32 v23, v23, v177
 v_cvt_pk_bf16_f32 v176, v176, v177
 v_mfma_f32_32x32x16_bf16 a[16:31], a[196:199], v[168:171], a[16:31]
 ds_read_b64_tr_b16 a[212:213], v5 offset:26432
 ds_read_b64_tr_b16 a[214:215], v5 offset:30784
 v_exp_f32 v180, v180
 v_add_f32 v22, v22, v178
 v_exp_f32 v181, v181
 s_waitcnt lgkmcnt(4)
 v_mfma_f32_32x32x16_bf16 a[32:47], a[200:203], v[168:171], a[32:47]
 s_add_u32 m0, s32, 52800
 ds_read_b64_tr_b16 a[216:217], v5 offset:26496
 buffer_load_dwordx4 v15, s[16:19], s30 offen offset:512 lds
 ds_read_b64_tr_b16 a[218:219], v5 offset:30848
 v_add_f32 v23, v23, v179
 v_cvt_pk_bf16_f32 v177, v178, v179
 v_mfma_f32_32x32x16_bf16 a[48:63], a[204:207], v[168:171], a[48:63]
 ds_read_b64_tr_b16 a[220:221], v5 offset:26560
 ds_read_b64_tr_b16 a[222:223], v5 offset:30912
 v_exp_f32 v182, v182
 v_add_f32 v22, v22, v180
 v_exp_f32 v183, v183
 s_waitcnt lgkmcnt(4)
 v_mfma_f32_32x32x16_bf16 a[64:79], a[208:211], v[168:171], a[64:79]
 ds_read_b64_tr_b16 a[192:193], v5 offset:34816
 ds_read_b64_tr_b16 a[194:195], v5 offset:39168
 v_add_f32 v23, v23, v181
 v_cvt_pk_bf16_f32 v178, v180, v181
 v_add_f32 v22, v22, v182
 v_add_f32 v23, v23, v183
 v_cvt_pk_bf16_f32 v179, v182, v183
 v_mfma_f32_32x32x16_bf16 a[80:95], a[212:215], v[168:171], a[80:95]
 s_add_u32 m0, s32, 53376
 ds_read_b64_tr_b16 a[196:197], v5 offset:34880
 buffer_load_dwordx4 v15, s[16:19], s30 offen offset:1024 lds
 ds_read_b64_tr_b16 a[198:199], v5 offset:39232
 v_exp_f32 v184, v184
 s_waitcnt lgkmcnt(4)
 v_mfma_f32_32x32x16_bf16 a[96:111], a[216:219], v[168:171], a[96:111]
 ds_read_b64_tr_b16 a[200:201], v5 offset:34944
 ds_read_b64_tr_b16 a[202:203], v5 offset:39296
 v_exp_f32 v185, v185
 v_exp_f32 v186, v186
 v_add_f32 v22, v22, v184
 v_mfma_f32_32x32x16_bf16 a[112:127], a[220:223], v[168:171], a[112:127]
 ds_read_b64_tr_b16 a[204:205], v5 offset:35008
 ds_read_b64_tr_b16 a[206:207], v5 offset:39360
 v_exp_f32 v187, v187
 v_add_f32 v23, v23, v185
 v_cvt_pk_bf16_f32 v184, v184, v185
 s_waitcnt lgkmcnt(4)
 v_mfma_f32_32x32x16_bf16 a[0:15], a[192:195], v[176:179], a[0:15]
 s_add_u32 m0, s32, 53952
 s_nop 0
 buffer_load_dwordx4 v15, s[16:19], s30 offen offset:1536 lds
 v_exp_f32 v188, v188
 v_add_f32 v22, v22, v186
 v_mfma_f32_32x32x16_bf16 a[16:31], a[196:199], v[176:179], a[16:31]
 ds_read_b64_tr_b16 a[208:209], v5 offset:35072
 ds_read_b64_tr_b16 a[210:211], v5 offset:39424
 v_exp_f32 v189, v189
 v_add_f32 v23, v23, v187
 v_cvt_pk_bf16_f32 v185, v186, v187
 s_waitcnt lgkmcnt(2)
 v_mfma_f32_32x32x16_bf16 a[32:47], a[200:203], v[176:179], a[32:47]
 ds_read_b64_tr_b16 a[212:213], v5 offset:35136
 ds_read_b64_tr_b16 a[214:215], v5 offset:39488
 v_exp_f32 v190, v190
 v_add_f32 v22, v22, v188
 v_exp_f32 v191, v191
 v_mfma_f32_32x32x16_bf16 a[48:63], a[204:207], v[176:179], a[48:63]
 ds_read_b64_tr_b16 a[216:217], v5 offset:35200
 ds_read_b64_tr_b16 a[218:219], v5 offset:39552
 v_add_f32 v23, v23, v189
 v_cvt_pk_bf16_f32 v186, v188, v189
 v_add_f32 v22, v22, v190
 v_add_f32 v23, v23, v191
 v_cvt_pk_bf16_f32 v187, v190, v191
 v_mfma_f32_32x32x16_bf16 v[224:239], a[144:147], v[28:31], v[224:239]
 ds_read_b64_tr_b16 a[220:221], v5 offset:35264
 ds_read_b64_tr_b16 a[222:223], v5 offset:39616
 v_exp_f32 v192, v192
 v_exp_f32 v193, v193
 s_waitcnt lgkmcnt(4)
 v_mfma_f32_32x32x16_bf16 a[64:79], a[208:211], v[176:179], a[64:79]
 ds_read_b64_tr_b16 a[192:193], v5 offset:43520
 ds_read_b64_tr_b16 a[194:195], v5 offset:47872
 v_exp_f32 v194, v194
 v_add_f32 v22, v22, v192
 v_exp_f32 v195, v195
 v_mfma_f32_32x32x16_bf16 a[80:95], a[212:215], v[176:179], a[80:95]
 ds_read_b64_tr_b16 a[196:197], v5 offset:43584
 ds_read_b64_tr_b16 a[198:199], v5 offset:47936
 v_add_f32 v23, v23, v193
 v_cvt_pk_bf16_f32 v192, v192, v193
 v_exp_f32 v196, v196
 v_add_f32 v22, v22, v194
 s_waitcnt lgkmcnt(4)
 v_mfma_f32_32x32x16_bf16 a[96:111], a[216:219], v[176:179], a[96:111]
 ds_read_b64_tr_b16 a[200:201], v5 offset:43648
 ds_read_b64_tr_b16 a[202:203], v5 offset:48000
 v_exp_f32 v197, v197
 v_add_f32 v23, v23, v195
 v_cvt_pk_bf16_f32 v193, v194, v195
 v_mfma_f32_32x32x16_bf16 a[112:127], a[220:223], v[176:179], a[112:127]
 ds_read_b64_tr_b16 a[204:205], v5 offset:43712
 ds_read_b64_tr_b16 a[206:207], v5 offset:48064
 v_exp_f32 v198, v198
 v_add_f32 v22, v22, v196
 v_exp_f32 v199, v199
 s_waitcnt lgkmcnt(4)
 v_mfma_f32_32x32x16_bf16 a[0:15], a[192:195], v[184:187], a[0:15]
 ds_read_b64_tr_b16 a[208:209], v5 offset:43776
 ds_read_b64_tr_b16 a[210:211], v5 offset:48128
 ds_read_b64_tr_b16 a[212:213], v5 offset:43840
 ds_read_b64_tr_b16 a[214:215], v5 offset:48192
 v_add_f32 v23, v23, v197
 v_cvt_pk_bf16_f32 v194, v196, v197
 v_add_f32 v22, v22, v198
 v_mfma_f32_32x32x16_bf16 a[16:31], a[196:199], v[184:187], a[16:31]
 ds_read_b64_tr_b16 a[216:217], v5 offset:43904
 ds_read_b64_tr_b16 a[218:219], v5 offset:48256
 ds_read_b64_tr_b16 a[220:221], v5 offset:43968
 ds_read_b64_tr_b16 a[222:223], v5 offset:48320
 v_add_f32 v23, v23, v199
 v_cvt_pk_bf16_f32 v195, v198, v199
 s_waitcnt lgkmcnt(8)
 v_mfma_f32_32x32x16_bf16 a[32:47], a[200:203], v[184:187], a[32:47]
 v_exp_f32 v200, v200
 v_exp_f32 v201, v201
 v_exp_f32 v202, v202
 v_add_f32 v22, v22, v200
 v_mfma_f32_32x32x16_bf16 a[48:63], a[204:207], v[184:187], a[48:63]
 v_exp_f32 v203, v203
 v_add_f32 v23, v23, v201
 v_cvt_pk_bf16_f32 v200, v200, v201
 v_exp_f32 v204, v204
 v_add_f32 v22, v22, v202
 s_waitcnt lgkmcnt(4)
 v_mfma_f32_32x32x16_bf16 a[64:79], a[208:211], v[184:187], a[64:79]
 s_waitcnt vmcnt(16) lgkmcnt(0)
 s_barrier
 s_add_u32 s30, s30, 16384
 s_add_u32 m0, s32, 69632
 ds_read_b64_tr_b16 a[192:193], v6 offset:0
 buffer_load_dwordx4 v15, s[16:19], s30 offen offset:0 lds
 ds_read_b64_tr_b16 a[194:195], v6 offset:4352
 v_mfma_f32_32x32x16_bf16 a[80:95], a[212:215], v[184:187], a[80:95]
 ds_read_b64_tr_b16 a[196:197], v6 offset:64
 ds_read_b64_tr_b16 a[198:199], v6 offset:4416
 v_exp_f32 v205, v205
 v_add_f32 v23, v23, v203
 v_cvt_pk_bf16_f32 v201, v202, v203
 v_mfma_f32_32x32x16_bf16 a[96:111], a[216:219], v[184:187], a[96:111]
 ds_read_b64_tr_b16 a[200:201], v6 offset:128
 ds_read_b64_tr_b16 a[202:203], v6 offset:4480
 v_exp_f32 v206, v206
 v_add_f32 v22, v22, v204
 v_exp_f32 v207, v207
 v_mfma_f32_32x32x16_bf16 a[112:127], a[220:223], v[184:187], a[112:127]
 s_add_u32 m0, s32, 70208
 ds_read_b64_tr_b16 a[204:205], v6 offset:192
 buffer_load_dwordx4 v15, s[16:19], s30 offen offset:512 lds
 ds_read_b64_tr_b16 a[206:207], v6 offset:4544
 v_add_f32 v23, v23, v205
 v_cvt_pk_bf16_f32 v202, v204, v205
 s_waitcnt lgkmcnt(4)
 v_mfma_f32_32x32x16_bf16 a[0:15], a[192:195], v[192:195], a[0:15]
 v_add_f32 v22, v22, v206
 v_add_f32 v23, v23, v207
 v_cvt_pk_bf16_f32 v203, v206, v207
 v_exp_f32 v208, v208
 v_exp_f32 v209, v209
 v_mfma_f32_32x32x16_bf16 a[16:31], a[196:199], v[192:195], a[16:31]
 ds_read_b64_tr_b16 a[208:209], v6 offset:256
 ds_read_b64_tr_b16 a[210:211], v6 offset:4608
 v_exp_f32 v210, v210
 v_add_f32 v22, v22, v208
 v_exp_f32 v211, v211
 s_waitcnt lgkmcnt(2)
 v_mfma_f32_32x32x16_bf16 a[32:47], a[200:203], v[192:195], a[32:47]
 s_add_u32 m0, s32, 70784
 ds_read_b64_tr_b16 a[212:213], v6 offset:320
 buffer_load_dwordx4 v15, s[16:19], s30 offen offset:1024 lds
 ds_read_b64_tr_b16 a[214:215], v6 offset:4672
 v_add_f32 v23, v23, v209
 v_cvt_pk_bf16_f32 v208, v208, v209
 v_mfma_f32_32x32x16_bf16 a[48:63], a[204:207], v[192:195], a[48:63]
 ds_read_b64_tr_b16 a[216:217], v6 offset:384
 ds_read_b64_tr_b16 a[218:219], v6 offset:4736
 v_exp_f32 v212, v212
 v_add_f32 v22, v22, v210
 v_exp_f32 v213, v213
 v_mfma_f32_32x32x16_bf16 v[240:255], a[144:147], v[28:31], v[240:255]
 ds_read_b64_tr_b16 a[220:221], v6 offset:448
 ds_read_b64_tr_b16 a[222:223], v6 offset:4800
 v_add_f32 v23, v23, v211
 v_cvt_pk_bf16_f32 v209, v210, v211
 v_exp_f32 v214, v214
 v_add_f32 v22, v22, v212
 s_waitcnt lgkmcnt(4)
 v_mfma_f32_32x32x16_bf16 a[64:79], a[208:211], v[192:195], a[64:79]
 s_add_u32 m0, s32, 71360
 ds_read_b64_tr_b16 a[192:193], v6 offset:8704
 buffer_load_dwordx4 v15, s[16:19], s30 offen offset:1536 lds
 ds_read_b64_tr_b16 a[194:195], v6 offset:13056
 v_exp_f32 v215, v215
 v_mfma_f32_32x32x16_bf16 a[80:95], a[212:215], v[192:195], a[80:95]
 ds_read_b64_tr_b16 a[196:197], v6 offset:8768
 ds_read_b64_tr_b16 a[198:199], v6 offset:13120
 v_add_f32 v23, v23, v213
 v_cvt_pk_bf16_f32 v210, v212, v213
 v_add_f32 v22, v22, v214
 v_add_f32 v23, v23, v215
 v_cvt_pk_bf16_f32 v211, v214, v215
 s_waitcnt lgkmcnt(4)
 v_mfma_f32_32x32x16_bf16 a[96:111], a[216:219], v[192:195], a[96:111]
 ds_read_b64_tr_b16 a[200:201], v6 offset:8832
 ds_read_b64_tr_b16 a[202:203], v6 offset:13184
 v_exp_f32 v216, v216
 v_exp_f32 v217, v217
 v_mfma_f32_32x32x16_bf16 a[112:127], a[220:223], v[192:195], a[112:127]
 s_add_u32 s30, s30, 16384
 s_add_u32 m0, s32, 87040
 ds_read_b64_tr_b16 a[204:205], v6 offset:8896
 buffer_load_dwordx4 v15, s[16:19], s30 offen offset:0 lds
 ds_read_b64_tr_b16 a[206:207], v6 offset:13248
 s_waitcnt lgkmcnt(4)
 v_mfma_f32_32x32x16_bf16 a[0:15], a[192:195], v[200:203], a[0:15]
 ds_read_b64_tr_b16 a[208:209], v6 offset:8960
 ds_read_b64_tr_b16 a[210:211], v6 offset:13312
 v_exp_f32 v218, v218
 v_add_f32 v22, v22, v216
 v_exp_f32 v219, v219
 v_mfma_f32_32x32x16_bf16 a[16:31], a[196:199], v[200:203], a[16:31]
 ds_read_b64_tr_b16 a[212:213], v6 offset:9024
 ds_read_b64_tr_b16 a[214:215], v6 offset:13376
 v_add_f32 v23, v23, v217
 v_cvt_pk_bf16_f32 v216, v216, v217
 v_exp_f32 v220, v220
 v_add_f32 v22, v22, v218
 s_waitcnt lgkmcnt(4)
 v_mfma_f32_32x32x16_bf16 a[32:47], a[200:203], v[200:203], a[32:47]
 s_add_u32 m0, s32, 87616
 ds_read_b64_tr_b16 a[216:217], v6 offset:9088
 buffer_load_dwordx4 v15, s[16:19], s30 offen offset:512 lds
 ds_read_b64_tr_b16 a[218:219], v6 offset:13440
 v_exp_f32 v221, v221
 v_mfma_f32_32x32x16_bf16 a[48:63], a[204:207], v[200:203], a[48:63]
 ds_read_b64_tr_b16 a[220:221], v6 offset:9152
 ds_read_b64_tr_b16 a[222:223], v6 offset:13504
 v_add_f32 v23, v23, v219
 v_cvt_pk_bf16_f32 v217, v218, v219
 v_exp_f32 v222, v222
 v_add_f32 v22, v22, v220
 s_waitcnt lgkmcnt(4)
 v_mfma_f32_32x32x16_bf16 a[64:79], a[208:211], v[200:203], a[64:79]
 ds_read_b64_tr_b16 a[192:193], v6 offset:17408
 ds_read_b64_tr_b16 a[194:195], v6 offset:21760
 v_exp_f32 v223, v223
 v_add_f32 v23, v23, v221
 v_cvt_pk_bf16_f32 v218, v220, v221
 v_add_f32 v22, v22, v222
 v_mfma_f32_32x32x16_bf16 a[80:95], a[212:215], v[200:203], a[80:95]
 s_add_u32 m0, s32, 88192
 ds_read_b64_tr_b16 a[196:197], v6 offset:17472
 buffer_load_dwordx4 v15, s[16:19], s30 offen offset:1024 lds
 ds_read_b64_tr_b16 a[198:199], v6 offset:21824
 v_add_f32 v23, v23, v223
 v_cvt_pk_bf16_f32 v219, v222, v223
 s_waitcnt lgkmcnt(4)
 v_mfma_f32_32x32x16_bf16 a[96:111], a[216:219], v[200:203], a[96:111]
 ds_read_b64_tr_b16 a[200:201], v6 offset:17536
 ds_read_b64_tr_b16 a[202:203], v6 offset:21888
 v_exp_f32 v224, v224
 v_exp_f32 v225, v225
 v_mfma_f32_32x32x16_bf16 a[112:127], a[220:223], v[200:203], a[112:127]
 ds_read_b64_tr_b16 a[204:205], v6 offset:17600
 ds_read_b64_tr_b16 a[206:207], v6 offset:21952
 v_exp_f32 v226, v226
 v_add_f32 v22, v22, v224
 v_exp_f32 v227, v227
 s_waitcnt lgkmcnt(4)
 v_mfma_f32_32x32x16_bf16 a[0:15], a[192:195], v[208:211], a[0:15]
 s_add_u32 m0, s32, 88768
 s_nop 0
 buffer_load_dwordx4 v15, s[16:19], s30 offen offset:1536 lds
 v_add_f32 v23, v23, v225
 v_cvt_pk_bf16_f32 v224, v224, v225
 v_exp_f32 v228, v228
 v_mfma_f32_32x32x16_bf16 a[16:31], a[196:199], v[208:211], a[16:31]
 ds_read_b64_tr_b16 a[208:209], v6 offset:17664
 ds_read_b64_tr_b16 a[210:211], v6 offset:22016
 v_add_f32 v22, v22, v226
 v_exp_f32 v229, v229
 v_add_f32 v23, v23, v227
 v_cvt_pk_bf16_f32 v225, v226, v227
 s_waitcnt lgkmcnt(2)
 v_mfma_f32_32x32x16_bf16 a[32:47], a[200:203], v[208:211], a[32:47]
 ds_read_b64_tr_b16 a[212:213], v6 offset:17728
 ds_read_b64_tr_b16 a[214:215], v6 offset:22080
 v_exp_f32 v230, v230
 v_add_f32 v22, v22, v228
 v_exp_f32 v231, v231
 v_mfma_f32_32x32x16_bf16 a[48:63], a[204:207], v[208:211], a[48:63]
 ds_read_b64_tr_b16 a[216:217], v6 offset:17792
 ds_read_b64_tr_b16 a[218:219], v6 offset:22144
 v_add_f32 v23, v23, v229
 v_cvt_pk_bf16_f32 v226, v228, v229
 v_add_f32 v22, v22, v230
 v_add_f32 v23, v23, v231
 v_cvt_pk_bf16_f32 v227, v230, v231
 v_mfma_f32_32x32x16_bf16 a[224:239], a[144:147], v[28:31], a[224:239]
 ds_read_b64_tr_b16 a[220:221], v6 offset:17856
 ds_read_b64_tr_b16 a[222:223], v6 offset:22208
 v_exp_f32 v232, v232
 v_exp_f32 v233, v233
 s_waitcnt lgkmcnt(4)
 v_mfma_f32_32x32x16_bf16 a[64:79], a[208:211], v[208:211], a[64:79]
 ds_read_b64_tr_b16 a[192:193], v6 offset:26112
 ds_read_b64_tr_b16 a[194:195], v6 offset:30464
 v_exp_f32 v234, v234
 v_add_f32 v22, v22, v232
 v_exp_f32 v235, v235
 v_mfma_f32_32x32x16_bf16 a[80:95], a[212:215], v[208:211], a[80:95]
 ds_read_b64_tr_b16 a[196:197], v6 offset:26176
 ds_read_b64_tr_b16 a[198:199], v6 offset:30528
 v_add_f32 v23, v23, v233
 v_cvt_pk_bf16_f32 v232, v232, v233
 v_exp_f32 v236, v236
 v_add_f32 v22, v22, v234
 s_waitcnt lgkmcnt(4)
 v_mfma_f32_32x32x16_bf16 a[96:111], a[216:219], v[208:211], a[96:111]
 ds_read_b64_tr_b16 a[200:201], v6 offset:26240
 ds_read_b64_tr_b16 a[202:203], v6 offset:30592
 v_exp_f32 v237, v237
 v_add_f32 v23, v23, v235
 v_cvt_pk_bf16_f32 v233, v234, v235
 v_mfma_f32_32x32x16_bf16 a[112:127], a[220:223], v[208:211], a[112:127]
 ds_read_b64_tr_b16 a[204:205], v6 offset:26304
 ds_read_b64_tr_b16 a[206:207], v6 offset:30656
 v_exp_f32 v238, v238
 v_add_f32 v22, v22, v236
 v_exp_f32 v239, v239
 s_waitcnt lgkmcnt(4)
 v_mfma_f32_32x32x16_bf16 a[0:15], a[192:195], v[216:219], a[0:15]
 ds_read_b64_tr_b16 a[208:209], v6 offset:26368
 ds_read_b64_tr_b16 a[210:211], v6 offset:30720
 ds_read_b64_tr_b16 a[212:213], v6 offset:26432
 ds_read_b64_tr_b16 a[214:215], v6 offset:30784
 v_add_f32 v23, v23, v237
 v_cvt_pk_bf16_f32 v234, v236, v237
 v_add_f32 v22, v22, v238
 v_mfma_f32_32x32x16_bf16 a[16:31], a[196:199], v[216:219], a[16:31]
 ds_read_b64_tr_b16 a[216:217], v6 offset:26496
 ds_read_b64_tr_b16 a[218:219], v6 offset:30848
 ds_read_b64_tr_b16 a[220:221], v6 offset:26560
 ds_read_b64_tr_b16 a[222:223], v6 offset:30912
 v_add_f32 v23, v23, v239
 v_cvt_pk_bf16_f32 v235, v238, v239
 s_waitcnt lgkmcnt(8)
 v_mfma_f32_32x32x16_bf16 a[32:47], a[200:203], v[216:219], a[32:47]
 v_exp_f32 v240, v240
 v_exp_f32 v241, v241
 v_exp_f32 v242, v242
 v_add_f32 v22, v22, v240
 v_mfma_f32_32x32x16_bf16 a[48:63], a[204:207], v[216:219], a[48:63]
 v_exp_f32 v243, v243
 v_add_f32 v23, v23, v241
 v_cvt_pk_bf16_f32 v240, v240, v241
 v_exp_f32 v244, v244
 v_add_f32 v22, v22, v242
 s_waitcnt lgkmcnt(4)
 v_mfma_f32_32x32x16_bf16 a[64:79], a[208:211], v[216:219], a[64:79]
 s_waitcnt vmcnt(16) lgkmcnt(0)
 s_barrier
 s_add_u32 s30, s30, 16384
 s_add_u32 m0, s32, 104448
 ds_read_b64_tr_b16 a[192:193], v4 offset:0
 buffer_load_dwordx4 v15, s[16:19], s30 offen offset:0 lds
 ds_read_b64_tr_b16 a[194:195], v4 offset:4352
 v_mfma_f32_32x32x16_bf16 a[80:95], a[212:215], v[216:219], a[80:95]
 ds_read_b64_tr_b16 a[196:197], v4 offset:64
 ds_read_b64_tr_b16 a[198:199], v4 offset:4416
 v_exp_f32 v245, v245
 v_add_f32 v23, v23, v243
 v_cvt_pk_bf16_f32 v241, v242, v243
 v_mfma_f32_32x32x16_bf16 a[96:111], a[216:219], v[216:219], a[96:111]
 ds_read_b64_tr_b16 a[200:201], v4 offset:128
 ds_read_b64_tr_b16 a[202:203], v4 offset:4480
 v_exp_f32 v246, v246
 v_add_f32 v22, v22, v244
 v_exp_f32 v247, v247
 v_mfma_f32_32x32x16_bf16 a[112:127], a[220:223], v[216:219], a[112:127]
 s_add_u32 m0, s32, 105024
 ds_read_b64_tr_b16 a[204:205], v4 offset:192
 buffer_load_dwordx4 v15, s[16:19], s30 offen offset:512 lds
 ds_read_b64_tr_b16 a[206:207], v4 offset:4544
 v_add_f32 v23, v23, v245
 v_cvt_pk_bf16_f32 v242, v244, v245
 s_waitcnt lgkmcnt(4)
 v_mfma_f32_32x32x16_bf16 a[0:15], a[192:195], v[224:227], a[0:15]
 v_add_f32 v22, v22, v246
 v_add_f32 v23, v23, v247
 v_cvt_pk_bf16_f32 v243, v246, v247
 v_exp_f32 v248, v248
 v_exp_f32 v249, v249
 v_mfma_f32_32x32x16_bf16 a[16:31], a[196:199], v[224:227], a[16:31]
 ds_read_b64_tr_b16 a[208:209], v4 offset:256
 ds_read_b64_tr_b16 a[210:211], v4 offset:4608
 v_exp_f32 v250, v250
 v_add_f32 v22, v22, v248
 v_exp_f32 v251, v251
 s_waitcnt lgkmcnt(2)
 v_mfma_f32_32x32x16_bf16 a[32:47], a[200:203], v[224:227], a[32:47]
 s_add_u32 m0, s32, 105600
 ds_read_b64_tr_b16 a[212:213], v4 offset:320
 buffer_load_dwordx4 v15, s[16:19], s30 offen offset:1024 lds
 ds_read_b64_tr_b16 a[214:215], v4 offset:4672
 v_add_f32 v23, v23, v249
 v_cvt_pk_bf16_f32 v248, v248, v249
 v_mfma_f32_32x32x16_bf16 a[48:63], a[204:207], v[224:227], a[48:63]
 ds_read_b64_tr_b16 a[216:217], v4 offset:384
 ds_read_b64_tr_b16 a[218:219], v4 offset:4736
 v_exp_f32 v252, v252
 v_add_f32 v22, v22, v250
 v_exp_f32 v253, v253
 v_mfma_f32_32x32x16_bf16 a[240:255], a[144:147], v[28:31], a[240:255]
 ds_read_b64_tr_b16 a[220:221], v4 offset:448
 ds_read_b64_tr_b16 a[222:223], v4 offset:4800
 v_add_f32 v23, v23, v251
 v_cvt_pk_bf16_f32 v249, v250, v251
 v_exp_f32 v254, v254
 v_add_f32 v22, v22, v252
 s_waitcnt lgkmcnt(4)
 v_mfma_f32_32x32x16_bf16 a[64:79], a[208:211], v[224:227], a[64:79]
 s_add_u32 m0, s32, 106176
 ds_read_b64_tr_b16 a[192:193], v4 offset:8704
 buffer_load_dwordx4 v15, s[16:19], s30 offen offset:1536 lds
 ds_read_b64_tr_b16 a[194:195], v4 offset:13056
 v_exp_f32 v255, v255
 v_mfma_f32_32x32x16_bf16 a[80:95], a[212:215], v[224:227], a[80:95]
 ds_read_b64_tr_b16 a[196:197], v4 offset:8768
 ds_read_b64_tr_b16 a[198:199], v4 offset:13120
 v_add_f32 v23, v23, v253
 v_cvt_pk_bf16_f32 v250, v252, v253
 v_add_f32 v22, v22, v254
 v_add_f32 v23, v23, v255
 v_cvt_pk_bf16_f32 v251, v254, v255
 s_waitcnt lgkmcnt(4)
 v_mfma_f32_32x32x16_bf16 a[96:111], a[216:219], v[224:227], a[96:111]
 ds_read_b64_tr_b16 a[200:201], v4 offset:8832
 ds_read_b64_tr_b16 a[202:203], v4 offset:13184
 v_accvgpr_read_b32 v164, a224
 v_accvgpr_read_b32 v165, a225
 v_exp_f32 v164, v164
 v_mfma_f32_32x32x16_bf16 a[112:127], a[220:223], v[224:227], a[112:127]
 s_add_u32 s30, s30, 16384
 s_add_u32 m0, s32, 121856
 ds_read_b64_tr_b16 a[204:205], v4 offset:8896
 buffer_load_dwordx4 v15, s[16:19], s30 offen offset:0 lds
 ds_read_b64_tr_b16 a[206:207], v4 offset:13248
 s_waitcnt lgkmcnt(4)
 v_mfma_f32_32x32x16_bf16 a[0:15], a[192:195], v[232:235], a[0:15]
 ds_read_b64_tr_b16 a[208:209], v4 offset:8960
 ds_read_b64_tr_b16 a[210:211], v4 offset:13312
 v_exp_f32 v165, v165
 v_accvgpr_read_b32 v166, a226
 v_accvgpr_read_b32 v167, a227
 v_mfma_f32_32x32x16_bf16 a[16:31], a[196:199], v[232:235], a[16:31]
 ds_read_b64_tr_b16 a[212:213], v4 offset:9024
 ds_read_b64_tr_b16 a[214:215], v4 offset:13376
 v_exp_f32 v166, v166
 v_add_f32 v22, v22, v164
 v_exp_f32 v167, v167
 s_waitcnt lgkmcnt(4)
 v_mfma_f32_32x32x16_bf16 a[32:47], a[200:203], v[232:235], a[32:47]
 s_add_u32 m0, s32, 122432
 ds_read_b64_tr_b16 a[216:217], v4 offset:9088
 buffer_load_dwordx4 v15, s[16:19], s30 offen offset:512 lds
 ds_read_b64_tr_b16 a[218:219], v4 offset:13440
 v_add_f32 v23, v23, v165
 v_cvt_pk_bf16_f32 v180, v164, v165
 v_mfma_f32_32x32x16_bf16 a[48:63], a[204:207], v[232:235], a[48:63]
 ds_read_b64_tr_b16 a[220:221], v4 offset:9152
 ds_read_b64_tr_b16 a[222:223], v4 offset:13504
 v_accvgpr_read_b32 v172, a228
 v_accvgpr_read_b32 v173, a229
 v_exp_f32 v172, v172
 v_add_f32 v22, v22, v166
 s_waitcnt lgkmcnt(4)
 v_mfma_f32_32x32x16_bf16 a[64:79], a[208:211], v[232:235], a[64:79]
 ds_read_b64_tr_b16 a[192:193], v4 offset:17408
 ds_read_b64_tr_b16 a[194:195], v4 offset:21760
 v_exp_f32 v173, v173
 v_add_f32 v23, v23, v167
 v_cvt_pk_bf16_f32 v181, v166, v167
 v_accvgpr_read_b32 v174, a230
 v_mfma_f32_32x32x16_bf16 a[80:95], a[212:215], v[232:235], a[80:95]
 s_add_u32 m0, s32, 123008
 ds_read_b64_tr_b16 a[196:197], v4 offset:17472
 buffer_load_dwordx4 v15, s[16:19], s30 offen offset:1024 lds
 ds_read_b64_tr_b16 a[198:199], v4 offset:21824
 v_accvgpr_read_b32 v175, a231
 s_waitcnt lgkmcnt(4)
 v_mfma_f32_32x32x16_bf16 a[96:111], a[216:219], v[232:235], a[96:111]
 ds_read_b64_tr_b16 a[200:201], v4 offset:17536
 ds_read_b64_tr_b16 a[202:203], v4 offset:21888
 v_exp_f32 v174, v174
 v_add_f32 v22, v22, v172
 v_exp_f32 v175, v175
 v_mfma_f32_32x32x16_bf16 a[112:127], a[220:223], v[232:235], a[112:127]
 ds_read_b64_tr_b16 a[204:205], v4 offset:17600
 ds_read_b64_tr_b16 a[206:207], v4 offset:21952
 v_add_f32 v23, v23, v173
 v_cvt_pk_bf16_f32 v182, v172, v173
 v_add_f32 v22, v22, v174
 v_add_f32 v23, v23, v175
 v_cvt_pk_bf16_f32 v183, v174, v175
 s_waitcnt lgkmcnt(4)
 v_mfma_f32_32x32x16_bf16 a[0:15], a[192:195], v[240:243], a[0:15]
 s_add_u32 m0, s32, 123584
 s_nop 0
 buffer_load_dwordx4 v15, s[16:19], s30 offen offset:1536 lds
 v_accvgpr_read_b32 v164, a232
 v_accvgpr_read_b32 v165, a233
 v_exp_f32 v164, v164
 v_mfma_f32_32x32x16_bf16 a[16:31], a[196:199], v[240:243], a[16:31]
 ds_read_b64_tr_b16 a[208:209], v4 offset:17664
 ds_read_b64_tr_b16 a[210:211], v4 offset:22016
 v_exp_f32 v165, v165
 v_accvgpr_read_b32 v166, a234
 v_accvgpr_read_b32 v167, a235
 s_waitcnt lgkmcnt(2)
 v_mfma_f32_32x32x16_bf16 a[32:47], a[200:203], v[240:243], a[32:47]
 ds_read_b64_tr_b16 a[212:213], v4 offset:17728
 ds_read_b64_tr_b16 a[214:215], v4 offset:22080
 v_exp_f32 v166, v166
 v_add_f32 v22, v22, v164
 v_exp_f32 v167, v167
 v_mfma_f32_32x32x16_bf16 a[48:63], a[204:207], v[240:243], a[48:63]
 ds_read_b64_tr_b16 a[216:217], v4 offset:17792
 ds_read_b64_tr_b16 a[218:219], v4 offset:22144
 v_add_f32 v23, v23, v165
 v_cvt_pk_bf16_f32 v188, v164, v165
 v_accvgpr_read_b32 v172, a236
 v_accvgpr_read_b32 v173, a237
 v_mfma_f32_32x32x16_bf16 v[32:47], a[144:147], v[28:31], v[32:47]
 ds_read_b64_tr_b16 a[220:221], v4 offset:17856
 ds_read_b64_tr_b16 a[222:223], v4 offset:22208
 v_exp_f32 v172, v172
 v_add_f32 v22, v22, v166
 v_exp_f32 v173, v173
 s_waitcnt lgkmcnt(4)
 v_mfma_f32_32x32x16_bf16 a[64:79], a[208:211], v[240:243], a[64:79]
 ds_read_b64_tr_b16 a[192:193], v4 offset:26112
 ds_read_b64_tr_b16 a[194:195], v4 offset:30464
 v_add_f32 v23, v23, v167
 v_cvt_pk_bf16_f32 v189, v166, v167
 v_accvgpr_read_b32 v174, a238
 v_accvgpr_read_b32 v175, a239
 v_mfma_f32_32x32x16_bf16 a[80:95], a[212:215], v[240:243], a[80:95]
 ds_read_b64_tr_b16 a[196:197], v4 offset:26176
 ds_read_b64_tr_b16 a[198:199], v4 offset:30528
 v_exp_f32 v174, v174
 v_add_f32 v22, v22, v172
 v_exp_f32 v175, v175
 s_waitcnt lgkmcnt(4)
 v_mfma_f32_32x32x16_bf16 a[96:111], a[216:219], v[240:243], a[96:111]
 ds_read_b64_tr_b16 a[200:201], v4 offset:26240
 ds_read_b64_tr_b16 a[202:203], v4 offset:30592
 v_add_f32 v23, v23, v173
 v_cvt_pk_bf16_f32 v190, v172, v173
 v_add_f32 v22, v22, v174
 v_add_f32 v23, v23, v175
 v_cvt_pk_bf16_f32 v191, v174, v175
 v_mfma_f32_32x32x16_bf16 a[112:127], a[220:223], v[240:243], a[112:127]
 ds_read_b64_tr_b16 a[204:205], v4 offset:26304
 ds_read_b64_tr_b16 a[206:207], v4 offset:30656
 v_accvgpr_read_b32 v164, a240
 v_accvgpr_read_b32 v165, a241
 v_exp_f32 v164, v164
 s_waitcnt lgkmcnt(4)
 v_mfma_f32_32x32x16_bf16 a[0:15], a[192:195], v[248:251], a[0:15]
 ds_read_b64_tr_b16 a[208:209], v4 offset:26368
 ds_read_b64_tr_b16 a[210:211], v4 offset:30720
 ds_read_b64_tr_b16 a[212:213], v4 offset:26432
 ds_read_b64_tr_b16 a[214:215], v4 offset:30784
 v_exp_f32 v165, v165
 v_accvgpr_read_b32 v166, a242
 v_mfma_f32_32x32x16_bf16 a[16:31], a[196:199], v[248:251], a[16:31]
 ds_read_b64_tr_b16 a[216:217], v4 offset:26496
 ds_read_b64_tr_b16 a[218:219], v4 offset:30848
 ds_read_b64_tr_b16 a[220:221], v4 offset:26560
 ds_read_b64_tr_b16 a[222:223], v4 offset:30912
 v_accvgpr_read_b32 v167, a243
 v_exp_f32 v166, v166
 s_waitcnt lgkmcnt(8)
 v_mfma_f32_32x32x16_bf16 a[32:47], a[200:203], v[248:251], a[32:47]
 v_add_f32 v22, v22, v164
 v_exp_f32 v167, v167
 v_add_f32 v23, v23, v165
 v_cvt_pk_bf16_f32 v196, v164, v165
 v_accvgpr_read_b32 v172, a244
 v_accvgpr_read_b32 v173, a245
 v_mfma_f32_32x32x16_bf16 a[48:63], a[204:207], v[248:251], a[48:63]
 v_exp_f32 v172, v172
 v_add_f32 v22, v22, v166
 v_exp_f32 v173, v173
 v_add_f32 v23, v23, v167
 v_cvt_pk_bf16_f32 v197, v166, v167
 s_waitcnt lgkmcnt(4)
 v_mfma_f32_32x32x16_bf16 a[64:79], a[208:211], v[248:251], a[64:79]
 s_waitcnt vmcnt(16) lgkmcnt(0)
 s_barrier
 s_add_u32 s30, s30, 16384
 s_add_u32 m0, s32, 0
 ds_read_b64_tr_b16 a[192:193], v4 offset:34816
 buffer_load_dwordx4 v15, s[16:19], s30 offen offset:0 lds
 ds_read_b64_tr_b16 a[194:195], v4 offset:39168
 v_mfma_f32_32x32x16_bf16 a[80:95], a[212:215], v[248:251], a[80:95]
 ds_read_b64_tr_b16 a[196:197], v4 offset:34880
 ds_read_b64_tr_b16 a[198:199], v4 offset:39232
 v_accvgpr_read_b32 v174, a246
 v_accvgpr_read_b32 v175, a247
 v_exp_f32 v174, v174
 v_add_f32 v22, v22, v172
 v_mfma_f32_32x32x16_bf16 a[96:111], a[216:219], v[248:251], a[96:111]
 ds_read_b64_tr_b16 a[200:201], v4 offset:34944
 ds_read_b64_tr_b16 a[202:203], v4 offset:39296
 v_exp_f32 v175, v175
 v_add_f32 v23, v23, v173
 v_cvt_pk_bf16_f32 v198, v172, v173
 v_add_f32 v22, v22, v174
 v_mfma_f32_32x32x16_bf16 a[112:127], a[220:223], v[248:251], a[112:127]
 s_add_u32 m0, s32, 576
 ds_read_b64_tr_b16 a[204:205], v4 offset:35008
 buffer_load_dwordx4 v15, s[16:19], s30 offen offset:512 lds
 ds_read_b64_tr_b16 a[206:207], v4 offset:39360
 v_add_f32 v23, v23, v175
 v_cvt_pk_bf16_f32 v199, v174, v175
 s_waitcnt lgkmcnt(4)
 v_mfma_f32_32x32x16_bf16 a[0:15], a[192:195], v[180:183], a[0:15]
 v_accvgpr_read_b32 v164, a248
 v_accvgpr_read_b32 v165, a249
 v_exp_f32 v164, v164
 v_exp_f32 v165, v165
 v_accvgpr_read_b32 v166, a250
 v_mfma_f32_32x32x16_bf16 a[16:31], a[196:199], v[180:183], a[16:31]
 ds_read_b64_tr_b16 a[208:209], v4 offset:35072
 ds_read_b64_tr_b16 a[210:211], v4 offset:39424
 v_accvgpr_read_b32 v167, a251
 v_exp_f32 v166, v166
 v_add_f32 v22, v22, v164
 s_waitcnt lgkmcnt(2)
 v_mfma_f32_32x32x16_bf16 a[32:47], a[200:203], v[180:183], a[32:47]
 s_add_u32 m0, s32, 1152
 ds_read_b64_tr_b16 a[212:213], v4 offset:35136
 buffer_load_dwordx4 v15, s[16:19], s30 offen offset:1024 lds
 ds_read_b64_tr_b16 a[214:215], v4 offset:39488
 v_exp_f32 v167, v167
 v_mfma_f32_32x32x16_bf16 a[48:63], a[204:207], v[180:183], a[48:63]
 ds_read_b64_tr_b16 a[216:217], v4 offset:35200
 ds_read_b64_tr_b16 a[218:219], v4 offset:39552
 v_add_f32 v23, v23, v165
 v_cvt_pk_bf16_f32 v204, v164, v165
 v_accvgpr_read_b32 v172, a252
 v_accvgpr_read_b32 v173, a253
 v_mfma_f32_32x32x16_bf16 v[48:63], a[144:147], v[28:31], v[48:63]
 ds_read_b64_tr_b16 a[220:221], v4 offset:35264
 ds_read_b64_tr_b16 a[222:223], v4 offset:39616
 v_exp_f32 v172, v172
 v_add_f32 v22, v22, v166
 v_exp_f32 v173, v173
 s_waitcnt lgkmcnt(4)
 v_mfma_f32_32x32x16_bf16 a[64:79], a[208:211], v[180:183], a[64:79]
 s_add_u32 m0, s32, 1728
 ds_read_b64_tr_b16 a[192:193], v4 offset:43520
 buffer_load_dwordx4 v15, s[16:19], s30 offen offset:1536 lds
 ds_read_b64_tr_b16 a[194:195], v4 offset:47872
 v_add_f32 v23, v23, v167
 v_cvt_pk_bf16_f32 v205, v166, v167
 v_mfma_f32_32x32x16_bf16 a[80:95], a[212:215], v[180:183], a[80:95]
 ds_read_b64_tr_b16 a[196:197], v4 offset:43584
 ds_read_b64_tr_b16 a[198:199], v4 offset:47936
 v_accvgpr_read_b32 v174, a254
 v_accvgpr_read_b32 v175, a255
 v_exp_f32 v174, v174
 v_add_f32 v22, v22, v172
 s_waitcnt lgkmcnt(4)
 v_mfma_f32_32x32x16_bf16 a[96:111], a[216:219], v[180:183], a[96:111]
 ds_read_b64_tr_b16 a[200:201], v4 offset:43648
 ds_read_b64_tr_b16 a[202:203], v4 offset:48000
 v_exp_f32 v175, v175
 v_add_f32 v23, v23, v173
 v_cvt_pk_bf16_f32 v206, v172, v173
 v_add_f32 v22, v22, v174
 v_mfma_f32_32x32x16_bf16 a[112:127], a[220:223], v[180:183], a[112:127]
 s_add_u32 s30, s30, 16384
 s_add_u32 m0, s32, 17408
 ds_read_b64_tr_b16 a[204:205], v4 offset:43712
 buffer_load_dwordx4 v15, s[16:19], s30 offen offset:0 lds
 ds_read_b64_tr_b16 a[206:207], v4 offset:48064
 v_add_f32 v23, v23, v175
 s_waitcnt lgkmcnt(4)
 v_mfma_f32_32x32x16_bf16 a[0:15], a[192:195], v[188:191], a[0:15]
 ds_read_b64_tr_b16 a[208:209], v4 offset:43776
 ds_read_b64_tr_b16 a[210:211], v4 offset:48128
 v_cvt_pk_bf16_f32 v207, v174, v175
 v_exp_f32 v32, v32
 v_exp_f32 v33, v33
 v_mfma_f32_32x32x16_bf16 a[16:31], a[196:199], v[188:191], a[16:31]
 ds_read_b64_tr_b16 a[212:213], v4 offset:43840
 ds_read_b64_tr_b16 a[214:215], v4 offset:48192
 v_exp_f32 v34, v34
 v_add_f32 v22, v22, v32
 v_exp_f32 v35, v35
 s_waitcnt lgkmcnt(4)
 v_mfma_f32_32x32x16_bf16 a[32:47], a[200:203], v[188:191], a[32:47]
 s_add_u32 m0, s32, 17984
 ds_read_b64_tr_b16 a[216:217], v4 offset:43904
 buffer_load_dwordx4 v15, s[16:19], s30 offen offset:512 lds
 ds_read_b64_tr_b16 a[218:219], v4 offset:48256
 v_add_f32 v23, v23, v33
 v_cvt_pk_bf16_f32 v32, v32, v33
 v_mfma_f32_32x32x16_bf16 a[48:63], a[204:207], v[188:191], a[48:63]
 ds_read_b64_tr_b16 a[220:221], v4 offset:43968
 ds_read_b64_tr_b16 a[222:223], v4 offset:48320
 v_exp_f32 v36, v36
 v_add_f32 v22, v22, v34
 v_exp_f32 v37, v37
 s_waitcnt lgkmcnt(4)
 v_mfma_f32_32x32x16_bf16 a[64:79], a[208:211], v[188:191], a[64:79]
 ds_read_b64_tr_b16 a[192:193], v5 offset:0
 ds_read_b64_tr_b16 a[194:195], v5 offset:4352
 v_add_f32 v23, v23, v35
 v_cvt_pk_bf16_f32 v33, v34, v35
 v_exp_f32 v38, v38
 v_add_f32 v22, v22, v36
 v_mfma_f32_32x32x16_bf16 a[80:95], a[212:215], v[188:191], a[80:95]
 s_add_u32 m0, s32, 18560
 ds_read_b64_tr_b16 a[196:197], v5 offset:64
 buffer_load_dwordx4 v15, s[16:19], s30 offen offset:1024 lds
 ds_read_b64_tr_b16 a[198:199], v5 offset:4416
 v_exp_f32 v39, v39
 s_waitcnt lgkmcnt(4)
 v_mfma_f32_32x32x16_bf16 a[96:111], a[216:219], v[188:191], a[96:111]
 ds_read_b64_tr_b16 a[200:201], v5 offset:128
 ds_read_b64_tr_b16 a[202:203], v5 offset:4480
 v_add_f32 v23, v23, v37
 v_cvt_pk_bf16_f32 v34, v36, v37
 v_add_f32 v22, v22, v38
 v_add_f32 v23, v23, v39
 v_cvt_pk_bf16_f32 v35, v38, v39
 v_mfma_f32_32x32x16_bf16 a[112:127], a[220:223], v[188:191], a[112:127]
 ds_read_b64_tr_b16 a[204:205], v5 offset:192
 ds_read_b64_tr_b16 a[206:207], v5 offset:4544
 v_exp_f32 v40, v40
 v_exp_f32 v41, v41
 s_waitcnt lgkmcnt(4)
 v_mfma_f32_32x32x16_bf16 a[0:15], a[192:195], v[196:199], a[0:15]
 s_add_u32 m0, s32, 19136
 s_nop 0
 buffer_load_dwordx4 v15, s[16:19], s30 offen offset:1536 lds
 v_exp_f32 v42, v42
 v_add_f32 v22, v22, v40
 v_mfma_f32_32x32x16_bf16 a[16:31], a[196:199], v[196:199], a[16:31]
 ds_read_b64_tr_b16 a[208:209], v5 offset:256
 ds_read_b64_tr_b16 a[210:211], v5 offset:4608
 v_exp_f32 v43, v43
 v_add_f32 v23, v23, v41
 v_cvt_pk_bf16_f32 v40, v40, v41
 s_waitcnt lgkmcnt(2)
 v_mfma_f32_32x32x16_bf16 a[32:47], a[200:203], v[196:199], a[32:47]
 ds_read_b64_tr_b16 a[212:213], v5 offset:320
 ds_read_b64_tr_b16 a[214:215], v5 offset:4672
 v_exp_f32 v44, v44
 v_add_f32 v22, v22, v42
 v_exp_f32 v45, v45
 v_mfma_f32_32x32x16_bf16 a[48:63], a[204:207], v[196:199], a[48:63]
 ds_read_b64_tr_b16 a[216:217], v5 offset:384
 ds_read_b64_tr_b16 a[218:219], v5 offset:4736
 v_add_f32 v23, v23, v43
 v_cvt_pk_bf16_f32 v41, v42, v43
 v_exp_f32 v46, v46
 v_add_f32 v22, v22, v44
 v_mfma_f32_32x32x16_bf16 v[64:79], a[144:147], v[28:31], v[64:79]
 ds_read_b64_tr_b16 a[220:221], v5 offset:448
 ds_read_b64_tr_b16 a[222:223], v5 offset:4800
 v_exp_f32 v47, v47
 v_add_f32 v23, v23, v45
 v_cvt_pk_bf16_f32 v42, v44, v45
 v_add_f32 v22, v22, v46
 s_waitcnt lgkmcnt(4)
 v_mfma_f32_32x32x16_bf16 a[64:79], a[208:211], v[196:199], a[64:79]
 ds_read_b64_tr_b16 a[192:193], v5 offset:8704
 ds_read_b64_tr_b16 a[194:195], v5 offset:13056
 v_add_f32 v23, v23, v47
 v_cvt_pk_bf16_f32 v43, v46, v47
 v_exp_f32 v48, v48
 v_mfma_f32_32x32x16_bf16 a[80:95], a[212:215], v[196:199], a[80:95]
 ds_read_b64_tr_b16 a[196:197], v5 offset:8768
 ds_read_b64_tr_b16 a[198:199], v5 offset:13120
 v_exp_f32 v49, v49
 v_exp_f32 v50, v50
 v_add_f32 v22, v22, v48
 s_waitcnt lgkmcnt(4)
 v_mfma_f32_32x32x16_bf16 a[96:111], a[216:219], v[196:199], a[96:111]
 ds_read_b64_tr_b16 a[200:201], v5 offset:8832
 ds_read_b64_tr_b16 a[202:203], v5 offset:13184
 v_exp_f32 v51, v51
 v_add_f32 v23, v23, v49
 v_cvt_pk_bf16_f32 v48, v48, v49
 v_mfma_f32_32x32x16_bf16 a[112:127], a[220:223], v[196:199], a[112:127]
 ds_read_b64_tr_b16 a[204:205], v5 offset:8896
 ds_read_b64_tr_b16 a[206:207], v5 offset:13248
 v_exp_f32 v52, v52
 v_add_f32 v22, v22, v50
 v_exp_f32 v53, v53
 s_waitcnt lgkmcnt(4)
 v_mfma_f32_32x32x16_bf16 a[0:15], a[192:195], v[204:207], a[0:15]
 ds_read_b64_tr_b16 a[208:209], v5 offset:8960
 ds_read_b64_tr_b16 a[210:211], v5 offset:13312
 ds_read_b64_tr_b16 a[212:213], v5 offset:9024
 ds_read_b64_tr_b16 a[214:215], v5 offset:13376
 v_add_f32 v23, v23, v51
 v_cvt_pk_bf16_f32 v49, v50, v51
 v_mfma_f32_32x32x16_bf16 a[16:31], a[196:199], v[204:207], a[16:31]
 ds_read_b64_tr_b16 a[216:217], v5 offset:9088
 ds_read_b64_tr_b16 a[218:219], v5 offset:13440
 ds_read_b64_tr_b16 a[220:221], v5 offset:9152
 ds_read_b64_tr_b16 a[222:223], v5 offset:13504
 v_exp_f32 v54, v54
 v_add_f32 v22, v22, v52
 s_waitcnt lgkmcnt(8)
 v_mfma_f32_32x32x16_bf16 a[32:47], a[200:203], v[204:207], a[32:47]
 v_exp_f32 v55, v55
 v_add_f32 v23, v23, v53
 v_cvt_pk_bf16_f32 v50, v52, v53
 v_add_f32 v22, v22, v54
 v_add_f32 v23, v23, v55
 v_cvt_pk_bf16_f32 v51, v54, v55
 v_mfma_f32_32x32x16_bf16 a[48:63], a[204:207], v[204:207], a[48:63]
 v_exp_f32 v56, v56
 v_exp_f32 v57, v57
 v_exp_f32 v58, v58
 v_add_f32 v22, v22, v56
 s_waitcnt lgkmcnt(4)
 v_mfma_f32_32x32x16_bf16 a[64:79], a[208:211], v[204:207], a[64:79]
 s_waitcnt vmcnt(16) lgkmcnt(0)
 s_barrier
 s_add_u32 s30, s30, 16384
 s_add_u32 m0, s32, 34816
 ds_read_b64_tr_b16 a[192:193], v5 offset:17408
 buffer_load_dwordx4 v15, s[16:19], s30 offen offset:0 lds
 ds_read_b64_tr_b16 a[194:195], v5 offset:21760
 v_mfma_f32_32x32x16_bf16 a[80:95], a[212:215], v[204:207], a[80:95]
 ds_read_b64_tr_b16 a[196:197], v5 offset:17472
 ds_read_b64_tr_b16 a[198:199], v5 offset:21824
 v_exp_f32 v59, v59
 v_add_f32 v23, v23, v57
 v_cvt_pk_bf16_f32 v56, v56, v57
 v_mfma_f32_32x32x16_bf16 a[96:111], a[216:219], v[204:207], a[96:111]
 ds_read_b64_tr_b16 a[200:201], v5 offset:17536
 ds_read_b64_tr_b16 a[202:203], v5 offset:21888
 v_exp_f32 v60, v60
 v_add_f32 v22, v22, v58
 v_exp_f32 v61, v61
 v_mfma_f32_32x32x16_bf16 a[112:127], a[220:223], v[204:207], a[112:127]
 s_add_u32 m0, s32, 35392
 ds_read_b64_tr_b16 a[204:205], v5 offset:17600
 buffer_load_dwordx4 v15, s[16:19], s30 offen offset:512 lds
 ds_read_b64_tr_b16 a[206:207], v5 offset:21952
 v_add_f32 v23, v23, v59
 v_cvt_pk_bf16_f32 v57, v58, v59
 s_waitcnt lgkmcnt(4)
 v_mfma_f32_32x32x16_bf16 a[0:15], a[192:195], v[32:35], a[0:15]
 v_exp_f32 v62, v62
 v_add_f32 v22, v22, v60
 v_exp_f32 v63, v63
 v_add_f32 v23, v23, v61
 v_cvt_pk_bf16_f32 v58, v60, v61
 v_mfma_f32_32x32x16_bf16 a[16:31], a[196:199], v[32:35], a[16:31]
 ds_read_b64_tr_b16 a[208:209], v5 offset:17664
 ds_read_b64_tr_b16 a[210:211], v5 offset:22016
 v_add_f32 v22, v22, v62
 v_add_f32 v23, v23, v63
 v_cvt_pk_bf16_f32 v59, v62, v63
 v_exp_f32 v64, v64
 s_waitcnt lgkmcnt(2)
 v_mfma_f32_32x32x16_bf16 a[32:47], a[200:203], v[32:35], a[32:47]
 s_add_u32 m0, s32, 35968
 ds_read_b64_tr_b16 a[212:213], v5 offset:17728
 buffer_load_dwordx4 v15, s[16:19], s30 offen offset:1024 lds
 ds_read_b64_tr_b16 a[214:215], v5 offset:22080
 v_exp_f32 v65, v65
 v_mfma_f32_32x32x16_bf16 a[48:63], a[204:207], v[32:35], a[48:63]
 ds_read_b64_tr_b16 a[216:217], v5 offset:17792
 ds_read_b64_tr_b16 a[218:219], v5 offset:22144
 v_exp_f32 v66, v66
 v_add_f32 v22, v22, v64
 v_exp_f32 v67, v67
 v_mfma_f32_32x32x16_bf16 v[80:95], a[144:147], v[28:31], v[80:95]
 ds_read_b64_tr_b16 a[220:221], v5 offset:17856
 ds_read_b64_tr_b16 a[222:223], v5 offset:22208
 v_add_f32 v23, v23, v65
 v_cvt_pk_bf16_f32 v64, v64, v65
 v_exp_f32 v68, v68
 v_add_f32 v22, v22, v66
 s_waitcnt lgkmcnt(4)
 v_mfma_f32_32x32x16_bf16 a[64:79], a[208:211], v[32:35], a[64:79]
 s_add_u32 m0, s32, 36544
 ds_read_b64_tr_b16 a[192:193], v5 offset:26112
 buffer_load_dwordx4 v15, s[16:19], s30 offen offset:1536 lds
 ds_read_b64_tr_b16 a[194:195], v5 offset:30464
 v_exp_f32 v69, v69
 v_mfma_f32_32x32x16_bf16 a[80:95], a[212:215], v[32:35], a[80:95]
 ds_read_b64_tr_b16 a[196:197], v5 offset:26176
 ds_read_b64_tr_b16 a[198:199], v5 offset:30528
 v_add_f32 v23, v23, v67
 v_cvt_pk_bf16_f32 v65, v66, v67
 v_exp_f32 v70, v70
 v_add_f32 v22, v22, v68
 s_waitcnt lgkmcnt(4)
 v_mfma_f32_32x32x16_bf16 a[96:111], a[216:219], v[32:35], a[96:111]
 ds_read_b64_tr_b16 a[200:201], v5 offset:26240
 ds_read_b64_tr_b16 a[202:203], v5 offset:30592
 v_exp_f32 v71, v71
 v_add_f32 v23, v23, v69
 v_cvt_pk_bf16_f32 v66, v68, v69
 v_add_f32 v22, v22, v70
 v_mfma_f32_32x32x16_bf16 a[112:127], a[220:223], v[32:35], a[112:127]
 s_add_u32 s30, s30, 16384
 s_add_u32 m0, s32, 52224
 ds_read_b64_tr_b16 a[204:205], v5 offset:26304
 buffer_load_dwordx4 v15, s[16:19], s30 offen offset:0 lds
 ds_read_b64_tr_b16 a[206:207], v5 offset:30656
 v_add_f32 v23, v23, v71
 s_waitcnt lgkmcnt(4)
 v_mfma_f32_32x32x16_bf16 a[0:15], a[192:195], v[40:43], a[0:15]
 ds_read_b64_tr_b16 a[208:209], v5 offset:26368
 ds_read_b64_tr_b16 a[210:211], v5 offset:30720
 v_cvt_pk_bf16_f32 v67, v70, v71
 v_exp_f32 v72, v72
 v_exp_f32 v73, v73
 v_mfma_f32_32x32x16_bf16 a[16:31], a[196:199], v[40:43], a[16:31]
 ds_read_b64_tr_b16 a[212:213], v5 offset:26432
 ds_read_b64_tr_b16 a[214:215], v5 offset:30784
 v_exp_f32 v74, v74
 v_add_f32 v22, v22, v72
 v_exp_f32 v75, v75
 s_waitcnt lgkmcnt(4)
 v_mfma_f32_32x32x16_bf16 a[32:47], a[200:203], v[40:43], a[32:47]
 s_add_u32 m0, s32, 52800
 ds_read_b64_tr_b16 a[216:217], v5 offset:26496
 buffer_load_dwordx4 v15, s[16:19], s30 offen offset:512 lds
 ds_read_b64_tr_b16 a[218:219], v5 offset:30848
 v_add_f32 v23, v23, v73
 v_cvt_pk_bf16_f32 v72, v72, v73
 v_mfma_f32_32x32x16_bf16 a[48:63], a[204:207], v[40:43], a[48:63]
 ds_read_b64_tr_b16 a[220:221], v5 offset:26560
 ds_read_b64_tr_b16 a[222:223], v5 offset:30912
 v_exp_f32 v76, v76
 v_add_f32 v22, v22, v74
 v_exp_f32 v77, v77
 s_waitcnt lgkmcnt(4)
 v_mfma_f32_32x32x16_bf16 a[64:79], a[208:211], v[40:43], a[64:79]
 ds_read_b64_tr_b16 a[192:193], v5 offset:34816
 ds_read_b64_tr_b16 a[194:195], v5 offset:39168
 v_add_f32 v23, v23, v75
 v_cvt_pk_bf16_f32 v73, v74, v75
 v_exp_f32 v78, v78
 v_add_f32 v22, v22, v76
 v_mfma_f32_32x32x16_bf16 a[80:95], a[212:215], v[40:43], a[80:95]
 s_add_u32 m0, s32, 53376
 ds_read_b64_tr_b16 a[196:197], v5 offset:34880
 buffer_load_dwordx4 v15, s[16:19], s30 offen offset:1024 lds
 ds_read_b64_tr_b16 a[198:199], v5 offset:39232
 v_exp_f32 v79, v79
 s_waitcnt lgkmcnt(4)
 v_mfma_f32_32x32x16_bf16 a[96:111], a[216:219], v[40:43], a[96:111]
 ds_read_b64_tr_b16 a[200:201], v5 offset:34944
 ds_read_b64_tr_b16 a[202:203], v5 offset:39296
 v_add_f32 v23, v23, v77
 v_cvt_pk_bf16_f32 v74, v76, v77
 v_add_f32 v22, v22, v78
 v_add_f32 v23, v23, v79
 v_cvt_pk_bf16_f32 v75, v78, v79
 v_mfma_f32_32x32x16_bf16 a[112:127], a[220:223], v[40:43], a[112:127]
 ds_read_b64_tr_b16 a[204:205], v5 offset:35008
 ds_read_b64_tr_b16 a[206:207], v5 offset:39360
 v_exp_f32 v80, v80
 v_exp_f32 v81, v81
 s_waitcnt lgkmcnt(4)
 v_mfma_f32_32x32x16_bf16 a[0:15], a[192:195], v[48:51], a[0:15]
 s_add_u32 m0, s32, 53952
 s_nop 0
 buffer_load_dwordx4 v15, s[16:19], s30 offen offset:1536 lds
 v_exp_f32 v82, v82
 v_add_f32 v22, v22, v80
 v_mfma_f32_32x32x16_bf16 a[16:31], a[196:199], v[48:51], a[16:31]
 ds_read_b64_tr_b16 a[208:209], v5 offset:35072
 ds_read_b64_tr_b16 a[210:211], v5 offset:39424
 v_exp_f32 v83, v83
 v_add_f32 v23, v23, v81
 v_cvt_pk_bf16_f32 v80, v80, v81
 s_waitcnt lgkmcnt(2)
 v_mfma_f32_32x32x16_bf16 a[32:47], a[200:203], v[48:51], a[32:47]
 ds_read_b64_tr_b16 a[212:213], v5 offset:35136
 ds_read_b64_tr_b16 a[214:215], v5 offset:39488
 v_exp_f32 v84, v84
 v_add_f32 v22, v22, v82
 v_exp_f32 v85, v85
 v_mfma_f32_32x32x16_bf16 a[48:63], a[204:207], v[48:51], a[48:63]
 ds_read_b64_tr_b16 a[216:217], v5 offset:35200
 ds_read_b64_tr_b16 a[218:219], v5 offset:39552
 v_add_f32 v23, v23, v83
 v_cvt_pk_bf16_f32 v81, v82, v83
 v_exp_f32 v86, v86
 v_add_f32 v22, v22, v84
 v_mfma_f32_32x32x16_bf16 v[96:111], a[144:147], v[28:31], v[96:111]
 ds_read_b64_tr_b16 a[220:221], v5 offset:35264
 ds_read_b64_tr_b16 a[222:223], v5 offset:39616
 v_exp_f32 v87, v87
 v_add_f32 v23, v23, v85
 v_cvt_pk_bf16_f32 v82, v84, v85
 v_add_f32 v22, v22, v86
 s_waitcnt lgkmcnt(4)
 v_mfma_f32_32x32x16_bf16 a[64:79], a[208:211], v[48:51], a[64:79]
 ds_read_b64_tr_b16 a[192:193], v5 offset:43520
 ds_read_b64_tr_b16 a[194:195], v5 offset:47872
 v_add_f32 v23, v23, v87
 v_cvt_pk_bf16_f32 v83, v86, v87
 v_exp_f32 v88, v88
 v_mfma_f32_32x32x16_bf16 a[80:95], a[212:215], v[48:51], a[80:95]
 ds_read_b64_tr_b16 a[196:197], v5 offset:43584
 ds_read_b64_tr_b16 a[198:199], v5 offset:47936
 v_exp_f32 v89, v89
 v_exp_f32 v90, v90
 v_add_f32 v22, v22, v88
 s_waitcnt lgkmcnt(4)
 v_mfma_f32_32x32x16_bf16 a[96:111], a[216:219], v[48:51], a[96:111]
 ds_read_b64_tr_b16 a[200:201], v5 offset:43648
 ds_read_b64_tr_b16 a[202:203], v5 offset:48000
 v_exp_f32 v91, v91
 v_add_f32 v23, v23, v89
 v_cvt_pk_bf16_f32 v88, v88, v89
 v_mfma_f32_32x32x16_bf16 a[112:127], a[220:223], v[48:51], a[112:127]
 ds_read_b64_tr_b16 a[204:205], v5 offset:43712
 ds_read_b64_tr_b16 a[206:207], v5 offset:48064
 v_exp_f32 v92, v92
 v_add_f32 v22, v22, v90
 v_exp_f32 v93, v93
 s_waitcnt lgkmcnt(4)
 v_mfma_f32_32x32x16_bf16 a[0:15], a[192:195], v[56:59], a[0:15]
 ds_read_b64_tr_b16 a[208:209], v5 offset:43776
 ds_read_b64_tr_b16 a[210:211], v5 offset:48128
 ds_read_b64_tr_b16 a[212:213], v5 offset:43840
 ds_read_b64_tr_b16 a[214:215], v5 offset:48192
 v_add_f32 v23, v23, v91
 v_cvt_pk_bf16_f32 v89, v90, v91
 v_mfma_f32_32x32x16_bf16 a[16:31], a[196:199], v[56:59], a[16:31]
 ds_read_b64_tr_b16 a[216:217], v5 offset:43904
 ds_read_b64_tr_b16 a[218:219], v5 offset:48256
 ds_read_b64_tr_b16 a[220:221], v5 offset:43968
 ds_read_b64_tr_b16 a[222:223], v5 offset:48320
 v_exp_f32 v94, v94
 v_add_f32 v22, v22, v92
 s_waitcnt lgkmcnt(8)
 v_mfma_f32_32x32x16_bf16 a[32:47], a[200:203], v[56:59], a[32:47]
 v_exp_f32 v95, v95
 v_add_f32 v23, v23, v93
 v_cvt_pk_bf16_f32 v90, v92, v93
 v_add_f32 v22, v22, v94
 v_add_f32 v23, v23, v95
 v_cvt_pk_bf16_f32 v91, v94, v95
 v_mfma_f32_32x32x16_bf16 a[48:63], a[204:207], v[56:59], a[48:63]
 v_exp_f32 v96, v96
 v_exp_f32 v97, v97
 v_exp_f32 v98, v98
 v_add_f32 v22, v22, v96
 s_waitcnt lgkmcnt(4)
 v_mfma_f32_32x32x16_bf16 a[64:79], a[208:211], v[56:59], a[64:79]
 s_waitcnt vmcnt(16) lgkmcnt(0)
 s_barrier
 s_add_u32 m0, s32, 69632
 ds_read_b64_tr_b16 a[192:193], v6 offset:0
 buffer_load_dwordx4 v16, s[20:23], s31 offen offset:0 lds
 ds_read_b64_tr_b16 a[194:195], v6 offset:4352
 v_mfma_f32_32x32x16_bf16 a[80:95], a[212:215], v[56:59], a[80:95]
 ds_read_b64_tr_b16 a[196:197], v6 offset:64
 ds_read_b64_tr_b16 a[198:199], v6 offset:4416
 v_exp_f32 v99, v99
 v_add_f32 v23, v23, v97
 v_cvt_pk_bf16_f32 v96, v96, v97
 v_mfma_f32_32x32x16_bf16 a[96:111], a[216:219], v[56:59], a[96:111]
 ds_read_b64_tr_b16 a[200:201], v6 offset:128
 ds_read_b64_tr_b16 a[202:203], v6 offset:4480
 v_exp_f32 v100, v100
 v_add_f32 v22, v22, v98
 v_exp_f32 v101, v101
 v_mfma_f32_32x32x16_bf16 a[112:127], a[220:223], v[56:59], a[112:127]
 s_add_u32 m0, s32, 69824
 ds_read_b64_tr_b16 a[204:205], v6 offset:192
 buffer_load_dwordx4 v16, s[20:23], s31 offen offset:896 lds
 ds_read_b64_tr_b16 a[206:207], v6 offset:4544
 v_add_f32 v23, v23, v99
 v_cvt_pk_bf16_f32 v97, v98, v99
 s_waitcnt lgkmcnt(4)
 v_mfma_f32_32x32x16_bf16 a[0:15], a[192:195], v[64:67], a[0:15]
 v_exp_f32 v102, v102
 v_add_f32 v22, v22, v100
 v_exp_f32 v103, v103
 v_add_f32 v23, v23, v101
 v_cvt_pk_bf16_f32 v98, v100, v101
 v_mfma_f32_32x32x16_bf16 a[16:31], a[196:199], v[64:67], a[16:31]
 ds_read_b64_tr_b16 a[208:209], v6 offset:256
 ds_read_b64_tr_b16 a[210:211], v6 offset:4608
 v_add_f32 v22, v22, v102
 v_add_f32 v23, v23, v103
 v_cvt_pk_bf16_f32 v99, v102, v103
 v_exp_f32 v104, v104
 s_waitcnt lgkmcnt(2)
 v_mfma_f32_32x32x16_bf16 a[32:47], a[200:203], v[64:67], a[32:47]
 s_add_u32 m0, s32, 70016
 ds_read_b64_tr_b16 a[212:213], v6 offset:320
 buffer_load_dwordx4 v16, s[20:23], s31 offen offset:1792 lds
 ds_read_b64_tr_b16 a[214:215], v6 offset:4672
 v_exp_f32 v105, v105
 v_mfma_f32_32x32x16_bf16 a[48:63], a[204:207], v[64:67], a[48:63]
 ds_read_b64_tr_b16 a[216:217], v6 offset:384
 ds_read_b64_tr_b16 a[218:219], v6 offset:4736
 v_exp_f32 v106, v106
 v_add_f32 v22, v22, v104
 v_exp_f32 v107, v107
 v_mfma_f32_32x32x16_bf16 v[112:127], a[144:147], v[28:31], v[112:127]
 ds_read_b64_tr_b16 a[220:221], v6 offset:448
 ds_read_b64_tr_b16 a[222:223], v6 offset:4800
 v_add_f32 v23, v23, v105
 v_cvt_pk_bf16_f32 v104, v104, v105
 v_exp_f32 v108, v108
 v_add_f32 v22, v22, v106
 s_waitcnt lgkmcnt(4)
 v_mfma_f32_32x32x16_bf16 a[64:79], a[208:211], v[64:67], a[64:79]
 s_add_u32 m0, s32, 70208
 ds_read_b64_tr_b16 a[192:193], v6 offset:8704
 buffer_load_dwordx4 v16, s[20:23], s31 offen offset:2688 lds
 ds_read_b64_tr_b16 a[194:195], v6 offset:13056
 v_exp_f32 v109, v109
 v_mfma_f32_32x32x16_bf16 a[80:95], a[212:215], v[64:67], a[80:95]
 ds_read_b64_tr_b16 a[196:197], v6 offset:8768
 ds_read_b64_tr_b16 a[198:199], v6 offset:13120
 v_add_f32 v23, v23, v107
 v_cvt_pk_bf16_f32 v105, v106, v107
 v_exp_f32 v110, v110
 v_add_f32 v22, v22, v108
 s_waitcnt lgkmcnt(4)
 v_mfma_f32_32x32x16_bf16 a[96:111], a[216:219], v[64:67], a[96:111]
 ds_read_b64_tr_b16 a[200:201], v6 offset:8832
 ds_read_b64_tr_b16 a[202:203], v6 offset:13184
 v_exp_f32 v111, v111
 v_add_f32 v23, v23, v109
 v_cvt_pk_bf16_f32 v106, v108, v109
 v_add_f32 v22, v22, v110
 v_mfma_f32_32x32x16_bf16 a[112:127], a[220:223], v[64:67], a[112:127]
 s_add_u32 m0, s32, 87040
 ds_read_b64_tr_b16 a[204:205], v6 offset:8896
 buffer_load_dwordx4 v16, s[20:23], s38 offen offset:0 lds
 ds_read_b64_tr_b16 a[206:207], v6 offset:13248
 v_add_f32 v23, v23, v111
 v_cvt_pk_bf16_f32 v107, v110, v111
 s_waitcnt lgkmcnt(4)
 v_mfma_f32_32x32x16_bf16 a[0:15], a[192:195], v[72:75], a[0:15]
 ds_read_b64_tr_b16 a[208:209], v6 offset:8960
 ds_read_b64_tr_b16 a[210:211], v6 offset:13312
 v_exp_f32 v112, v112
 v_exp_f32 v113, v113
 v_mfma_f32_32x32x16_bf16 a[16:31], a[196:199], v[72:75], a[16:31]
 ds_read_b64_tr_b16 a[212:213], v6 offset:9024
 ds_read_b64_tr_b16 a[214:215], v6 offset:13376
 v_exp_f32 v114, v114
 v_add_f32 v22, v22, v112
 v_exp_f32 v115, v115
 s_waitcnt lgkmcnt(4)
 v_mfma_f32_32x32x16_bf16 a[32:47], a[200:203], v[72:75], a[32:47]
 s_add_u32 m0, s32, 87232
 ds_read_b64_tr_b16 a[216:217], v6 offset:9088
 buffer_load_dwordx4 v16, s[20:23], s38 offen offset:896 lds
 ds_read_b64_tr_b16 a[218:219], v6 offset:13440
 v_add_f32 v23, v23, v113
 v_cvt_pk_bf16_f32 v112, v112, v113
 v_mfma_f32_32x32x16_bf16 a[48:63], a[204:207], v[72:75], a[48:63]
 ds_read_b64_tr_b16 a[220:221], v6 offset:9152
 ds_read_b64_tr_b16 a[222:223], v6 offset:13504
 v_exp_f32 v116, v116
 v_add_f32 v22, v22, v114
 v_exp_f32 v117, v117
 s_waitcnt lgkmcnt(4)
 v_mfma_f32_32x32x16_bf16 a[64:79], a[208:211], v[72:75], a[64:79]
 ds_read_b64_tr_b16 a[192:193], v6 offset:17408
 ds_read_b64_tr_b16 a[194:195], v6 offset:21760
 v_add_f32 v23, v23, v115
 v_cvt_pk_bf16_f32 v113, v114, v115
 v_exp_f32 v118, v118
 v_add_f32 v22, v22, v116
 v_mfma_f32_32x32x16_bf16 a[80:95], a[212:215], v[72:75], a[80:95]
 s_add_u32 m0, s32, 87424
 ds_read_b64_tr_b16 a[196:197], v6 offset:17472
 buffer_load_dwordx4 v16, s[20:23], s38 offen offset:1792 lds
 ds_read_b64_tr_b16 a[198:199], v6 offset:21824
 v_exp_f32 v119, v119
 s_waitcnt lgkmcnt(4)
 v_mfma_f32_32x32x16_bf16 a[96:111], a[216:219], v[72:75], a[96:111]
 ds_read_b64_tr_b16 a[200:201], v6 offset:17536
 ds_read_b64_tr_b16 a[202:203], v6 offset:21888
 v_add_f32 v23, v23, v117
 v_cvt_pk_bf16_f32 v114, v116, v117
 v_add_f32 v22, v22, v118
 v_add_f32 v23, v23, v119
 v_cvt_pk_bf16_f32 v115, v118, v119
 v_mfma_f32_32x32x16_bf16 a[112:127], a[220:223], v[72:75], a[112:127]
 ds_read_b64_tr_b16 a[204:205], v6 offset:17600
 ds_read_b64_tr_b16 a[206:207], v6 offset:21952
 v_exp_f32 v120, v120
 v_exp_f32 v121, v121
 s_waitcnt lgkmcnt(4)
 v_mfma_f32_32x32x16_bf16 a[0:15], a[192:195], v[80:83], a[0:15]
 s_add_u32 m0, s32, 87616
 s_nop 0
 buffer_load_dwordx4 v16, s[20:23], s38 offen offset:2688 lds
 v_exp_f32 v122, v122
 v_add_f32 v22, v22, v120
 v_mfma_f32_32x32x16_bf16 a[16:31], a[196:199], v[80:83], a[16:31]
 ds_read_b64_tr_b16 a[208:209], v6 offset:17664
 ds_read_b64_tr_b16 a[210:211], v6 offset:22016
 v_exp_f32 v123, v123
 v_add_f32 v23, v23, v121
 v_cvt_pk_bf16_f32 v120, v120, v121
 s_waitcnt lgkmcnt(2)
 v_mfma_f32_32x32x16_bf16 a[32:47], a[200:203], v[80:83], a[32:47]
 ds_read_b64_tr_b16 a[212:213], v6 offset:17728
 ds_read_b64_tr_b16 a[214:215], v6 offset:22080
 v_exp_f32 v124, v124
 v_add_f32 v22, v22, v122
 v_exp_f32 v125, v125
 v_mfma_f32_32x32x16_bf16 a[48:63], a[204:207], v[80:83], a[48:63]
 ds_read_b64_tr_b16 a[216:217], v6 offset:17792
 ds_read_b64_tr_b16 a[218:219], v6 offset:22144
 v_add_f32 v23, v23, v123
 v_cvt_pk_bf16_f32 v121, v122, v123
 v_exp_f32 v126, v126
 v_add_f32 v22, v22, v124
 v_mfma_f32_32x32x16_bf16 v[128:143], a[144:147], v[28:31], v[128:143]
 ds_read_b64_tr_b16 a[220:221], v6 offset:17856
 ds_read_b64_tr_b16 a[222:223], v6 offset:22208
 v_exp_f32 v127, v127
 v_add_f32 v23, v23, v125
 v_cvt_pk_bf16_f32 v122, v124, v125
 v_add_f32 v22, v22, v126
 s_waitcnt lgkmcnt(4)
 v_mfma_f32_32x32x16_bf16 a[64:79], a[208:211], v[80:83], a[64:79]
 ds_read_b64_tr_b16 a[192:193], v6 offset:26112
 ds_read_b64_tr_b16 a[194:195], v6 offset:30464
 v_add_f32 v23, v23, v127
 v_cvt_pk_bf16_f32 v123, v126, v127
 v_mfma_f32_32x32x16_bf16 a[80:95], a[212:215], v[80:83], a[80:95]
 ds_read_b64_tr_b16 a[196:197], v6 offset:26176
 ds_read_b64_tr_b16 a[198:199], v6 offset:30528
 v_exp_f32 v128, v128
 v_exp_f32 v129, v129
 s_waitcnt lgkmcnt(4)
 v_mfma_f32_32x32x16_bf16 a[96:111], a[216:219], v[80:83], a[96:111]
 ds_read_b64_tr_b16 a[200:201], v6 offset:26240
 ds_read_b64_tr_b16 a[202:203], v6 offset:30592
 v_exp_f32 v130, v130
 v_add_f32 v22, v22, v128
 v_exp_f32 v131, v131
 v_mfma_f32_32x32x16_bf16 a[112:127], a[220:223], v[80:83], a[112:127]
 ds_read_b64_tr_b16 a[204:205], v6 offset:26304
 ds_read_b64_tr_b16 a[206:207], v6 offset:30656
 v_add_f32 v23, v23, v129
 v_cvt_pk_bf16_f32 v128, v128, v129
 v_exp_f32 v132, v132
 v_add_f32 v22, v22, v130
 s_waitcnt lgkmcnt(4)
 v_mfma_f32_32x32x16_bf16 a[0:15], a[192:195], v[88:91], a[0:15]
 ds_read_b64_tr_b16 a[208:209], v6 offset:26368
 ds_read_b64_tr_b16 a[210:211], v6 offset:30720
 ds_read_b64_tr_b16 a[212:213], v6 offset:26432
 ds_read_b64_tr_b16 a[214:215], v6 offset:30784
 v_exp_f32 v133, v133
 v_add_f32 v23, v23, v131
 v_mfma_f32_32x32x16_bf16 a[16:31], a[196:199], v[88:91], a[16:31]
 ds_read_b64_tr_b16 a[216:217], v6 offset:26496
 ds_read_b64_tr_b16 a[218:219], v6 offset:30848
 ds_read_b64_tr_b16 a[220:221], v6 offset:26560
 ds_read_b64_tr_b16 a[222:223], v6 offset:30912
 v_cvt_pk_bf16_f32 v129, v130, v131
 v_exp_f32 v134, v134
 s_waitcnt lgkmcnt(8)
 v_mfma_f32_32x32x16_bf16 a[32:47], a[200:203], v[88:91], a[32:47]
 v_add_f32 v22, v22, v132
 v_exp_f32 v135, v135
 v_add_f32 v23, v23, v133
 v_cvt_pk_bf16_f32 v130, v132, v133
 v_add_f32 v22, v22, v134
 v_add_f32 v23, v23, v135
 v_mfma_f32_32x32x16_bf16 a[48:63], a[204:207], v[88:91], a[48:63]
 v_cvt_pk_bf16_f32 v131, v134, v135
 v_exp_f32 v136, v136
 v_exp_f32 v137, v137
 v_exp_f32 v138, v138
 s_waitcnt lgkmcnt(4)
 v_mfma_f32_32x32x16_bf16 a[64:79], a[208:211], v[88:91], a[64:79]
 s_waitcnt vmcnt(16) lgkmcnt(0)
 s_barrier
 s_add_u32 s31, s31, 14336
 s_add_u32 m0, s32, 104448
 ds_read_b64_tr_b16 a[192:193], v4 offset:0
 buffer_load_dwordx4 v16, s[20:23], s31 offen offset:0 lds
 ds_read_b64_tr_b16 a[194:195], v4 offset:4352
 v_mfma_f32_32x32x16_bf16 a[80:95], a[212:215], v[88:91], a[80:95]
 ds_read_b64_tr_b16 a[196:197], v4 offset:64
 ds_read_b64_tr_b16 a[198:199], v4 offset:4416
 v_add_f32 v22, v22, v136
 v_exp_f32 v139, v139
 v_add_f32 v23, v23, v137
 v_cvt_pk_bf16_f32 v136, v136, v137
 v_mfma_f32_32x32x16_bf16 a[96:111], a[216:219], v[88:91], a[96:111]
 ds_read_b64_tr_b16 a[200:201], v4 offset:128
 ds_read_b64_tr_b16 a[202:203], v4 offset:4480
 v_exp_f32 v140, v140
 v_add_f32 v22, v22, v138
 v_exp_f32 v141, v141
 v_mfma_f32_32x32x16_bf16 a[112:127], a[220:223], v[88:91], a[112:127]
 s_add_u32 m0, s32, 104640
 ds_read_b64_tr_b16 a[204:205], v4 offset:192
 buffer_load_dwordx4 v16, s[20:23], s31 offen offset:896 lds
 ds_read_b64_tr_b16 a[206:207], v4 offset:4544
 v_add_f32 v23, v23, v139
 v_cvt_pk_bf16_f32 v137, v138, v139
 s_waitcnt lgkmcnt(4)
 v_mfma_f32_32x32x16_bf16 a[0:15], a[192:195], v[96:99], a[0:15]
 v_exp_f32 v142, v142
 v_add_f32 v22, v22, v140
 v_exp_f32 v143, v143
 v_add_f32 v23, v23, v141
 v_cvt_pk_bf16_f32 v138, v140, v141
 v_mfma_f32_32x32x16_bf16 a[16:31], a[196:199], v[96:99], a[16:31]
 ds_read_b64_tr_b16 a[208:209], v4 offset:256
 ds_read_b64_tr_b16 a[210:211], v4 offset:4608
 v_add_f32 v22, v22, v142
 v_add_f32 v23, v23, v143
 v_cvt_pk_bf16_f32 v139, v142, v143
 s_waitcnt lgkmcnt(2)
 v_mfma_f32_32x32x16_bf16 a[32:47], a[200:203], v[96:99], a[32:47]
 s_add_u32 m0, s32, 104832
 ds_read_b64_tr_b16 a[212:213], v4 offset:320
 buffer_load_dwordx4 v16, s[20:23], s31 offen offset:1792 lds
 ds_read_b64_tr_b16 a[214:215], v4 offset:4672
 v_mfma_f32_32x32x16_bf16 a[48:63], a[204:207], v[96:99], a[48:63]
 ds_read_b64_tr_b16 a[216:217], v4 offset:384
 ds_read_b64_tr_b16 a[218:219], v4 offset:4736
 v_mfma_f32_32x32x16_bf16 v[144:159], a[144:147], v[28:31], v[144:159]
 ds_read_b64_tr_b16 a[220:221], v4 offset:448
 ds_read_b64_tr_b16 a[222:223], v4 offset:4800
 s_waitcnt lgkmcnt(4)
 v_mfma_f32_32x32x16_bf16 a[64:79], a[208:211], v[96:99], a[64:79]
 s_add_u32 m0, s32, 105024
 ds_read_b64_tr_b16 a[192:193], v4 offset:8704
 buffer_load_dwordx4 v16, s[20:23], s31 offen offset:2688 lds
 ds_read_b64_tr_b16 a[194:195], v4 offset:13056
 v_mfma_f32_32x32x16_bf16 a[80:95], a[212:215], v[96:99], a[80:95]
 ds_read_b64_tr_b16 a[196:197], v4 offset:8768
 ds_read_b64_tr_b16 a[198:199], v4 offset:13120
 s_nop 0
 v_exp_f32 v144, v144
 v_exp_f32 v145, v145
 s_waitcnt lgkmcnt(4)
 v_mfma_f32_32x32x16_bf16 a[96:111], a[216:219], v[96:99], a[96:111]
 ds_read_b64_tr_b16 a[200:201], v4 offset:8832
 ds_read_b64_tr_b16 a[202:203], v4 offset:13184
 v_exp_f32 v146, v146
 v_add_f32 v22, v22, v144
 v_exp_f32 v147, v147
 v_mfma_f32_32x32x16_bf16 a[112:127], a[220:223], v[96:99], a[112:127]
 s_add_u32 s38, s38, 14336
 s_add_u32 m0, s32, 121856
 ds_read_b64_tr_b16 a[204:205], v4 offset:8896
 buffer_load_dwordx4 v16, s[20:23], s38 offen offset:0 lds
 ds_read_b64_tr_b16 a[206:207], v4 offset:13248
 v_add_f32 v23, v23, v145
 s_waitcnt lgkmcnt(4)
 v_mfma_f32_32x32x16_bf16 a[0:15], a[192:195], v[104:107], a[0:15]
 ds_read_b64_tr_b16 a[208:209], v4 offset:8960
 ds_read_b64_tr_b16 a[210:211], v4 offset:13312
 v_cvt_pk_bf16_f32 v144, v144, v145
 v_exp_f32 v148, v148
 v_add_f32 v22, v22, v146
 v_mfma_f32_32x32x16_bf16 a[16:31], a[196:199], v[104:107], a[16:31]
 ds_read_b64_tr_b16 a[212:213], v4 offset:9024
 ds_read_b64_tr_b16 a[214:215], v4 offset:13376
 v_exp_f32 v149, v149
 v_add_f32 v23, v23, v147
 v_cvt_pk_bf16_f32 v145, v146, v147
 s_waitcnt lgkmcnt(4)
 v_mfma_f32_32x32x16_bf16 a[32:47], a[200:203], v[104:107], a[32:47]
 s_add_u32 m0, s32, 122048
 ds_read_b64_tr_b16 a[216:217], v4 offset:9088
 buffer_load_dwordx4 v16, s[20:23], s38 offen offset:896 lds
 ds_read_b64_tr_b16 a[218:219], v4 offset:13440
 v_exp_f32 v150, v150
 v_mfma_f32_32x32x16_bf16 a[48:63], a[204:207], v[104:107], a[48:63]
 ds_read_b64_tr_b16 a[220:221], v4 offset:9152
 ds_read_b64_tr_b16 a[222:223], v4 offset:13504
 v_add_f32 v22, v22, v148
 v_exp_f32 v151, v151
 v_add_f32 v23, v23, v149
 v_cvt_pk_bf16_f32 v146, v148, v149
 s_waitcnt lgkmcnt(4)
 v_mfma_f32_32x32x16_bf16 a[64:79], a[208:211], v[104:107], a[64:79]
 ds_read_b64_tr_b16 a[192:193], v4 offset:17408
 ds_read_b64_tr_b16 a[194:195], v4 offset:21760
 v_add_f32 v22, v22, v150
 v_add_f32 v23, v23, v151
 v_cvt_pk_bf16_f32 v147, v150, v151
 v_exp_f32 v152, v152
 v_mfma_f32_32x32x16_bf16 a[80:95], a[212:215], v[104:107], a[80:95]
 s_add_u32 m0, s32, 122240
 ds_read_b64_tr_b16 a[196:197], v4 offset:17472
 buffer_load_dwordx4 v16, s[20:23], s38 offen offset:1792 lds
 ds_read_b64_tr_b16 a[198:199], v4 offset:21824
 v_exp_f32 v153, v153
 s_waitcnt lgkmcnt(4)
 v_mfma_f32_32x32x16_bf16 a[96:111], a[216:219], v[104:107], a[96:111]
 ds_read_b64_tr_b16 a[200:201], v4 offset:17536
 ds_read_b64_tr_b16 a[202:203], v4 offset:21888
 v_exp_f32 v154, v154
 v_add_f32 v22, v22, v152
 v_exp_f32 v155, v155
 v_mfma_f32_32x32x16_bf16 a[112:127], a[220:223], v[104:107], a[112:127]
 ds_read_b64_tr_b16 a[204:205], v4 offset:17600
 ds_read_b64_tr_b16 a[206:207], v4 offset:21952
 v_add_f32 v23, v23, v153
 v_cvt_pk_bf16_f32 v152, v152, v153
 v_exp_f32 v156, v156
 v_add_f32 v22, v22, v154
 s_waitcnt lgkmcnt(4)
 v_mfma_f32_32x32x16_bf16 a[0:15], a[192:195], v[112:115], a[0:15]
 s_add_u32 m0, s32, 122432
 ds_read_b64_tr_b16 a[208:209], v4 offset:17664
 buffer_load_dwordx4 v16, s[20:23], s38 offen offset:2688 lds
 ds_read_b64_tr_b16 a[210:211], v4 offset:22016
 v_exp_f32 v157, v157
 v_mfma_f32_32x32x16_bf16 a[16:31], a[196:199], v[112:115], a[16:31]
 ds_read_b64_tr_b16 a[212:213], v4 offset:17728
 ds_read_b64_tr_b16 a[214:215], v4 offset:22080
 v_add_f32 v23, v23, v155
 v_cvt_pk_bf16_f32 v153, v154, v155
 v_exp_f32 v158, v158
 v_add_f32 v22, v22, v156
 s_waitcnt lgkmcnt(4)
 v_mfma_f32_32x32x16_bf16 a[32:47], a[200:203], v[112:115], a[32:47]
 ds_read_b64_tr_b16 a[216:217], v4 offset:17792
 ds_read_b64_tr_b16 a[218:219], v4 offset:22144
 v_exp_f32 v159, v159
 v_add_f32 v23, v23, v157
 v_cvt_pk_bf16_f32 v154, v156, v157
 v_add_f32 v22, v22, v158
 v_mfma_f32_32x32x16_bf16 a[48:63], a[204:207], v[112:115], a[48:63]
 ds_read_b64_tr_b16 a[220:221], v4 offset:17856
 ds_read_b64_tr_b16 a[222:223], v4 offset:22208
 v_add_f32 v23, v23, v159
 v_cvt_pk_bf16_f32 v155, v158, v159
 v_add_f32 v22, v22, v23
 v_mov_b32 v27, v22
 s_nop 1
 v_permlane32_swap_b32 v22, v27
 s_waitcnt lgkmcnt(4)
 v_mfma_f32_32x32x16_bf16 a[64:79], a[208:211], v[112:115], a[64:79]
 ds_read_b64_tr_b16 a[192:193], v4 offset:26112
 ds_read_b64_tr_b16 a[194:195], v4 offset:30464
 v_add_f32 v22, v22, v27
 v_rcp_f32 v26, v22
 v_mfma_f32_32x32x16_bf16 a[80:95], a[212:215], v[112:115], a[80:95]
 ds_read_b64_tr_b16 a[196:197], v4 offset:26176
 ds_read_b64_tr_b16 a[198:199], v4 offset:30528
 s_waitcnt lgkmcnt(4)
 v_mfma_f32_32x32x16_bf16 a[96:111], a[216:219], v[112:115], a[96:111]
 ds_read_b64_tr_b16 a[200:201], v4 offset:26240
 ds_read_b64_tr_b16 a[202:203], v4 offset:30592
 v_mfma_f32_32x32x16_bf16 a[112:127], a[220:223], v[112:115], a[112:127]
 ds_read_b64_tr_b16 a[204:205], v4 offset:26304
 ds_read_b64_tr_b16 a[206:207], v4 offset:30656
 s_waitcnt lgkmcnt(4)
 v_mfma_f32_32x32x16_bf16 a[0:15], a[192:195], v[120:123], a[0:15]
 ds_read_b64_tr_b16 a[208:209], v4 offset:26368
 ds_read_b64_tr_b16 a[210:211], v4 offset:30720
 ds_read_b64_tr_b16 a[212:213], v4 offset:26432
 ds_read_b64_tr_b16 a[214:215], v4 offset:30784
 v_mfma_f32_32x32x16_bf16 a[16:31], a[196:199], v[120:123], a[16:31]
 ds_read_b64_tr_b16 a[216:217], v4 offset:26496
 ds_read_b64_tr_b16 a[218:219], v4 offset:30848
 ds_read_b64_tr_b16 a[220:221], v4 offset:26560
 ds_read_b64_tr_b16 a[222:223], v4 offset:30912
 s_waitcnt lgkmcnt(8)
 v_mfma_f32_32x32x16_bf16 a[32:47], a[200:203], v[120:123], a[32:47]
 v_mfma_f32_32x32x16_bf16 a[48:63], a[204:207], v[120:123], a[48:63]
 s_waitcnt lgkmcnt(4)
 v_mfma_f32_32x32x16_bf16 a[64:79], a[208:211], v[120:123], a[64:79]
 s_waitcnt vmcnt(16) lgkmcnt(0)
 s_barrier
 s_add_u32 s31, s31, 14336
 s_add_u32 m0, s32, 0
 ds_read_b64_tr_b16 a[192:193], v4 offset:34816
 buffer_load_dwordx4 v16, s[20:23], s31 offen offset:0 lds
 ds_read_b64_tr_b16 a[194:195], v4 offset:39168
 v_mfma_f32_32x32x16_bf16 a[80:95], a[212:215], v[120:123], a[80:95]
 ds_read_b64_tr_b16 a[196:197], v4 offset:43520
 ds_read_b64_tr_b16 a[198:199], v4 offset:47872
 v_mfma_f32_32x32x16_bf16 a[96:111], a[216:219], v[120:123], a[96:111]
 ds_read_b64_tr_b16 a[200:201], v5 offset:0
 ds_read_b64_tr_b16 a[202:203], v5 offset:4352
 v_mfma_f32_32x32x16_bf16 a[112:127], a[220:223], v[120:123], a[112:127]
 s_add_u32 m0, s32, 192
 ds_read_b64_tr_b16 a[204:205], v5 offset:8704
 buffer_load_dwordx4 v16, s[20:23], s31 offen offset:896 lds
 ds_read_b64_tr_b16 a[206:207], v5 offset:13056
 s_waitcnt lgkmcnt(4)
 v_mfma_f32_32x32x16_bf16 a[0:15], a[192:195], v[128:131], a[0:15]
 ds_read_b64_tr_b16 a[208:209], v4 offset:34880
 ds_read_b64_tr_b16 a[210:211], v4 offset:39232
 v_mfma_f32_32x32x16_bf16 a[0:15], a[196:199], v[136:139], a[0:15]
 ds_read_b64_tr_b16 a[212:213], v4 offset:43584
 ds_read_b64_tr_b16 a[214:215], v4 offset:47936
 s_waitcnt lgkmcnt(4)
 v_mfma_f32_32x32x16_bf16 a[0:15], a[200:203], v[144:147], a[0:15]
 s_add_u32 m0, s32, 384
 ds_read_b64_tr_b16 a[216:217], v5 offset:64
 buffer_load_dwordx4 v16, s[20:23], s31 offen offset:1792 lds
 ds_read_b64_tr_b16 a[218:219], v5 offset:4416
 v_mfma_f32_32x32x16_bf16 a[0:15], a[204:207], v[152:155], a[0:15]
 ds_read_b64_tr_b16 a[220:221], v5 offset:8768
 ds_read_b64_tr_b16 a[222:223], v5 offset:13120
 s_waitcnt lgkmcnt(4)
 v_mfma_f32_32x32x16_bf16 a[16:31], a[208:211], v[128:131], a[16:31]
 ds_read_b64_tr_b16 a[192:193], v4 offset:34944
 ds_read_b64_tr_b16 a[194:195], v4 offset:39296
 v_mfma_f32_32x32x16_bf16 a[16:31], a[212:215], v[136:139], a[16:31]
 s_add_u32 m0, s32, 576
 ds_read_b64_tr_b16 a[196:197], v4 offset:43648
 buffer_load_dwordx4 v16, s[20:23], s31 offen offset:2688 lds
 ds_read_b64_tr_b16 a[198:199], v4 offset:48000
 s_waitcnt lgkmcnt(4)
 v_mfma_f32_32x32x16_bf16 a[16:31], a[216:219], v[144:147], a[16:31]
 ds_read_b64_tr_b16 a[200:201], v5 offset:128
 ds_read_b64_tr_b16 a[202:203], v5 offset:4480
 v_accvgpr_read_b32 v27, a0
 v_accvgpr_read_b32 v28, a1
 v_mul_f32 v27, v27, v26
 v_mul_f32 v28, v28, v26
 v_cvt_pk_bf16_f32 v160, v27, v28
 v_mfma_f32_32x32x16_bf16 a[16:31], a[220:223], v[152:155], a[16:31]
 ds_read_b64_tr_b16 a[204:205], v5 offset:8832
 ds_read_b64_tr_b16 a[206:207], v5 offset:13184
 v_accvgpr_read_b32 v29, a2
 v_accvgpr_read_b32 v30, a3
 v_mul_f32 v29, v29, v26
 v_mul_f32 v30, v30, v26
 v_cvt_pk_bf16_f32 v161, v29, v30
 s_waitcnt lgkmcnt(4)
 v_mfma_f32_32x32x16_bf16 a[32:47], a[192:195], v[128:131], a[32:47]
 s_add_u32 s38, s38, 14336
 s_add_u32 m0, s32, 17408
 ds_read_b64_tr_b16 a[208:209], v4 offset:35008
 buffer_load_dwordx4 v16, s[20:23], s38 offen offset:0 lds
 ds_read_b64_tr_b16 a[210:211], v4 offset:39360
 v_accvgpr_read_b32 v27, a4
 v_mfma_f32_32x32x16_bf16 a[32:47], a[196:199], v[136:139], a[32:47]
 ds_read_b64_tr_b16 a[212:213], v4 offset:43712
 ds_read_b64_tr_b16 a[214:215], v4 offset:48064
 v_accvgpr_read_b32 v28, a5
 v_mul_f32 v27, v27, v26
 v_mul_f32 v28, v28, v26
 v_cvt_pk_bf16_f32 v162, v27, v28
 v_accvgpr_read_b32 v29, a6
 s_waitcnt lgkmcnt(4)
 v_mfma_f32_32x32x16_bf16 a[32:47], a[200:203], v[144:147], a[32:47]
 ds_read_b64_tr_b16 a[216:217], v5 offset:192
 ds_read_b64_tr_b16 a[218:219], v5 offset:4544
 v_accvgpr_read_b32 v30, a7
 v_mul_f32 v29, v29, v26
 v_mul_f32 v30, v30, v26
 v_cvt_pk_bf16_f32 v163, v29, v30
 v_accvgpr_read_b32 v27, a8
 v_mfma_f32_32x32x16_bf16 a[32:47], a[204:207], v[152:155], a[32:47]
 s_add_u32 m0, s32, 17600
 ds_read_b64_tr_b16 a[220:221], v5 offset:8896
 buffer_load_dwordx4 v16, s[20:23], s38 offen offset:896 lds
 ds_read_b64_tr_b16 a[222:223], v5 offset:13248
 ds_write_b128 v17, v[160:163] offset:0
 s_waitcnt lgkmcnt(5)
 v_mfma_f32_32x32x16_bf16 a[48:63], a[208:211], v[128:131], a[48:63]
 ds_read_b64_tr_b16 a[192:193], v4 offset:35072
 ds_read_b64_tr_b16 a[194:195], v4 offset:39424
 v_accvgpr_read_b32 v28, a9
 v_mul_f32 v27, v27, v26
 v_mul_f32 v28, v28, v26
 v_cvt_pk_bf16_f32 v164, v27, v28
 v_accvgpr_read_b32 v29, a10
 v_mfma_f32_32x32x16_bf16 a[48:63], a[212:215], v[136:139], a[48:63]
 ds_read_b64_tr_b16 a[196:197], v4 offset:43776
 ds_read_b64_tr_b16 a[198:199], v4 offset:48128
 v_accvgpr_read_b32 v30, a11
 v_mul_f32 v29, v29, v26
 v_mul_f32 v30, v30, v26
 v_cvt_pk_bf16_f32 v165, v29, v30
 v_accvgpr_read_b32 v27, a12
 s_waitcnt lgkmcnt(5)
 v_mfma_f32_32x32x16_bf16 a[48:63], a[216:219], v[144:147], a[48:63]
 s_add_u32 m0, s32, 17792
 ds_read_b64_tr_b16 a[200:201], v5 offset:256
 buffer_load_dwordx4 v16, s[20:23], s38 offen offset:1792 lds
 ds_read_b64_tr_b16 a[202:203], v5 offset:4608
 v_accvgpr_read_b32 v28, a13
 v_mul_f32 v27, v27, v26
 v_mfma_f32_32x32x16_bf16 a[48:63], a[220:223], v[152:155], a[48:63]
 ds_read_b64_tr_b16 a[204:205], v5 offset:8960
 ds_read_b64_tr_b16 a[206:207], v5 offset:13312
 v_mul_f32 v28, v28, v26
 v_cvt_pk_bf16_f32 v166, v27, v28
 v_accvgpr_read_b32 v29, a14
 v_accvgpr_read_b32 v30, a15
 v_mul_f32 v29, v29, v26
 s_waitcnt lgkmcnt(4)
 v_mfma_f32_32x32x16_bf16 a[64:79], a[192:195], v[128:131], a[64:79]
 ds_read_b64_tr_b16 a[208:209], v4 offset:35136
 ds_read_b64_tr_b16 a[210:211], v4 offset:39488
 v_mul_f32 v30, v30, v26
 v_cvt_pk_bf16_f32 v167, v29, v30
 v_accvgpr_read_b32 v27, a16
 v_accvgpr_read_b32 v28, a17
 v_mul_f32 v27, v27, v26
 v_mfma_f32_32x32x16_bf16 a[64:79], a[196:199], v[136:139], a[64:79]
 s_add_u32 m0, s32, 17984
 ds_read_b64_tr_b16 a[212:213], v4 offset:43840
 buffer_load_dwordx4 v16, s[20:23], s38 offen offset:2688 lds
 ds_read_b64_tr_b16 a[214:215], v4 offset:48192
 ds_write_b128 v17, v[164:167] offset:1024
 s_waitcnt lgkmcnt(5)
 v_mfma_f32_32x32x16_bf16 a[64:79], a[200:203], v[144:147], a[64:79]
 ds_read_b64_tr_b16 a[216:217], v5 offset:320
 ds_read_b64_tr_b16 a[218:219], v5 offset:4672
 v_mul_f32 v28, v28, v26
 v_cvt_pk_bf16_f32 v168, v27, v28
 v_accvgpr_read_b32 v29, a18
 v_accvgpr_read_b32 v30, a19
 v_mul_f32 v29, v29, v26
 v_mfma_f32_32x32x16_bf16 a[64:79], a[204:207], v[152:155], a[64:79]
 ds_read_b64_tr_b16 a[220:221], v5 offset:9024
 ds_read_b64_tr_b16 a[222:223], v5 offset:13376
 v_mul_f32 v30, v30, v26
 v_cvt_pk_bf16_f32 v169, v29, v30
 v_accvgpr_read_b32 v27, a20
 v_accvgpr_read_b32 v28, a21
 v_mul_f32 v27, v27, v26
 s_waitcnt lgkmcnt(5)
 v_mfma_f32_32x32x16_bf16 a[80:95], a[208:211], v[128:131], a[80:95]
 ds_read_b64_tr_b16 a[192:193], v4 offset:35200
 ds_read_b64_tr_b16 a[194:195], v4 offset:39552
 v_mul_f32 v28, v28, v26
 v_cvt_pk_bf16_f32 v170, v27, v28
 v_accvgpr_read_b32 v29, a22
 v_accvgpr_read_b32 v30, a23
 v_mul_f32 v29, v29, v26
 v_mfma_f32_32x32x16_bf16 a[80:95], a[212:215], v[136:139], a[80:95]
 ds_read_b64_tr_b16 a[196:197], v4 offset:43904
 ds_read_b64_tr_b16 a[198:199], v4 offset:48256
 v_mul_f32 v30, v30, v26
 v_cvt_pk_bf16_f32 v171, v29, v30
 v_accvgpr_read_b32 v27, a24
 v_accvgpr_read_b32 v28, a25
 v_mul_f32 v27, v27, v26
 s_waitcnt lgkmcnt(4)
 v_mfma_f32_32x32x16_bf16 a[80:95], a[216:219], v[144:147], a[80:95]
 ds_read_b64_tr_b16 a[200:201], v5 offset:384
 ds_read_b64_tr_b16 a[202:203], v5 offset:4736
 ds_write_b128 v17, v[168:171] offset:2048
 v_mul_f32 v28, v28, v26
 v_cvt_pk_bf16_f32 v172, v27, v28
 v_accvgpr_read_b32 v29, a26
 v_mfma_f32_32x32x16_bf16 a[80:95], a[220:223], v[152:155], a[80:95]
 ds_read_b64_tr_b16 a[204:205], v5 offset:9088
 ds_read_b64_tr_b16 a[206:207], v5 offset:13440
 v_accvgpr_read_b32 v30, a27
 v_mul_f32 v29, v29, v26
 v_mul_f32 v30, v30, v26
 v_cvt_pk_bf16_f32 v173, v29, v30
 v_accvgpr_read_b32 v27, a28
 s_waitcnt lgkmcnt(5)
 v_mfma_f32_32x32x16_bf16 a[96:111], a[192:195], v[128:131], a[96:111]
 ds_read_b64_tr_b16 a[208:209], v4 offset:35264
 ds_read_b64_tr_b16 a[210:211], v4 offset:39616
 ds_read_b64_tr_b16 a[212:213], v4 offset:43968
 ds_read_b64_tr_b16 a[214:215], v4 offset:48320
 v_accvgpr_read_b32 v28, a29
 v_mul_f32 v27, v27, v26
 v_mul_f32 v28, v28, v26
 v_mfma_f32_32x32x16_bf16 a[96:111], a[196:199], v[136:139], a[96:111]
 ds_read_b64_tr_b16 a[216:217], v5 offset:448
 ds_read_b64_tr_b16 a[218:219], v5 offset:4800
 ds_read_b64_tr_b16 a[220:221], v5 offset:9152
 ds_read_b64_tr_b16 a[222:223], v5 offset:13504
 v_cvt_pk_bf16_f32 v174, v27, v28
 v_accvgpr_read_b32 v29, a30
 v_accvgpr_read_b32 v30, a31
 s_waitcnt lgkmcnt(8)
 v_mfma_f32_32x32x16_bf16 a[96:111], a[200:203], v[144:147], a[96:111]
 v_mul_f32 v29, v29, v26
 v_mul_f32 v30, v30, v26
 v_cvt_pk_bf16_f32 v175, v29, v30
 v_accvgpr_read_b32 v27, a32
 v_accvgpr_read_b32 v28, a33
 v_mul_f32 v27, v27, v26
 v_mul_f32 v28, v28, v26
 v_mfma_f32_32x32x16_bf16 a[96:111], a[204:207], v[152:155], a[96:111]
 ds_write_b128 v17, v[172:175] offset:3072
 v_cvt_pk_bf16_f32 v176, v27, v28
 v_accvgpr_read_b32 v29, a34
 v_accvgpr_read_b32 v30, a35
 v_mul_f32 v29, v29, v26
 v_mul_f32 v30, v30, v26
 s_waitcnt lgkmcnt(5)
 v_mfma_f32_32x32x16_bf16 a[112:127], a[208:211], v[128:131], a[112:127]
 s_waitcnt vmcnt(16) lgkmcnt(0)
 s_barrier
 s_add_u32 s31, s31, 14336
 s_add_u32 m0, s32, 34816
 ds_read_b64_tr_b16 a[192:193], v2 offset:0
 buffer_load_dwordx4 v16, s[20:23], s31 offen offset:0 lds
 ds_read_b64_tr_b16 a[194:195], v2 offset:4352
 ds_read_b128 a[128:131], v18 offset:0
 v_mfma_f32_32x32x16_bf16 a[112:127], a[212:215], v[136:139], a[112:127]
 ds_read_b64_tr_b16 a[196:197], v2 offset:64
 ds_read_b64_tr_b16 a[198:199], v2 offset:4416
 ds_read_b128 a[132:135], v18 offset:1024
 v_cvt_pk_bf16_f32 v177, v29, v30
 v_accvgpr_read_b32 v27, a36
 v_accvgpr_read_b32 v28, a37
 v_mul_f32 v27, v27, v26
 v_mfma_f32_32x32x16_bf16 a[112:127], a[216:219], v[144:147], a[112:127]
 ds_read_b64_tr_b16 a[200:201], v2 offset:128
 ds_read_b64_tr_b16 a[202:203], v2 offset:4480
 ds_read_b128 a[136:139], v18 offset:2048
 v_mul_f32 v28, v28, v26
 v_cvt_pk_bf16_f32 v178, v27, v28
 v_accvgpr_read_b32 v29, a38
 v_accvgpr_read_b32 v30, a39
 v_mfma_f32_32x32x16_bf16 a[112:127], a[220:223], v[152:155], a[112:127]
 s_add_u32 m0, s32, 35008
 ds_read_b64_tr_b16 a[204:205], v2 offset:192
 buffer_load_dwordx4 v16, s[20:23], s31 offen offset:896 lds
 ds_read_b64_tr_b16 a[206:207], v2 offset:4544
 ds_read_b128 a[140:143], v18 offset:3072
 v_mul_f32 v29, v29, v26
 s_waitcnt lgkmcnt(7)
 v_mfma_f32_32x32x16_bf16 v[32:47], a[192:195], v[160:163], 0
 ds_read_b64_tr_b16 a[208:209], v2 offset:256
 ds_read_b64_tr_b16 a[210:211], v2 offset:4608
 v_mul_f32 v30, v30, v26
 v_cvt_pk_bf16_f32 v179, v29, v30
 v_accvgpr_read_b32 v27, a40
 v_accvgpr_read_b32 v28, a41
 v_mfma_f32_32x32x16_bf16 v[48:63], a[196:199], v[160:163], 0
 s_add_u32 m0, s32, 35200
 ds_read_b64_tr_b16 a[212:213], v2 offset:320
 buffer_load_dwordx4 v16, s[20:23], s31 offen offset:1792 lds
 ds_read_b64_tr_b16 a[214:215], v2 offset:4672
 v_mul_f32 v27, v27, v26
 s_waitcnt lgkmcnt(5)
 v_mfma_f32_32x32x16_bf16 v[64:79], a[200:203], v[160:163], 0
 ds_read_b64_tr_b16 a[216:217], v2 offset:384
 ds_read_b64_tr_b16 a[218:219], v2 offset:4736
 v_mul_f32 v28, v28, v26
 v_cvt_pk_bf16_f32 v180, v27, v28
 v_accvgpr_read_b32 v29, a42
 v_accvgpr_read_b32 v30, a43
 v_mfma_f32_32x32x16_bf16 v[80:95], a[204:207], v[160:163], 0
 s_add_u32 m0, s32, 35392
 ds_read_b64_tr_b16 a[220:221], v25 offset:0
 buffer_load_dwordx4 v16, s[20:23], s31 offen offset:2688 lds
 ds_read_b64_tr_b16 a[222:223], v25 offset:4352
 v_mul_f32 v29, v29, v26
 s_waitcnt lgkmcnt(4)
 v_mfma_f32_32x32x16_bf16 v[96:111], a[208:211], v[160:163], 0
 ds_read_b64_tr_b16 a[192:193], v25 offset:64
 ds_read_b64_tr_b16 a[194:195], v25 offset:4416
 v_mul_f32 v30, v30, v26
 v_cvt_pk_bf16_f32 v181, v29, v30
 v_accvgpr_read_b32 v27, a44
 v_accvgpr_read_b32 v28, a45
 v_mfma_f32_32x32x16_bf16 v[112:127], a[212:215], v[160:163], 0
 s_add_u32 s38, s38, 14336
 s_add_u32 m0, s32, 52224
 ds_read_b64_tr_b16 a[196:197], v25 offset:128
 buffer_load_dwordx4 v16, s[20:23], s38 offen offset:0 lds
 ds_read_b64_tr_b16 a[198:199], v25 offset:4480
 s_waitcnt lgkmcnt(4)
 v_mfma_f32_32x32x16_bf16 v[128:143], a[216:219], v[160:163], 0
 ds_read_b64_tr_b16 a[200:201], v25 offset:192
 ds_read_b64_tr_b16 a[202:203], v25 offset:4544
 ds_read_b64_tr_b16 a[204:205], v25 offset:256
 ds_read_b64_tr_b16 a[206:207], v25 offset:4608
 v_mul_f32 v27, v27, v26
 v_mul_f32 v28, v28, v26
 v_mfma_f32_32x32x16_bf16 v[32:47], a[220:223], a[128:131], v[32:47]
 s_add_u32 m0, s32, 52416
 ds_read_b64_tr_b16 a[208:209], v25 offset:320
 buffer_load_dwordx4 v16, s[20:23], s38 offen offset:896 lds
 ds_read_b64_tr_b16 a[210:211], v25 offset:4672
 ds_read_b64_tr_b16 a[212:213], v25 offset:384
 ds_read_b64_tr_b16 a[214:215], v25 offset:4736
 s_waitcnt lgkmcnt(8)
 v_mfma_f32_32x32x16_bf16 v[48:63], a[192:195], a[128:131], v[48:63]
 v_cvt_pk_bf16_f32 v182, v27, v28
 v_accvgpr_read_b32 v29, a46
 v_accvgpr_read_b32 v30, a47
 v_mul_f32 v29, v29, v26
 v_mul_f32 v30, v30, v26
 v_cvt_pk_bf16_f32 v183, v29, v30
 v_mfma_f32_32x32x16_bf16 v[64:79], a[196:199], a[128:131], v[64:79]
 s_add_u32 m0, s32, 52608
 s_nop 0
 buffer_load_dwordx4 v16, s[20:23], s38 offen offset:1792 lds
 v_accvgpr_read_b32 v27, a48
 v_accvgpr_read_b32 v28, a49
 v_mul_f32 v27, v27, v26
 s_waitcnt lgkmcnt(4)
 v_mfma_f32_32x32x16_bf16 v[80:95], a[200:203], a[128:131], v[80:95]
 s_waitcnt vmcnt(15) lgkmcnt(0)
 s_barrier
 ds_read_b64_tr_b16 a[216:217], v2 offset:34816
 ds_read_b64_tr_b16 a[218:219], v2 offset:39168
 ds_write_b128 v17, v[176:179] offset:0
 v_mfma_f32_32x32x16_bf16 v[96:111], a[204:207], a[128:131], v[96:111]
 s_add_u32 m0, s32, 52800
 ds_read_b64_tr_b16 a[220:221], v2 offset:34880
 buffer_load_dwordx4 v16, s[20:23], s38 offen offset:2688 lds
 ds_read_b64_tr_b16 a[222:223], v2 offset:39232
 ds_write_b128 v17, v[180:183] offset:1024
 v_mfma_f32_32x32x16_bf16 v[112:127], a[208:211], a[128:131], v[112:127]
 ds_read_b64_tr_b16 a[192:193], v2 offset:34944
 ds_read_b64_tr_b16 a[194:195], v2 offset:39296
 v_mul_f32 v28, v28, v26
 v_cvt_pk_bf16_f32 v184, v27, v28
 v_accvgpr_read_b32 v29, a50
 v_accvgpr_read_b32 v30, a51
 v_mfma_f32_32x32x16_bf16 v[128:143], a[212:215], a[128:131], v[128:143]
 s_add_u32 s31, s31, 14336
 s_add_u32 m0, s32, 69632
 ds_read_b64_tr_b16 a[196:197], v2 offset:35008
 buffer_load_dwordx4 v16, s[20:23], s31 offen offset:0 lds
 ds_read_b64_tr_b16 a[198:199], v2 offset:39360
 s_waitcnt lgkmcnt(5)
 v_mfma_f32_32x32x16_bf16 v[32:47], a[216:219], v[164:167], v[32:47]
 ds_read_b64_tr_b16 a[200:201], v2 offset:35072
 ds_read_b64_tr_b16 a[202:203], v2 offset:39424
 v_mul_f32 v29, v29, v26
 v_mul_f32 v30, v30, v26
 v_cvt_pk_bf16_f32 v185, v29, v30
 v_accvgpr_read_b32 v27, a52
 v_mfma_f32_32x32x16_bf16 v[48:63], a[220:223], v[164:167], v[48:63]
 s_add_u32 m0, s32, 69824
 ds_read_b64_tr_b16 a[204:205], v2 offset:35136
 buffer_load_dwordx4 v16, s[20:23], s31 offen offset:896 lds
 ds_read_b64_tr_b16 a[206:207], v2 offset:39488
 v_accvgpr_read_b32 v28, a53
 s_waitcnt lgkmcnt(4)
 v_mfma_f32_32x32x16_bf16 v[64:79], a[192:195], v[164:167], v[64:79]
 ds_read_b64_tr_b16 a[208:209], v2 offset:35200
 ds_read_b64_tr_b16 a[210:211], v2 offset:39552
 v_mul_f32 v27, v27, v26
 v_mul_f32 v28, v28, v26
 v_cvt_pk_bf16_f32 v186, v27, v28
 v_accvgpr_read_b32 v29, a54
 v_mfma_f32_32x32x16_bf16 v[80:95], a[196:199], v[164:167], v[80:95]
 s_add_u32 m0, s32, 70016
 ds_read_b64_tr_b16 a[212:213], v25 offset:34816
 buffer_load_dwordx4 v16, s[20:23], s31 offen offset:1792 lds
 ds_read_b64_tr_b16 a[214:215], v25 offset:39168
 v_accvgpr_read_b32 v30, a55
 s_waitcnt lgkmcnt(4)
 v_mfma_f32_32x32x16_bf16 v[96:111], a[200:203], v[164:167], v[96:111]
 ds_read_b64_tr_b16 a[216:217], v25 offset:34880
 ds_read_b64_tr_b16 a[218:219], v25 offset:39232
 v_mul_f32 v29, v29, v26
 v_mul_f32 v30, v30, v26
 v_cvt_pk_bf16_f32 v187, v29, v30
 v_accvgpr_read_b32 v27, a56
 v_mfma_f32_32x32x16_bf16 v[112:127], a[204:207], v[164:167], v[112:127]
 s_add_u32 m0, s32, 70208
 ds_read_b64_tr_b16 a[220:221], v25 offset:34944
 buffer_load_dwordx4 v16, s[20:23], s31 offen offset:2688 lds
 ds_read_b64_tr_b16 a[222:223], v25 offset:39296
 ds_write_b128 v17, v[184:187] offset:2048
 s_waitcnt lgkmcnt(5)
 v_mfma_f32_32x32x16_bf16 v[128:143], a[208:211], v[164:167], v[128:143]
 ds_read_b64_tr_b16 a[192:193], v25 offset:35008
 ds_read_b64_tr_b16 a[194:195], v25 offset:39360
 ds_read_b64_tr_b16 a[196:197], v25 offset:35072
 ds_read_b64_tr_b16 a[198:199], v25 offset:39424
 v_accvgpr_read_b32 v28, a57
 v_mul_f32 v27, v27, v26
 v_mfma_f32_32x32x16_bf16 v[32:47], a[212:215], a[132:135], v[32:47]
 s_add_u32 s38, s38, 14336
 s_add_u32 m0, s32, 87040
 ds_read_b64_tr_b16 a[200:201], v25 offset:35136
 buffer_load_dwordx4 v16, s[20:23], s38 offen offset:0 lds
 ds_read_b64_tr_b16 a[202:203], v25 offset:39488
 ds_read_b64_tr_b16 a[204:205], v25 offset:35200
 ds_read_b64_tr_b16 a[206:207], v25 offset:39552
 s_waitcnt lgkmcnt(9)
 v_mfma_f32_32x32x16_bf16 v[48:63], a[216:219], a[132:135], v[48:63]
 v_mul_f32 v28, v28, v26
 v_cvt_pk_bf16_f32 v188, v27, v28
 v_accvgpr_read_b32 v29, a58
 v_accvgpr_read_b32 v30, a59
 v_mul_f32 v29, v29, v26
 v_mul_f32 v30, v30, v26
 v_mfma_f32_32x32x16_bf16 v[64:79], a[220:223], a[132:135], v[64:79]
 s_add_u32 m0, s32, 87232
 s_nop 0
 buffer_load_dwordx4 v16, s[20:23], s38 offen offset:896 lds
 v_cvt_pk_bf16_f32 v189, v29, v30
 v_accvgpr_read_b32 v27, a60
 v_accvgpr_read_b32 v28, a61
 s_waitcnt lgkmcnt(4)
 v_mfma_f32_32x32x16_bf16 v[80:95], a[192:195], a[132:135], v[80:95]
 s_waitcnt vmcnt(14) lgkmcnt(0)
 s_barrier
 ds_read_b64_tr_b16 a[208:209], v1 offset:0
 ds_read_b64_tr_b16 a[210:211], v1 offset:4352
 ds_read_b128 a[144:147], v18 offset:0
 v_mul_f32 v27, v27, v26
 v_mfma_f32_32x32x16_bf16 v[96:111], a[196:199], a[132:135], v[96:111]
 s_add_u32 m0, s32, 87424
 ds_read_b64_tr_b16 a[212:213], v1 offset:64
 buffer_load_dwordx4 v16, s[20:23], s38 offen offset:1792 lds
 ds_read_b64_tr_b16 a[214:215], v1 offset:4416
 ds_read_b128 a[148:151], v18 offset:1024
 v_mfma_f32_32x32x16_bf16 v[112:127], a[200:203], a[132:135], v[112:127]
 ds_read_b64_tr_b16 a[216:217], v1 offset:128
 ds_read_b64_tr_b16 a[218:219], v1 offset:4480
 ds_read_b128 a[152:155], v18 offset:2048
 v_mul_f32 v28, v28, v26
 v_cvt_pk_bf16_f32 v190, v27, v28
 v_accvgpr_read_b32 v29, a62
 v_mfma_f32_32x32x16_bf16 v[128:143], a[204:207], a[132:135], v[128:143]
 s_add_u32 m0, s32, 87616
 ds_read_b64_tr_b16 a[220:221], v1 offset:192
 buffer_load_dwordx4 v16, s[20:23], s38 offen offset:2688 lds
 ds_read_b64_tr_b16 a[222:223], v1 offset:4544
 v_accvgpr_read_b32 v30, a63
 s_waitcnt lgkmcnt(6)
 v_mfma_f32_32x32x16_bf16 v[32:47], a[208:211], v[168:171], v[32:47]
 s_add_u32 s31, s31, 14336
 s_add_u32 m0, s32, 104448
 ds_read_b64_tr_b16 a[192:193], v1 offset:256
 buffer_load_dwordx4 v16, s[20:23], s31 offen offset:0 lds
 ds_read_b64_tr_b16 a[194:195], v1 offset:4608
 v_mfma_f32_32x32x16_bf16 v[48:63], a[212:215], v[168:171], v[48:63]
 ds_read_b64_tr_b16 a[196:197], v1 offset:320
 ds_read_b64_tr_b16 a[198:199], v1 offset:4672
 v_mul_f32 v29, v29, v26
 v_mul_f32 v30, v30, v26
 v_cvt_pk_bf16_f32 v191, v29, v30
 v_accvgpr_read_b32 v27, a64
 s_waitcnt lgkmcnt(4)
 v_mfma_f32_32x32x16_bf16 v[64:79], a[216:219], v[168:171], v[64:79]
 s_add_u32 m0, s32, 104640
 ds_read_b64_tr_b16 a[200:201], v1 offset:384
 buffer_load_dwordx4 v16, s[20:23], s31 offen offset:896 lds
 ds_read_b64_tr_b16 a[202:203], v1 offset:4736
 ds_write_b128 v17, v[188:191] offset:3072
 v_mfma_f32_32x32x16_bf16 v[80:95], a[220:223], v[168:171], v[80:95]
 ds_read_b64_tr_b16 a[204:205], v3 offset:0
 ds_read_b64_tr_b16 a[206:207], v3 offset:4352
 v_accvgpr_read_b32 v28, a65
 v_mul_f32 v27, v27, v26
 v_mul_f32 v28, v28, v26
 v_cvt_pk_bf16_f32 v192, v27, v28
 s_waitcnt lgkmcnt(5)
 v_mfma_f32_32x32x16_bf16 v[96:111], a[192:195], v[168:171], v[96:111]
 s_add_u32 m0, s32, 104832
 ds_read_b64_tr_b16 a[208:209], v3 offset:64
 buffer_load_dwordx4 v16, s[20:23], s31 offen offset:1792 lds
 ds_read_b64_tr_b16 a[210:211], v3 offset:4416
 v_accvgpr_read_b32 v29, a66
 v_mfma_f32_32x32x16_bf16 v[112:127], a[196:199], v[168:171], v[112:127]
 ds_read_b64_tr_b16 a[212:213], v3 offset:128
 ds_read_b64_tr_b16 a[214:215], v3 offset:4480
 v_accvgpr_read_b32 v30, a67
 v_mul_f32 v29, v29, v26
 v_mul_f32 v30, v30, v26
 v_cvt_pk_bf16_f32 v193, v29, v30
 s_waitcnt lgkmcnt(4)
 v_mfma_f32_32x32x16_bf16 v[128:143], a[200:203], v[168:171], v[128:143]
 s_add_u32 m0, s32, 105024
 ds_read_b64_tr_b16 a[216:217], v3 offset:192
 buffer_load_dwordx4 v16, s[20:23], s31 offen offset:2688 lds
 ds_read_b64_tr_b16 a[218:219], v3 offset:4544
 ds_read_b64_tr_b16 a[220:221], v3 offset:256
 ds_read_b64_tr_b16 a[222:223], v3 offset:4608
 v_mfma_f32_32x32x16_bf16 v[32:47], a[204:207], a[136:139], v[32:47]
 ds_read_b64_tr_b16 a[192:193], v3 offset:320
 ds_read_b64_tr_b16 a[194:195], v3 offset:4672
 ds_read_b64_tr_b16 a[196:197], v3 offset:384
 ds_read_b64_tr_b16 a[198:199], v3 offset:4736
 v_accvgpr_read_b32 v27, a68
 v_accvgpr_read_b32 v28, a69
 s_waitcnt lgkmcnt(8)
 v_mfma_f32_32x32x16_bf16 v[48:63], a[208:211], a[136:139], v[48:63]
 s_add_u32 s38, s38, 14336
 s_add_u32 m0, s32, 121856
 s_nop 0
 buffer_load_dwordx4 v16, s[20:23], s38 offen offset:0 lds
 v_mul_f32 v27, v27, v26
 v_mul_f32 v28, v28, v26
 v_mfma_f32_32x32x16_bf16 v[64:79], a[212:215], a[136:139], v[64:79]
 v_cvt_pk_bf16_f32 v194, v27, v28
 v_accvgpr_read_b32 v29, a70
 v_accvgpr_read_b32 v30, a71
 v_mul_f32 v29, v29, v26
 v_mul_f32 v30, v30, v26
 v_cvt_pk_bf16_f32 v195, v29, v30
 s_waitcnt lgkmcnt(4)
 v_mfma_f32_32x32x16_bf16 v[80:95], a[216:219], a[136:139], v[80:95]
 s_waitcnt vmcnt(13) lgkmcnt(0)
 s_barrier
 s_add_u32 m0, s32, 122048
 ds_read_b64_tr_b16 a[200:201], v1 offset:34816
 buffer_load_dwordx4 v16, s[20:23], s38 offen offset:896 lds
 ds_read_b64_tr_b16 a[202:203], v1 offset:39168
 ds_write_b128 v17, v[192:195] offset:0
 v_mfma_f32_32x32x16_bf16 v[96:111], a[220:223], a[136:139], v[96:111]
 ds_read_b64_tr_b16 a[204:205], v1 offset:34880
 ds_read_b64_tr_b16 a[206:207], v1 offset:39232
 ds_read_b128 a[156:159], v18 offset:3072
 v_accvgpr_read_b32 v27, a72
 v_accvgpr_read_b32 v28, a73
 v_mul_f32 v27, v27, v26
 v_mfma_f32_32x32x16_bf16 v[112:127], a[192:195], a[136:139], v[112:127]
 s_add_u32 m0, s32, 122240
 ds_read_b64_tr_b16 a[208:209], v1 offset:34944
 buffer_load_dwordx4 v16, s[20:23], s38 offen offset:1792 lds
 ds_read_b64_tr_b16 a[210:211], v1 offset:39296
 v_mul_f32 v28, v28, v26
 v_mfma_f32_32x32x16_bf16 v[128:143], a[196:199], a[136:139], v[128:143]
 ds_read_b64_tr_b16 a[212:213], v1 offset:35008
 ds_read_b64_tr_b16 a[214:215], v1 offset:39360
 v_cvt_pk_bf16_f32 v196, v27, v28
 v_accvgpr_read_b32 v29, a74
 v_accvgpr_read_b32 v30, a75
 v_mul_f32 v29, v29, v26
 s_waitcnt lgkmcnt(5)
 v_mfma_f32_32x32x16_bf16 v[32:47], a[200:203], v[172:175], v[32:47]
 s_add_u32 m0, s32, 122432
 ds_read_b64_tr_b16 a[216:217], v1 offset:35072
 buffer_load_dwordx4 v16, s[20:23], s38 offen offset:2688 lds
 ds_read_b64_tr_b16 a[218:219], v1 offset:39424
 v_mul_f32 v30, v30, v26
 v_mfma_f32_32x32x16_bf16 v[48:63], a[204:207], v[172:175], v[48:63]
 s_add_u32 s31, s31, 14336
 s_add_u32 m0, s32, 0
 ds_read_b64_tr_b16 a[220:221], v1 offset:35136
 buffer_load_dwordx4 v16, s[20:23], s31 offen offset:0 lds
 ds_read_b64_tr_b16 a[222:223], v1 offset:39488
 s_waitcnt lgkmcnt(4)
 v_mfma_f32_32x32x16_bf16 v[64:79], a[208:211], v[172:175], v[64:79]
 s_add_u32 m0, s32, 192
 ds_read_b64_tr_b16 a[192:193], v1 offset:35200
 buffer_load_dwordx4 v16, s[20:23], s31 offen offset:896 lds
 ds_read_b64_tr_b16 a[194:195], v1 offset:39552
 v_cvt_pk_bf16_f32 v197, v29, v30
 v_mfma_f32_32x32x16_bf16 v[80:95], a[212:215], v[172:175], v[80:95]
 ds_read_b64_tr_b16 a[196:197], v3 offset:34816
 ds_read_b64_tr_b16 a[198:199], v3 offset:39168
 v_accvgpr_read_b32 v27, a76
 v_accvgpr_read_b32 v28, a77
 v_mul_f32 v27, v27, v26
 v_mul_f32 v28, v28, v26
 s_waitcnt lgkmcnt(4)
 v_mfma_f32_32x32x16_bf16 v[96:111], a[216:219], v[172:175], v[96:111]
 s_add_u32 m0, s32, 384
 ds_read_b64_tr_b16 a[200:201], v3 offset:34880
 buffer_load_dwordx4 v16, s[20:23], s31 offen offset:1792 lds
 ds_read_b64_tr_b16 a[202:203], v3 offset:39232
 v_cvt_pk_bf16_f32 v198, v27, v28
 v_mfma_f32_32x32x16_bf16 v[112:127], a[220:223], v[172:175], v[112:127]
 ds_read_b64_tr_b16 a[204:205], v3 offset:34944
 ds_read_b64_tr_b16 a[206:207], v3 offset:39296
 v_accvgpr_read_b32 v29, a78
 v_accvgpr_read_b32 v30, a79
 v_mul_f32 v29, v29, v26
 v_mul_f32 v30, v30, v26
 s_waitcnt lgkmcnt(4)
 v_mfma_f32_32x32x16_bf16 v[128:143], a[192:195], v[172:175], v[128:143]
 s_add_u32 m0, s32, 576
 ds_read_b64_tr_b16 a[208:209], v3 offset:35008
 buffer_load_dwordx4 v16, s[20:23], s31 offen offset:2688 lds
 ds_read_b64_tr_b16 a[210:211], v3 offset:39360
 ds_read_b64_tr_b16 a[212:213], v3 offset:35072
 ds_read_b64_tr_b16 a[214:215], v3 offset:39424
 v_mfma_f32_32x32x16_bf16 v[32:47], a[196:199], a[140:143], v[32:47]
 ds_read_b64_tr_b16 a[216:217], v3 offset:35136
 ds_read_b64_tr_b16 a[218:219], v3 offset:39488
 ds_read_b64_tr_b16 a[220:221], v3 offset:35200
 ds_read_b64_tr_b16 a[222:223], v3 offset:39552
 v_cvt_pk_bf16_f32 v199, v29, v30
 v_accvgpr_read_b32 v27, a80
 s_waitcnt lgkmcnt(8)
 v_mfma_f32_32x32x16_bf16 v[48:63], a[200:203], a[140:143], v[48:63]
 s_add_u32 s38, s38, 14336
 s_add_u32 m0, s32, 17408
 s_nop 0
 buffer_load_dwordx4 v16, s[20:23], s38 offen offset:0 lds
 ds_write_b128 v17, v[196:199] offset:1024
 v_mfma_f32_32x32x16_bf16 v[64:79], a[204:207], a[140:143], v[64:79]
 v_accvgpr_read_b32 v28, a81
 v_mul_f32 v27, v27, v26
 v_mul_f32 v28, v28, v26
 v_cvt_pk_bf16_f32 v200, v27, v28
 v_accvgpr_read_b32 v29, a82
 v_accvgpr_read_b32 v30, a83
 s_waitcnt lgkmcnt(5)
 v_mfma_f32_32x32x16_bf16 v[80:95], a[208:211], a[140:143], v[80:95]
 s_waitcnt vmcnt(13) lgkmcnt(0)
 s_barrier
 s_add_u32 m0, s32, 17600
 ds_read_b64_tr_b16 a[192:193], v2 offset:0
 buffer_load_dwordx4 v16, s[20:23], s38 offen offset:896 lds
 ds_read_b64_tr_b16 a[194:195], v2 offset:4352
 ds_read_b128 a[160:163], v18 offset:0
 v_mfma_f32_32x32x16_bf16 v[96:111], a[212:215], a[140:143], v[96:111]
 ds_read_b64_tr_b16 a[196:197], v2 offset:64
 ds_read_b64_tr_b16 a[198:199], v2 offset:4416
 ds_read_b128 a[164:167], v18 offset:1024
 v_mul_f32 v29, v29, v26
 v_mul_f32 v30, v30, v26
 v_cvt_pk_bf16_f32 v201, v29, v30
 v_mfma_f32_32x32x16_bf16 v[112:127], a[216:219], a[140:143], v[112:127]
 s_add_u32 m0, s32, 17792
 ds_read_b64_tr_b16 a[200:201], v2 offset:128
 buffer_load_dwordx4 v16, s[20:23], s38 offen offset:1792 lds
 ds_read_b64_tr_b16 a[202:203], v2 offset:4480
 v_accvgpr_read_b32 v27, a84
 v_mfma_f32_32x32x16_bf16 v[128:143], a[220:223], a[140:143], v[128:143]
 ds_read_b64_tr_b16 a[204:205], v2 offset:192
 ds_read_b64_tr_b16 a[206:207], v2 offset:4544
 v_accvgpr_read_b32 v28, a85
 v_mul_f32 v27, v27, v26
 v_mul_f32 v28, v28, v26
 v_cvt_pk_bf16_f32 v202, v27, v28
 s_waitcnt lgkmcnt(5)
 v_mfma_f32_32x32x16_bf16 v[32:47], a[192:195], v[176:179], v[32:47]
 s_add_u32 m0, s32, 17984
 ds_read_b64_tr_b16 a[208:209], v2 offset:256
 buffer_load_dwordx4 v16, s[20:23], s38 offen offset:2688 lds
 ds_read_b64_tr_b16 a[210:211], v2 offset:4608
 v_accvgpr_read_b32 v29, a86
 v_mfma_f32_32x32x16_bf16 v[48:63], a[196:199], v[176:179], v[48:63]
 s_add_u32 s31, s31, 14336
 s_add_u32 m0, s32, 34816
 ds_read_b64_tr_b16 a[212:213], v2 offset:320
 buffer_load_dwordx4 v16, s[20:23], s31 offen offset:0 lds
 ds_read_b64_tr_b16 a[214:215], v2 offset:4672
 s_waitcnt lgkmcnt(4)
 v_mfma_f32_32x32x16_bf16 v[64:79], a[200:203], v[176:179], v[64:79]
 s_add_u32 m0, s32, 35008
 ds_read_b64_tr_b16 a[216:217], v2 offset:384
 buffer_load_dwordx4 v16, s[20:23], s31 offen offset:896 lds
 ds_read_b64_tr_b16 a[218:219], v2 offset:4736
 v_accvgpr_read_b32 v30, a87
 v_mfma_f32_32x32x16_bf16 v[80:95], a[204:207], v[176:179], v[80:95]
 ds_read_b64_tr_b16 a[220:221], v25 offset:0
 ds_read_b64_tr_b16 a[222:223], v25 offset:4352
 v_mul_f32 v29, v29, v26
 v_mul_f32 v30, v30, v26
 v_cvt_pk_bf16_f32 v203, v29, v30
 v_accvgpr_read_b32 v27, a88
 s_waitcnt lgkmcnt(4)
 v_mfma_f32_32x32x16_bf16 v[96:111], a[208:211], v[176:179], v[96:111]
 s_add_u32 m0, s32, 35200
 ds_read_b64_tr_b16 a[192:193], v25 offset:64
 buffer_load_dwordx4 v16, s[20:23], s31 offen offset:1792 lds
 ds_read_b64_tr_b16 a[194:195], v25 offset:4416
 ds_write_b128 v17, v[200:203] offset:2048
 v_mfma_f32_32x32x16_bf16 v[112:127], a[212:215], v[176:179], v[112:127]
 ds_read_b64_tr_b16 a[196:197], v25 offset:128
 ds_read_b64_tr_b16 a[198:199], v25 offset:4480
 v_accvgpr_read_b32 v28, a89
 v_mul_f32 v27, v27, v26
 v_mul_f32 v28, v28, v26
 v_cvt_pk_bf16_f32 v204, v27, v28
 s_waitcnt lgkmcnt(5)
 v_mfma_f32_32x32x16_bf16 v[128:143], a[216:219], v[176:179], v[128:143]
 s_add_u32 m0, s32, 35392
 ds_read_b64_tr_b16 a[200:201], v25 offset:192
 buffer_load_dwordx4 v16, s[20:23], s31 offen offset:2688 lds
 ds_read_b64_tr_b16 a[202:203], v25 offset:4544
 ds_read_b64_tr_b16 a[204:205], v25 offset:256
 ds_read_b64_tr_b16 a[206:207], v25 offset:4608
 v_mfma_f32_32x32x16_bf16 v[32:47], a[220:223], a[144:147], v[32:47]
 ds_read_b64_tr_b16 a[208:209], v25 offset:320
 ds_read_b64_tr_b16 a[210:211], v25 offset:4672
 ds_read_b64_tr_b16 a[212:213], v25 offset:384
 ds_read_b64_tr_b16 a[214:215], v25 offset:4736
 v_accvgpr_read_b32 v29, a90
 v_accvgpr_read_b32 v30, a91
 s_waitcnt lgkmcnt(8)
 v_mfma_f32_32x32x16_bf16 v[48:63], a[192:195], a[144:147], v[48:63]
 s_add_u32 s38, s38, 14336
 s_add_u32 m0, s32, 52224
 s_nop 0
 buffer_load_dwordx4 v16, s[20:23], s38 offen offset:0 lds
 v_mul_f32 v29, v29, v26
 v_mul_f32 v30, v30, v26
 v_mfma_f32_32x32x16_bf16 v[64:79], a[196:199], a[144:147], v[64:79]
 v_cvt_pk_bf16_f32 v205, v29, v30
 v_accvgpr_read_b32 v27, a92
 v_accvgpr_read_b32 v28, a93
 v_mul_f32 v27, v27, v26
 v_mul_f32 v28, v28, v26
 v_cvt_pk_bf16_f32 v206, v27, v28
 s_waitcnt lgkmcnt(4)
 v_mfma_f32_32x32x16_bf16 v[80:95], a[200:203], a[144:147], v[80:95]
 s_waitcnt vmcnt(13) lgkmcnt(0)
 s_barrier
 s_add_u32 m0, s32, 52416
 ds_read_b64_tr_b16 a[216:217], v2 offset:34816
 buffer_load_dwordx4 v16, s[20:23], s38 offen offset:896 lds
 ds_read_b64_tr_b16 a[218:219], v2 offset:39168
 ds_read_b128 a[168:171], v18 offset:2048
 v_mfma_f32_32x32x16_bf16 v[96:111], a[204:207], a[144:147], v[96:111]
 ds_read_b64_tr_b16 a[220:221], v2 offset:34880
 ds_read_b64_tr_b16 a[222:223], v2 offset:39232
 v_accvgpr_read_b32 v29, a94
 v_accvgpr_read_b32 v30, a95
 v_mul_f32 v29, v29, v26
 v_mul_f32 v30, v30, v26
 v_mfma_f32_32x32x16_bf16 v[112:127], a[208:211], a[144:147], v[112:127]
 s_add_u32 m0, s32, 52608
 ds_read_b64_tr_b16 a[192:193], v2 offset:34944
 buffer_load_dwordx4 v16, s[20:23], s38 offen offset:1792 lds
 ds_read_b64_tr_b16 a[194:195], v2 offset:39296
 v_cvt_pk_bf16_f32 v207, v29, v30
 v_mfma_f32_32x32x16_bf16 v[128:143], a[212:215], a[144:147], v[128:143]
 ds_read_b64_tr_b16 a[196:197], v2 offset:35008
 ds_read_b64_tr_b16 a[198:199], v2 offset:39360
 ds_write_b128 v17, v[204:207] offset:3072
 v_accvgpr_read_b32 v27, a96
 v_accvgpr_read_b32 v28, a97
 s_waitcnt lgkmcnt(5)
 v_mfma_f32_32x32x16_bf16 v[32:47], a[216:219], v[180:183], v[32:47]
 s_add_u32 m0, s32, 52800
 ds_read_b64_tr_b16 a[200:201], v2 offset:35072
 buffer_load_dwordx4 v16, s[20:23], s38 offen offset:2688 lds
 ds_read_b64_tr_b16 a[202:203], v2 offset:39424
 v_mul_f32 v27, v27, v26
 v_mfma_f32_32x32x16_bf16 v[48:63], a[220:223], v[180:183], v[48:63]
 s_add_u32 s31, s31, 14336
 s_add_u32 m0, s32, 69632
 ds_read_b64_tr_b16 a[204:205], v2 offset:35136
 buffer_load_dwordx4 v16, s[20:23], s31 offen offset:0 lds
 ds_read_b64_tr_b16 a[206:207], v2 offset:39488
 s_waitcnt lgkmcnt(5)
 v_mfma_f32_32x32x16_bf16 v[64:79], a[192:195], v[180:183], v[64:79]
 s_add_u32 m0, s32, 69824
 ds_read_b64_tr_b16 a[208:209], v2 offset:35200
 buffer_load_dwordx4 v16, s[20:23], s31 offen offset:896 lds
 ds_read_b64_tr_b16 a[210:211], v2 offset:39552
 v_mul_f32 v28, v28, v26
 v_mfma_f32_32x32x16_bf16 v[80:95], a[196:199], v[180:183], v[80:95]
 ds_read_b64_tr_b16 a[212:213], v25 offset:34816
 ds_read_b64_tr_b16 a[214:215], v25 offset:39168
 v_cvt_pk_bf16_f32 v208, v27, v28
 v_accvgpr_read_b32 v29, a98
 v_accvgpr_read_b32 v30, a99
 v_mul_f32 v29, v29, v26
 s_waitcnt lgkmcnt(4)
 v_mfma_f32_32x32x16_bf16 v[96:111], a[200:203], v[180:183], v[96:111]
 s_add_u32 m0, s32, 70016
 ds_read_b64_tr_b16 a[216:217], v25 offset:34880
 buffer_load_dwordx4 v16, s[20:23], s31 offen offset:1792 lds
 ds_read_b64_tr_b16 a[218:219], v25 offset:39232
 v_mul_f32 v30, v30, v26
 v_mfma_f32_32x32x16_bf16 v[112:127], a[204:207], v[180:183], v[112:127]
 ds_read_b64_tr_b16 a[220:221], v25 offset:34944
 ds_read_b64_tr_b16 a[222:223], v25 offset:39296
 v_cvt_pk_bf16_f32 v209, v29, v30
 v_accvgpr_read_b32 v27, a100
 v_accvgpr_read_b32 v28, a101
 v_mul_f32 v27, v27, v26
 s_waitcnt lgkmcnt(4)
 v_mfma_f32_32x32x16_bf16 v[128:143], a[208:211], v[180:183], v[128:143]
 s_add_u32 m0, s32, 70208
 ds_read_b64_tr_b16 a[192:193], v25 offset:35008
 buffer_load_dwordx4 v16, s[20:23], s31 offen offset:2688 lds
 ds_read_b64_tr_b16 a[194:195], v25 offset:39360
 ds_read_b64_tr_b16 a[196:197], v25 offset:35072
 ds_read_b64_tr_b16 a[198:199], v25 offset:39424
 v_mfma_f32_32x32x16_bf16 v[32:47], a[212:215], a[148:151], v[32:47]
 ds_read_b64_tr_b16 a[200:201], v25 offset:35136
 ds_read_b64_tr_b16 a[202:203], v25 offset:39488
 ds_read_b64_tr_b16 a[204:205], v25 offset:35200
 ds_read_b64_tr_b16 a[206:207], v25 offset:39552
 v_mul_f32 v28, v28, v26
 v_cvt_pk_bf16_f32 v210, v27, v28
 s_waitcnt lgkmcnt(8)
 v_mfma_f32_32x32x16_bf16 v[48:63], a[216:219], a[148:151], v[48:63]
 s_add_u32 s38, s38, 14336
 s_add_u32 m0, s32, 87040
 s_nop 0
 buffer_load_dwordx4 v16, s[20:23], s38 offen offset:0 lds
 v_accvgpr_read_b32 v29, a102
 v_accvgpr_read_b32 v30, a103
 v_mfma_f32_32x32x16_bf16 v[64:79], a[220:223], a[148:151], v[64:79]
 v_mul_f32 v29, v29, v26
 v_mul_f32 v30, v30, v26
 v_cvt_pk_bf16_f32 v211, v29, v30
 v_accvgpr_read_b32 v27, a104
 v_accvgpr_read_b32 v28, a105
 v_mul_f32 v27, v27, v26
 s_waitcnt lgkmcnt(4)
 v_mfma_f32_32x32x16_bf16 v[80:95], a[192:195], a[148:151], v[80:95]
 s_waitcnt vmcnt(13) lgkmcnt(0)
 s_barrier
 s_add_u32 m0, s32, 87232
 ds_read_b64_tr_b16 a[208:209], v1 offset:0
 buffer_load_dwordx4 v16, s[20:23], s38 offen offset:896 lds
 ds_read_b64_tr_b16 a[210:211], v1 offset:4352
 ds_write_b128 v17, v[208:211] offset:0
 v_mfma_f32_32x32x16_bf16 v[96:111], a[196:199], a[148:151], v[96:111]
 ds_read_b64_tr_b16 a[212:213], v1 offset:64
 ds_read_b64_tr_b16 a[214:215], v1 offset:4416
 ds_read_b128 a[172:175], v18 offset:3072
 v_mul_f32 v28, v28, v26
 v_cvt_pk_bf16_f32 v212, v27, v28
 v_accvgpr_read_b32 v29, a106
 v_mfma_f32_32x32x16_bf16 v[112:127], a[200:203], a[148:151], v[112:127]
 s_add_u32 m0, s32, 87424
 ds_read_b64_tr_b16 a[216:217], v1 offset:128
 buffer_load_dwordx4 v16, s[20:23], s38 offen offset:1792 lds
 ds_read_b64_tr_b16 a[218:219], v1 offset:4480
 v_accvgpr_read_b32 v30, a107
 v_mfma_f32_32x32x16_bf16 v[128:143], a[204:207], a[148:151], v[128:143]
 ds_read_b64_tr_b16 a[220:221], v1 offset:192
 ds_read_b64_tr_b16 a[222:223], v1 offset:4544
 v_mul_f32 v29, v29, v26
 v_mul_f32 v30, v30, v26
 v_cvt_pk_bf16_f32 v213, v29, v30
 v_accvgpr_read_b32 v27, a108
 s_waitcnt lgkmcnt(5)
 v_mfma_f32_32x32x16_bf16 v[32:47], a[208:211], v[184:187], v[32:47]
 s_add_u32 m0, s32, 87616
 ds_read_b64_tr_b16 a[192:193], v1 offset:256
 buffer_load_dwordx4 v16, s[20:23], s38 offen offset:2688 lds
 ds_read_b64_tr_b16 a[194:195], v1 offset:4608
 v_accvgpr_read_b32 v28, a109
 v_mfma_f32_32x32x16_bf16 v[48:63], a[212:215], v[184:187], v[48:63]
 s_add_u32 s31, s31, 14336
 s_add_u32 m0, s32, 104448
 ds_read_b64_tr_b16 a[196:197], v1 offset:320
 buffer_load_dwordx4 v16, s[20:23], s31 offen offset:0 lds
 ds_read_b64_tr_b16 a[198:199], v1 offset:4672
 s_waitcnt lgkmcnt(4)
 v_mfma_f32_32x32x16_bf16 v[64:79], a[216:219], v[184:187], v[64:79]
 s_add_u32 m0, s32, 104640
 ds_read_b64_tr_b16 a[200:201], v1 offset:384
 buffer_load_dwordx4 v16, s[20:23], s31 offen offset:896 lds
 ds_read_b64_tr_b16 a[202:203], v1 offset:4736
 v_mul_f32 v27, v27, v26
 v_mfma_f32_32x32x16_bf16 v[80:95], a[220:223], v[184:187], v[80:95]
 ds_read_b64_tr_b16 a[204:205], v3 offset:0
 ds_read_b64_tr_b16 a[206:207], v3 offset:4352
 v_mul_f32 v28, v28, v26
 v_cvt_pk_bf16_f32 v214, v27, v28
 v_accvgpr_read_b32 v29, a110
 v_accvgpr_read_b32 v30, a111
 s_waitcnt lgkmcnt(4)
 v_mfma_f32_32x32x16_bf16 v[96:111], a[192:195], v[184:187], v[96:111]
 s_add_u32 m0, s32, 104832
 ds_read_b64_tr_b16 a[208:209], v3 offset:64
 buffer_load_dwordx4 v16, s[20:23], s31 offen offset:1792 lds
 ds_read_b64_tr_b16 a[210:211], v3 offset:4416
 v_mul_f32 v29, v29, v26
 v_mfma_f32_32x32x16_bf16 v[112:127], a[196:199], v[184:187], v[112:127]
 ds_read_b64_tr_b16 a[212:213], v3 offset:128
 ds_read_b64_tr_b16 a[214:215], v3 offset:4480
 v_mul_f32 v30, v30, v26
 v_cvt_pk_bf16_f32 v215, v29, v30
 v_accvgpr_read_b32 v27, a112
 v_accvgpr_read_b32 v28, a113
 s_waitcnt lgkmcnt(4)
 v_mfma_f32_32x32x16_bf16 v[128:143], a[200:203], v[184:187], v[128:143]
 s_add_u32 m0, s32, 105024
 ds_read_b64_tr_b16 a[216:217], v3 offset:192
 buffer_load_dwordx4 v16, s[20:23], s31 offen offset:2688 lds
 ds_read_b64_tr_b16 a[218:219], v3 offset:4544
 ds_read_b64_tr_b16 a[220:221], v3 offset:256
 ds_read_b64_tr_b16 a[222:223], v3 offset:4608
 ds_write_b128 v17, v[212:215] offset:1024
 v_mfma_f32_32x32x16_bf16 v[32:47], a[204:207], a[152:155], v[32:47]
 ds_read_b64_tr_b16 a[192:193], v3 offset:320
 ds_read_b64_tr_b16 a[194:195], v3 offset:4672
 ds_read_b64_tr_b16 a[196:197], v3 offset:384
 ds_read_b64_tr_b16 a[198:199], v3 offset:4736
 v_mul_f32 v27, v27, v26
 v_mul_f32 v28, v28, v26
 s_waitcnt lgkmcnt(9)
 v_mfma_f32_32x32x16_bf16 v[48:63], a[208:211], a[152:155], v[48:63]
 s_add_u32 s38, s38, 14336
 s_add_u32 m0, s32, 121856
 s_nop 0
 buffer_load_dwordx4 v16, s[20:23], s38 offen offset:0 lds
 v_cvt_pk_bf16_f32 v216, v27, v28
 v_accvgpr_read_b32 v29, a114
 v_mfma_f32_32x32x16_bf16 v[64:79], a[212:215], a[152:155], v[64:79]
 v_accvgpr_read_b32 v30, a115
 v_mul_f32 v29, v29, v26
 v_mul_f32 v30, v30, v26
 v_cvt_pk_bf16_f32 v217, v29, v30
 v_accvgpr_read_b32 v27, a116
 v_accvgpr_read_b32 v28, a117
 s_waitcnt lgkmcnt(5)
 v_mfma_f32_32x32x16_bf16 v[80:95], a[216:219], a[152:155], v[80:95]
 s_waitcnt vmcnt(13) lgkmcnt(0)
 s_barrier
 s_add_u32 m0, s32, 122048
 ds_read_b64_tr_b16 a[200:201], v1 offset:34816
 buffer_load_dwordx4 v16, s[20:23], s38 offen offset:896 lds
 ds_read_b64_tr_b16 a[202:203], v1 offset:39168
 ds_read_b128 a[176:179], v18 offset:0
 v_mfma_f32_32x32x16_bf16 v[96:111], a[220:223], a[152:155], v[96:111]
 ds_read_b64_tr_b16 a[204:205], v1 offset:34880
 ds_read_b64_tr_b16 a[206:207], v1 offset:39232
 ds_read_b128 a[180:183], v18 offset:1024
 v_mul_f32 v27, v27, v26
 v_mul_f32 v28, v28, v26
 v_cvt_pk_bf16_f32 v218, v27, v28
 v_mfma_f32_32x32x16_bf16 v[112:127], a[192:195], a[152:155], v[112:127]
 s_add_u32 m0, s32, 122240
 ds_read_b64_tr_b16 a[208:209], v1 offset:34944
 buffer_load_dwordx4 v16, s[20:23], s38 offen offset:1792 lds
 ds_read_b64_tr_b16 a[210:211], v1 offset:39296
 v_accvgpr_read_b32 v29, a118
 v_mfma_f32_32x32x16_bf16 v[128:143], a[196:199], a[152:155], v[128:143]
 ds_read_b64_tr_b16 a[212:213], v1 offset:35008
 ds_read_b64_tr_b16 a[214:215], v1 offset:39360
 v_accvgpr_read_b32 v30, a119
 v_mul_f32 v29, v29, v26
 v_mul_f32 v30, v30, v26
 v_cvt_pk_bf16_f32 v219, v29, v30
 s_waitcnt lgkmcnt(5)
 v_mfma_f32_32x32x16_bf16 v[32:47], a[200:203], v[188:191], v[32:47]
 s_add_u32 m0, s32, 122432
 ds_read_b64_tr_b16 a[216:217], v1 offset:35072
 buffer_load_dwordx4 v16, s[20:23], s38 offen offset:2688 lds
 ds_read_b64_tr_b16 a[218:219], v1 offset:39424
 ds_write_b128 v17, v[216:219] offset:2048
 v_mfma_f32_32x32x16_bf16 v[48:63], a[204:207], v[188:191], v[48:63]
 s_add_u32 s31, s31, 14336
 s_add_u32 m0, s32, 0
 ds_read_b64_tr_b16 a[220:221], v1 offset:35136
 buffer_load_dwordx4 v16, s[20:23], s31 offen offset:0 lds
 ds_read_b64_tr_b16 a[222:223], v1 offset:39488
 s_waitcnt lgkmcnt(5)
 v_mfma_f32_32x32x16_bf16 v[64:79], a[208:211], v[188:191], v[64:79]
 s_add_u32 m0, s32, 192
 ds_read_b64_tr_b16 a[192:193], v1 offset:35200
 buffer_load_dwordx4 v16, s[20:23], s31 offen offset:896 lds
 ds_read_b64_tr_b16 a[194:195], v1 offset:39552
 v_accvgpr_read_b32 v27, a120
 v_mfma_f32_32x32x16_bf16 v[80:95], a[212:215], v[188:191], v[80:95]
 ds_read_b64_tr_b16 a[196:197], v3 offset:34816
 ds_read_b64_tr_b16 a[198:199], v3 offset:39168
 v_accvgpr_read_b32 v28, a121
 v_mul_f32 v27, v27, v26
 v_mul_f32 v28, v28, v26
 v_cvt_pk_bf16_f32 v220, v27, v28
 s_waitcnt lgkmcnt(4)
 v_mfma_f32_32x32x16_bf16 v[96:111], a[216:219], v[188:191], v[96:111]
 s_add_u32 m0, s32, 384
 ds_read_b64_tr_b16 a[200:201], v3 offset:34880
 buffer_load_dwordx4 v16, s[20:23], s31 offen offset:1792 lds
 ds_read_b64_tr_b16 a[202:203], v3 offset:39232
 v_accvgpr_read_b32 v29, a122
 v_mfma_f32_32x32x16_bf16 v[112:127], a[220:223], v[188:191], v[112:127]
 ds_read_b64_tr_b16 a[204:205], v3 offset:34944
 ds_read_b64_tr_b16 a[206:207], v3 offset:39296
 v_accvgpr_read_b32 v30, a123
 v_mul_f32 v29, v29, v26
 v_mul_f32 v30, v30, v26
 v_cvt_pk_bf16_f32 v221, v29, v30
 s_waitcnt lgkmcnt(4)
 v_mfma_f32_32x32x16_bf16 v[128:143], a[192:195], v[188:191], v[128:143]
 s_add_u32 m0, s32, 576
 ds_read_b64_tr_b16 a[208:209], v3 offset:35008
 buffer_load_dwordx4 v16, s[20:23], s31 offen offset:2688 lds
 ds_read_b64_tr_b16 a[210:211], v3 offset:39360
 ds_read_b64_tr_b16 a[212:213], v3 offset:35072
 ds_read_b64_tr_b16 a[214:215], v3 offset:39424
 v_mfma_f32_32x32x16_bf16 v[32:47], a[196:199], a[156:159], v[32:47]
 ds_read_b64_tr_b16 a[216:217], v3 offset:35136
 ds_read_b64_tr_b16 a[218:219], v3 offset:39488
 ds_read_b64_tr_b16 a[220:221], v3 offset:35200
 ds_read_b64_tr_b16 a[222:223], v3 offset:39552
 v_accvgpr_read_b32 v27, a124
 v_accvgpr_read_b32 v28, a125
 s_waitcnt lgkmcnt(8)
 v_mfma_f32_32x32x16_bf16 v[48:63], a[200:203], a[156:159], v[48:63]
 s_add_u32 s38, s38, 14336
 s_add_u32 m0, s32, 17408
 s_nop 0
 buffer_load_dwordx4 v16, s[20:23], s38 offen offset:0 lds
 v_mul_f32 v27, v27, v26
 v_mul_f32 v28, v28, v26
 v_mfma_f32_32x32x16_bf16 v[64:79], a[204:207], a[156:159], v[64:79]
 v_cvt_pk_bf16_f32 v222, v27, v28
 v_accvgpr_read_b32 v29, a126
 v_accvgpr_read_b32 v30, a127
 v_mul_f32 v29, v29, v26
 v_mul_f32 v30, v30, v26
 v_cvt_pk_bf16_f32 v223, v29, v30
 s_waitcnt lgkmcnt(4)
 v_mfma_f32_32x32x16_bf16 v[80:95], a[208:211], a[156:159], v[80:95]
 s_waitcnt vmcnt(13) lgkmcnt(0)
 s_barrier
 s_add_u32 m0, s32, 17600
 ds_read_b64_tr_b16 a[192:193], v2 offset:0
 buffer_load_dwordx4 v16, s[20:23], s38 offen offset:896 lds
 ds_read_b64_tr_b16 a[194:195], v2 offset:4352
 ds_write_b128 v17, v[220:223] offset:3072
 v_mfma_f32_32x32x16_bf16 v[96:111], a[212:215], a[156:159], v[96:111]
 ds_read_b64_tr_b16 a[196:197], v2 offset:64
 ds_read_b64_tr_b16 a[198:199], v2 offset:4416
 ds_read_b128 a[184:187], v18 offset:2048
 v_mfma_f32_32x32x16_bf16 v[112:127], a[216:219], a[156:159], v[112:127]
 s_add_u32 m0, s32, 17792
 ds_read_b64_tr_b16 a[200:201], v2 offset:128
 buffer_load_dwordx4 v16, s[20:23], s38 offen offset:1792 lds
 ds_read_b64_tr_b16 a[202:203], v2 offset:4480
 v_mfma_f32_32x32x16_bf16 v[128:143], a[220:223], a[156:159], v[128:143]
 ds_read_b64_tr_b16 a[204:205], v2 offset:192
 ds_read_b64_tr_b16 a[206:207], v2 offset:4544
 s_waitcnt lgkmcnt(5)
 v_mfma_f32_32x32x16_bf16 v[32:47], a[192:195], v[192:195], v[32:47]
 s_add_u32 m0, s32, 17984
 ds_read_b64_tr_b16 a[208:209], v2 offset:256
 buffer_load_dwordx4 v16, s[20:23], s38 offen offset:2688 lds
 ds_read_b64_tr_b16 a[210:211], v2 offset:4608
 v_mfma_f32_32x32x16_bf16 v[48:63], a[196:199], v[192:195], v[48:63]
 s_add_u32 s31, s31, 14336
 s_add_u32 m0, s32, 34816
 ds_read_b64_tr_b16 a[212:213], v2 offset:320
 buffer_load_dwordx4 v16, s[20:23], s31 offen offset:0 lds
 ds_read_b64_tr_b16 a[214:215], v2 offset:4672
 s_waitcnt lgkmcnt(4)
 v_mfma_f32_32x32x16_bf16 v[64:79], a[200:203], v[192:195], v[64:79]
 s_add_u32 m0, s32, 35008
 ds_read_b64_tr_b16 a[216:217], v2 offset:384
 buffer_load_dwordx4 v16, s[20:23], s31 offen offset:896 lds
 ds_read_b64_tr_b16 a[218:219], v2 offset:4736
 v_mfma_f32_32x32x16_bf16 v[80:95], a[204:207], v[192:195], v[80:95]
 ds_read_b64_tr_b16 a[220:221], v25 offset:0
 ds_read_b64_tr_b16 a[222:223], v25 offset:4352
 s_waitcnt lgkmcnt(4)
 v_mfma_f32_32x32x16_bf16 v[96:111], a[208:211], v[192:195], v[96:111]
 s_add_u32 m0, s32, 35200
 ds_read_b64_tr_b16 a[192:193], v25 offset:64
 buffer_load_dwordx4 v16, s[20:23], s31 offen offset:1792 lds
 ds_read_b64_tr_b16 a[194:195], v25 offset:4416
 v_mfma_f32_32x32x16_bf16 v[112:127], a[212:215], v[192:195], v[112:127]
 ds_read_b64_tr_b16 a[196:197], v25 offset:128
 ds_read_b64_tr_b16 a[198:199], v25 offset:4480
 s_waitcnt lgkmcnt(4)
 v_mfma_f32_32x32x16_bf16 v[128:143], a[216:219], v[192:195], v[128:143]
 s_add_u32 m0, s32, 35392
 ds_read_b64_tr_b16 a[200:201], v25 offset:192
 buffer_load_dwordx4 v16, s[20:23], s31 offen offset:2688 lds
 ds_read_b64_tr_b16 a[202:203], v25 offset:4544
 ds_read_b64_tr_b16 a[204:205], v25 offset:256
 ds_read_b64_tr_b16 a[206:207], v25 offset:4608
 v_mfma_f32_32x32x16_bf16 v[32:47], a[220:223], a[160:163], v[32:47]
 ds_read_b64_tr_b16 a[208:209], v25 offset:320
 ds_read_b64_tr_b16 a[210:211], v25 offset:4672
 ds_read_b64_tr_b16 a[212:213], v25 offset:384
 ds_read_b64_tr_b16 a[214:215], v25 offset:4736
 s_waitcnt lgkmcnt(8)
 v_mfma_f32_32x32x16_bf16 v[48:63], a[192:195], a[160:163], v[48:63]
 s_add_u32 s38, s38, 14336
 s_add_u32 m0, s32, 52224
 s_nop 0
 buffer_load_dwordx4 v16, s[20:23], s38 offen offset:0 lds
 v_mfma_f32_32x32x16_bf16 v[64:79], a[196:199], a[160:163], v[64:79]
 s_waitcnt lgkmcnt(4)
 v_mfma_f32_32x32x16_bf16 v[80:95], a[200:203], a[160:163], v[80:95]
 s_waitcnt vmcnt(13) lgkmcnt(0)
 s_barrier
 s_add_u32 m0, s32, 52416
 ds_read_b64_tr_b16 a[216:217], v2 offset:34816
 buffer_load_dwordx4 v16, s[20:23], s38 offen offset:896 lds
 ds_read_b64_tr_b16 a[218:219], v2 offset:39168
 ds_read_b128 a[188:191], v18 offset:3072
 v_mfma_f32_32x32x16_bf16 v[96:111], a[204:207], a[160:163], v[96:111]
 ds_read_b64_tr_b16 a[220:221], v2 offset:34880
 ds_read_b64_tr_b16 a[222:223], v2 offset:39232
 v_mfma_f32_32x32x16_bf16 v[112:127], a[208:211], a[160:163], v[112:127]
 s_add_u32 m0, s32, 52608
 ds_read_b64_tr_b16 a[192:193], v2 offset:34944
 buffer_load_dwordx4 v16, s[20:23], s38 offen offset:1792 lds
 ds_read_b64_tr_b16 a[194:195], v2 offset:39296
 v_mfma_f32_32x32x16_bf16 v[128:143], a[212:215], a[160:163], v[128:143]
 ds_read_b64_tr_b16 a[196:197], v2 offset:35008
 ds_read_b64_tr_b16 a[198:199], v2 offset:39360
 s_waitcnt lgkmcnt(4)
 v_mfma_f32_32x32x16_bf16 v[32:47], a[216:219], v[196:199], v[32:47]
 s_add_u32 m0, s32, 52800
 ds_read_b64_tr_b16 a[200:201], v2 offset:35072
 buffer_load_dwordx4 v16, s[20:23], s38 offen offset:2688 lds
 ds_read_b64_tr_b16 a[202:203], v2 offset:39424
 v_mfma_f32_32x32x16_bf16 v[48:63], a[220:223], v[196:199], v[48:63]
 s_add_u32 s31, s31, 14336
 s_add_u32 m0, s32, 69632
 ds_read_b64_tr_b16 a[204:205], v2 offset:35136
 buffer_load_dwordx4 v16, s[20:23], s31 offen offset:0 lds
 ds_read_b64_tr_b16 a[206:207], v2 offset:39488
 s_waitcnt lgkmcnt(4)
 v_mfma_f32_32x32x16_bf16 v[64:79], a[192:195], v[196:199], v[64:79]
 s_add_u32 m0, s32, 69824
 ds_read_b64_tr_b16 a[208:209], v2 offset:35200
 buffer_load_dwordx4 v16, s[20:23], s31 offen offset:896 lds
 ds_read_b64_tr_b16 a[210:211], v2 offset:39552
 v_mfma_f32_32x32x16_bf16 v[80:95], a[196:199], v[196:199], v[80:95]
 ds_read_b64_tr_b16 a[212:213], v25 offset:34816
 ds_read_b64_tr_b16 a[214:215], v25 offset:39168
 s_waitcnt lgkmcnt(4)
 v_mfma_f32_32x32x16_bf16 v[96:111], a[200:203], v[196:199], v[96:111]
 s_add_u32 m0, s32, 70016
 ds_read_b64_tr_b16 a[216:217], v25 offset:34880
 buffer_load_dwordx4 v16, s[20:23], s31 offen offset:1792 lds
 ds_read_b64_tr_b16 a[218:219], v25 offset:39232
 v_mfma_f32_32x32x16_bf16 v[112:127], a[204:207], v[196:199], v[112:127]
 ds_read_b64_tr_b16 a[220:221], v25 offset:34944
 ds_read_b64_tr_b16 a[222:223], v25 offset:39296
 s_waitcnt lgkmcnt(4)
 v_mfma_f32_32x32x16_bf16 v[128:143], a[208:211], v[196:199], v[128:143]
 s_add_u32 m0, s32, 70208
 ds_read_b64_tr_b16 a[192:193], v25 offset:35008
 buffer_load_dwordx4 v16, s[20:23], s31 offen offset:2688 lds
 ds_read_b64_tr_b16 a[194:195], v25 offset:39360
 ds_read_b64_tr_b16 a[196:197], v25 offset:35072
 ds_read_b64_tr_b16 a[198:199], v25 offset:39424
 v_mfma_f32_32x32x16_bf16 v[32:47], a[212:215], a[164:167], v[32:47]
 ds_read_b64_tr_b16 a[200:201], v25 offset:35136
 ds_read_b64_tr_b16 a[202:203], v25 offset:39488
 ds_read_b64_tr_b16 a[204:205], v25 offset:35200
 ds_read_b64_tr_b16 a[206:207], v25 offset:39552
 s_waitcnt lgkmcnt(8)
 v_mfma_f32_32x32x16_bf16 v[48:63], a[216:219], a[164:167], v[48:63]
 s_add_u32 s38, s38, 14336
 s_add_u32 m0, s32, 87040
 s_nop 0
 buffer_load_dwordx4 v16, s[20:23], s38 offen offset:0 lds
 v_mfma_f32_32x32x16_bf16 v[64:79], a[220:223], a[164:167], v[64:79]
 s_waitcnt lgkmcnt(4)
 v_mfma_f32_32x32x16_bf16 v[80:95], a[192:195], a[164:167], v[80:95]
 s_waitcnt vmcnt(13) lgkmcnt(0)
 s_barrier
 s_add_u32 m0, s32, 87232
 ds_read_b64_tr_b16 a[208:209], v1 offset:0
 buffer_load_dwordx4 v16, s[20:23], s38 offen offset:896 lds
 ds_read_b64_tr_b16 a[210:211], v1 offset:4352
 v_mfma_f32_32x32x16_bf16 v[96:111], a[196:199], a[164:167], v[96:111]
 ds_read_b64_tr_b16 a[212:213], v1 offset:64
 ds_read_b64_tr_b16 a[214:215], v1 offset:4416
 v_mfma_f32_32x32x16_bf16 v[112:127], a[200:203], a[164:167], v[112:127]
 s_add_u32 m0, s32, 87424
 ds_read_b64_tr_b16 a[216:217], v1 offset:128
 buffer_load_dwordx4 v16, s[20:23], s38 offen offset:1792 lds
 ds_read_b64_tr_b16 a[218:219], v1 offset:4480
 v_mfma_f32_32x32x16_bf16 v[128:143], a[204:207], a[164:167], v[128:143]
 ds_read_b64_tr_b16 a[220:221], v1 offset:192
 ds_read_b64_tr_b16 a[222:223], v1 offset:4544
 s_waitcnt lgkmcnt(4)
 v_mfma_f32_32x32x16_bf16 v[32:47], a[208:211], v[200:203], v[32:47]
 s_add_u32 m0, s32, 87616
 ds_read_b64_tr_b16 a[192:193], v1 offset:256
 buffer_load_dwordx4 v16, s[20:23], s38 offen offset:2688 lds
 ds_read_b64_tr_b16 a[194:195], v1 offset:4608
 v_mfma_f32_32x32x16_bf16 v[48:63], a[212:215], v[200:203], v[48:63]
 s_add_u32 s31, s31, 14336
 s_add_u32 m0, s32, 104448
 ds_read_b64_tr_b16 a[196:197], v1 offset:320
 buffer_load_dwordx4 v16, s[20:23], s31 offen offset:0 lds
 ds_read_b64_tr_b16 a[198:199], v1 offset:4672
 s_waitcnt lgkmcnt(4)
 v_mfma_f32_32x32x16_bf16 v[64:79], a[216:219], v[200:203], v[64:79]
 s_add_u32 m0, s32, 104640
 ds_read_b64_tr_b16 a[200:201], v1 offset:384
 buffer_load_dwordx4 v16, s[20:23], s31 offen offset:896 lds
 ds_read_b64_tr_b16 a[202:203], v1 offset:4736
 v_mfma_f32_32x32x16_bf16 v[80:95], a[220:223], v[200:203], v[80:95]
 ds_read_b64_tr_b16 a[204:205], v3 offset:0
 ds_read_b64_tr_b16 a[206:207], v3 offset:4352
 s_waitcnt lgkmcnt(4)
 v_mfma_f32_32x32x16_bf16 v[96:111], a[192:195], v[200:203], v[96:111]
 s_add_u32 m0, s32, 104832
 ds_read_b64_tr_b16 a[208:209], v3 offset:64
 buffer_load_dwordx4 v16, s[20:23], s31 offen offset:1792 lds
 ds_read_b64_tr_b16 a[210:211], v3 offset:4416
 v_mfma_f32_32x32x16_bf16 v[112:127], a[196:199], v[200:203], v[112:127]
 ds_read_b64_tr_b16 a[212:213], v3 offset:128
 ds_read_b64_tr_b16 a[214:215], v3 offset:4480
 s_waitcnt lgkmcnt(4)
 v_mfma_f32_32x32x16_bf16 v[128:143], a[200:203], v[200:203], v[128:143]
 s_add_u32 m0, s32, 105024
 ds_read_b64_tr_b16 a[216:217], v3 offset:192
 buffer_load_dwordx4 v16, s[20:23], s31 offen offset:2688 lds
 ds_read_b64_tr_b16 a[218:219], v3 offset:4544
 ds_read_b64_tr_b16 a[220:221], v3 offset:256
 ds_read_b64_tr_b16 a[222:223], v3 offset:4608
 v_mfma_f32_32x32x16_bf16 v[32:47], a[204:207], a[168:171], v[32:47]
 ds_read_b64_tr_b16 a[192:193], v3 offset:320
 ds_read_b64_tr_b16 a[194:195], v3 offset:4672
 ds_read_b64_tr_b16 a[196:197], v3 offset:384
 ds_read_b64_tr_b16 a[198:199], v3 offset:4736
 s_waitcnt lgkmcnt(8)
 v_mfma_f32_32x32x16_bf16 v[48:63], a[208:211], a[168:171], v[48:63]
 s_add_u32 s38, s38, 14336
 s_add_u32 m0, s32, 121856
 s_nop 0
 buffer_load_dwordx4 v16, s[20:23], s38 offen offset:0 lds
 v_mfma_f32_32x32x16_bf16 v[64:79], a[212:215], a[168:171], v[64:79]
 s_waitcnt lgkmcnt(4)
 v_mfma_f32_32x32x16_bf16 v[80:95], a[216:219], a[168:171], v[80:95]
 s_waitcnt vmcnt(13) lgkmcnt(0)
 s_barrier
 s_add_u32 m0, s32, 122048
 ds_read_b64_tr_b16 a[200:201], v1 offset:34816
 buffer_load_dwordx4 v16, s[20:23], s38 offen offset:896 lds
 ds_read_b64_tr_b16 a[202:203], v1 offset:39168
 v_mfma_f32_32x32x16_bf16 v[96:111], a[220:223], a[168:171], v[96:111]
 ds_read_b64_tr_b16 a[204:205], v1 offset:34880
 ds_read_b64_tr_b16 a[206:207], v1 offset:39232
 v_mfma_f32_32x32x16_bf16 v[112:127], a[192:195], a[168:171], v[112:127]
 s_add_u32 m0, s32, 122240
 ds_read_b64_tr_b16 a[208:209], v1 offset:34944
 buffer_load_dwordx4 v16, s[20:23], s38 offen offset:1792 lds
 ds_read_b64_tr_b16 a[210:211], v1 offset:39296
 v_mfma_f32_32x32x16_bf16 v[128:143], a[196:199], a[168:171], v[128:143]
 ds_read_b64_tr_b16 a[212:213], v1 offset:35008
 ds_read_b64_tr_b16 a[214:215], v1 offset:39360
 s_waitcnt lgkmcnt(4)
 v_mfma_f32_32x32x16_bf16 v[32:47], a[200:203], v[204:207], v[32:47]
 s_add_u32 m0, s32, 122432
 ds_read_b64_tr_b16 a[216:217], v1 offset:35072
 buffer_load_dwordx4 v16, s[20:23], s38 offen offset:2688 lds
 ds_read_b64_tr_b16 a[218:219], v1 offset:39424
 v_mfma_f32_32x32x16_bf16 v[48:63], a[204:207], v[204:207], v[48:63]
 s_add_u32 s31, s31, 14336
 s_add_u32 m0, s32, 0
 ds_read_b64_tr_b16 a[220:221], v1 offset:35136
 buffer_load_dwordx4 v16, s[20:23], s31 offen offset:0 lds
 ds_read_b64_tr_b16 a[222:223], v1 offset:39488
 s_waitcnt lgkmcnt(4)
 v_mfma_f32_32x32x16_bf16 v[64:79], a[208:211], v[204:207], v[64:79]
 s_add_u32 m0, s32, 192
 ds_read_b64_tr_b16 a[192:193], v1 offset:35200
 buffer_load_dwordx4 v16, s[20:23], s31 offen offset:896 lds
 ds_read_b64_tr_b16 a[194:195], v1 offset:39552
 v_mfma_f32_32x32x16_bf16 v[80:95], a[212:215], v[204:207], v[80:95]
 ds_read_b64_tr_b16 a[196:197], v3 offset:34816
 ds_read_b64_tr_b16 a[198:199], v3 offset:39168
 s_waitcnt lgkmcnt(4)
 v_mfma_f32_32x32x16_bf16 v[96:111], a[216:219], v[204:207], v[96:111]
 s_add_u32 m0, s32, 384
 ds_read_b64_tr_b16 a[200:201], v3 offset:34880
 buffer_load_dwordx4 v16, s[20:23], s31 offen offset:1792 lds
 ds_read_b64_tr_b16 a[202:203], v3 offset:39232
 v_mfma_f32_32x32x16_bf16 v[112:127], a[220:223], v[204:207], v[112:127]
 ds_read_b64_tr_b16 a[204:205], v3 offset:34944
 ds_read_b64_tr_b16 a[206:207], v3 offset:39296
 s_waitcnt lgkmcnt(4)
 v_mfma_f32_32x32x16_bf16 v[128:143], a[192:195], v[204:207], v[128:143]
 s_add_u32 m0, s32, 576
 ds_read_b64_tr_b16 a[208:209], v3 offset:35008
 buffer_load_dwordx4 v16, s[20:23], s31 offen offset:2688 lds
 ds_read_b64_tr_b16 a[210:211], v3 offset:39360
 ds_read_b64_tr_b16 a[212:213], v3 offset:35072
 ds_read_b64_tr_b16 a[214:215], v3 offset:39424
 v_mfma_f32_32x32x16_bf16 v[32:47], a[196:199], a[172:175], v[32:47]
 ds_read_b64_tr_b16 a[216:217], v3 offset:35136
 ds_read_b64_tr_b16 a[218:219], v3 offset:39488
 ds_read_b64_tr_b16 a[220:221], v3 offset:35200
 ds_read_b64_tr_b16 a[222:223], v3 offset:39552
 s_waitcnt lgkmcnt(8)
 v_mfma_f32_32x32x16_bf16 v[48:63], a[200:203], a[172:175], v[48:63]
 s_add_u32 s38, s38, 14336
 s_add_u32 m0, s32, 17408
 s_nop 0
 buffer_load_dwordx4 v16, s[20:23], s38 offen offset:0 lds
 v_mfma_f32_32x32x16_bf16 v[64:79], a[204:207], a[172:175], v[64:79]
 s_waitcnt lgkmcnt(4)
 v_mfma_f32_32x32x16_bf16 v[80:95], a[208:211], a[172:175], v[80:95]
 s_waitcnt vmcnt(13) lgkmcnt(0)
 s_barrier
 s_add_u32 m0, s32, 17600
 ds_read_b64_tr_b16 a[192:193], v2 offset:0
 buffer_load_dwordx4 v16, s[20:23], s38 offen offset:896 lds
 ds_read_b64_tr_b16 a[194:195], v2 offset:4352
 v_mfma_f32_32x32x16_bf16 v[96:111], a[212:215], a[172:175], v[96:111]
 ds_read_b64_tr_b16 a[196:197], v2 offset:64
 ds_read_b64_tr_b16 a[198:199], v2 offset:4416
 v_mfma_f32_32x32x16_bf16 v[112:127], a[216:219], a[172:175], v[112:127]
 s_add_u32 m0, s32, 17792
 ds_read_b64_tr_b16 a[200:201], v2 offset:128
 buffer_load_dwordx4 v16, s[20:23], s38 offen offset:1792 lds
 ds_read_b64_tr_b16 a[202:203], v2 offset:4480
 v_mfma_f32_32x32x16_bf16 v[128:143], a[220:223], a[172:175], v[128:143]
 ds_read_b64_tr_b16 a[204:205], v2 offset:192
 ds_read_b64_tr_b16 a[206:207], v2 offset:4544
 s_waitcnt lgkmcnt(4)
 v_mfma_f32_32x32x16_bf16 v[32:47], a[192:195], v[208:211], v[32:47]
 s_add_u32 m0, s32, 17984
 ds_read_b64_tr_b16 a[208:209], v2 offset:256
 buffer_load_dwordx4 v16, s[20:23], s38 offen offset:2688 lds
 ds_read_b64_tr_b16 a[210:211], v2 offset:4608
 v_mfma_f32_32x32x16_bf16 v[48:63], a[196:199], v[208:211], v[48:63]
 s_add_u32 s31, s31, 14336
 s_add_u32 m0, s32, 34816
 ds_read_b64_tr_b16 a[212:213], v2 offset:320
 buffer_load_dwordx4 v16, s[20:23], s31 offen offset:0 lds
 ds_read_b64_tr_b16 a[214:215], v2 offset:4672
 s_waitcnt lgkmcnt(4)
 v_mfma_f32_32x32x16_bf16 v[64:79], a[200:203], v[208:211], v[64:79]
 s_add_u32 m0, s32, 35008
 ds_read_b64_tr_b16 a[216:217], v2 offset:384
 buffer_load_dwordx4 v16, s[20:23], s31 offen offset:896 lds
 ds_read_b64_tr_b16 a[218:219], v2 offset:4736
 v_mfma_f32_32x32x16_bf16 v[80:95], a[204:207], v[208:211], v[80:95]
 ds_read_b64_tr_b16 a[220:221], v25 offset:0
 ds_read_b64_tr_b16 a[222:223], v25 offset:4352
 s_waitcnt lgkmcnt(4)
 v_mfma_f32_32x32x16_bf16 v[96:111], a[208:211], v[208:211], v[96:111]
 s_add_u32 m0, s32, 35200
 ds_read_b64_tr_b16 a[192:193], v25 offset:64
 buffer_load_dwordx4 v16, s[20:23], s31 offen offset:1792 lds
 ds_read_b64_tr_b16 a[194:195], v25 offset:4416
 v_mfma_f32_32x32x16_bf16 v[112:127], a[212:215], v[208:211], v[112:127]
 ds_read_b64_tr_b16 a[196:197], v25 offset:128
 ds_read_b64_tr_b16 a[198:199], v25 offset:4480
 s_waitcnt lgkmcnt(4)
 v_mfma_f32_32x32x16_bf16 v[128:143], a[216:219], v[208:211], v[128:143]
 s_add_u32 m0, s32, 35392
 ds_read_b64_tr_b16 a[200:201], v25 offset:192
 buffer_load_dwordx4 v16, s[20:23], s31 offen offset:2688 lds
 ds_read_b64_tr_b16 a[202:203], v25 offset:4544
 ds_read_b64_tr_b16 a[204:205], v25 offset:256
 ds_read_b64_tr_b16 a[206:207], v25 offset:4608
 v_mfma_f32_32x32x16_bf16 v[32:47], a[220:223], a[176:179], v[32:47]
 ds_read_b64_tr_b16 a[208:209], v25 offset:320
 ds_read_b64_tr_b16 a[210:211], v25 offset:4672
 ds_read_b64_tr_b16 a[212:213], v25 offset:384
 ds_read_b64_tr_b16 a[214:215], v25 offset:4736
 s_waitcnt lgkmcnt(8)
 v_mfma_f32_32x32x16_bf16 v[48:63], a[192:195], a[176:179], v[48:63]
 s_add_u32 s38, s38, 14336
 s_add_u32 m0, s32, 52224
 s_nop 0
 buffer_load_dwordx4 v16, s[20:23], s38 offen offset:0 lds
 v_mfma_f32_32x32x16_bf16 v[64:79], a[196:199], a[176:179], v[64:79]
 s_waitcnt lgkmcnt(4)
 v_mfma_f32_32x32x16_bf16 v[80:95], a[200:203], a[176:179], v[80:95]
 s_waitcnt vmcnt(13) lgkmcnt(0)
 s_barrier
 s_add_u32 m0, s32, 52416
 ds_read_b64_tr_b16 a[216:217], v2 offset:34816
 buffer_load_dwordx4 v16, s[20:23], s38 offen offset:896 lds
 ds_read_b64_tr_b16 a[218:219], v2 offset:39168
 v_mfma_f32_32x32x16_bf16 v[96:111], a[204:207], a[176:179], v[96:111]
 ds_read_b64_tr_b16 a[220:221], v2 offset:34880
 ds_read_b64_tr_b16 a[222:223], v2 offset:39232
 v_mfma_f32_32x32x16_bf16 v[112:127], a[208:211], a[176:179], v[112:127]
 s_add_u32 m0, s32, 52608
 ds_read_b64_tr_b16 a[192:193], v2 offset:34944
 buffer_load_dwordx4 v16, s[20:23], s38 offen offset:1792 lds
 ds_read_b64_tr_b16 a[194:195], v2 offset:39296
 v_mfma_f32_32x32x16_bf16 v[128:143], a[212:215], a[176:179], v[128:143]
 ds_read_b64_tr_b16 a[196:197], v2 offset:35008
 ds_read_b64_tr_b16 a[198:199], v2 offset:39360
 s_waitcnt lgkmcnt(4)
 v_mfma_f32_32x32x16_bf16 v[32:47], a[216:219], v[212:215], v[32:47]
 s_add_u32 m0, s32, 52800
 ds_read_b64_tr_b16 a[200:201], v2 offset:35072
 buffer_load_dwordx4 v16, s[20:23], s38 offen offset:2688 lds
 ds_read_b64_tr_b16 a[202:203], v2 offset:39424
 v_mfma_f32_32x32x16_bf16 v[48:63], a[220:223], v[212:215], v[48:63]
 ds_read_b64_tr_b16 a[204:205], v2 offset:35136
 ds_read_b64_tr_b16 a[206:207], v2 offset:39488
 s_waitcnt lgkmcnt(4)
 v_mfma_f32_32x32x16_bf16 v[64:79], a[192:195], v[212:215], v[64:79]
 ds_read_b64_tr_b16 a[208:209], v2 offset:35200
 ds_read_b64_tr_b16 a[210:211], v2 offset:39552
 v_mfma_f32_32x32x16_bf16 v[80:95], a[196:199], v[212:215], v[80:95]
 ds_read_b64_tr_b16 a[212:213], v25 offset:34816
 ds_read_b64_tr_b16 a[214:215], v25 offset:39168
 s_waitcnt lgkmcnt(4)
 v_mfma_f32_32x32x16_bf16 v[96:111], a[200:203], v[212:215], v[96:111]
 ds_read_b64_tr_b16 a[216:217], v25 offset:34880
 ds_read_b64_tr_b16 a[218:219], v25 offset:39232
 v_mfma_f32_32x32x16_bf16 v[112:127], a[204:207], v[212:215], v[112:127]
 ds_read_b64_tr_b16 a[220:221], v25 offset:34944
 ds_read_b64_tr_b16 a[222:223], v25 offset:39296
 s_waitcnt lgkmcnt(4)
 v_mfma_f32_32x32x16_bf16 v[128:143], a[208:211], v[212:215], v[128:143]
 ds_read_b64_tr_b16 a[192:193], v25 offset:35008
 ds_read_b64_tr_b16 a[194:195], v25 offset:39360
 ds_read_b64_tr_b16 a[196:197], v25 offset:35072
 ds_read_b64_tr_b16 a[198:199], v25 offset:39424
 v_mfma_f32_32x32x16_bf16 v[32:47], a[212:215], a[180:183], v[32:47]
 ds_read_b64_tr_b16 a[200:201], v25 offset:35136
 ds_read_b64_tr_b16 a[202:203], v25 offset:39488
 ds_read_b64_tr_b16 a[204:205], v25 offset:35200
 ds_read_b64_tr_b16 a[206:207], v25 offset:39552
 s_waitcnt lgkmcnt(8)
 v_mfma_f32_32x32x16_bf16 v[48:63], a[216:219], a[180:183], v[48:63]
 v_mfma_f32_32x32x16_bf16 v[64:79], a[220:223], a[180:183], v[64:79]
 s_waitcnt lgkmcnt(4)
 v_mfma_f32_32x32x16_bf16 v[80:95], a[192:195], a[180:183], v[80:95]
 s_waitcnt vmcnt(8) lgkmcnt(0)
 s_barrier
 ds_read_b64_tr_b16 a[208:209], v1 offset:0
 ds_read_b64_tr_b16 a[210:211], v1 offset:4352
 v_mfma_f32_32x32x16_bf16 v[96:111], a[196:199], a[180:183], v[96:111]
 ds_read_b64_tr_b16 a[212:213], v1 offset:64
 ds_read_b64_tr_b16 a[214:215], v1 offset:4416
 v_mfma_f32_32x32x16_bf16 v[112:127], a[200:203], a[180:183], v[112:127]
 ds_read_b64_tr_b16 a[216:217], v1 offset:128
 ds_read_b64_tr_b16 a[218:219], v1 offset:4480
 v_mfma_f32_32x32x16_bf16 v[128:143], a[204:207], a[180:183], v[128:143]
 ds_read_b64_tr_b16 a[220:221], v1 offset:192
 ds_read_b64_tr_b16 a[222:223], v1 offset:4544
 s_waitcnt lgkmcnt(4)
 v_mfma_f32_32x32x16_bf16 v[32:47], a[208:211], v[216:219], v[32:47]
 ds_read_b64_tr_b16 a[192:193], v1 offset:256
 ds_read_b64_tr_b16 a[194:195], v1 offset:4608
 v_mfma_f32_32x32x16_bf16 v[48:63], a[212:215], v[216:219], v[48:63]
 ds_read_b64_tr_b16 a[196:197], v1 offset:320
 ds_read_b64_tr_b16 a[198:199], v1 offset:4672
 s_waitcnt lgkmcnt(4)
 v_mfma_f32_32x32x16_bf16 v[64:79], a[216:219], v[216:219], v[64:79]
 ds_read_b64_tr_b16 a[200:201], v1 offset:384
 ds_read_b64_tr_b16 a[202:203], v1 offset:4736
 v_mfma_f32_32x32x16_bf16 v[80:95], a[220:223], v[216:219], v[80:95]
 ds_read_b64_tr_b16 a[204:205], v3 offset:0
 ds_read_b64_tr_b16 a[206:207], v3 offset:4352
 s_waitcnt lgkmcnt(4)
 v_mfma_f32_32x32x16_bf16 v[96:111], a[192:195], v[216:219], v[96:111]
 ds_read_b64_tr_b16 a[208:209], v3 offset:64
 ds_read_b64_tr_b16 a[210:211], v3 offset:4416
 v_mfma_f32_32x32x16_bf16 v[112:127], a[196:199], v[216:219], v[112:127]
 ds_read_b64_tr_b16 a[212:213], v3 offset:128
 ds_read_b64_tr_b16 a[214:215], v3 offset:4480
 s_waitcnt lgkmcnt(4)
 v_mfma_f32_32x32x16_bf16 v[128:143], a[200:203], v[216:219], v[128:143]
 ds_read_b64_tr_b16 a[216:217], v3 offset:192
 ds_read_b64_tr_b16 a[218:219], v3 offset:4544
 ds_read_b64_tr_b16 a[220:221], v3 offset:256
 ds_read_b64_tr_b16 a[222:223], v3 offset:4608
 v_mfma_f32_32x32x16_bf16 v[32:47], a[204:207], a[184:187], v[32:47]
 ds_read_b64_tr_b16 a[192:193], v3 offset:320
 ds_read_b64_tr_b16 a[194:195], v3 offset:4672
 ds_read_b64_tr_b16 a[196:197], v3 offset:384
 ds_read_b64_tr_b16 a[198:199], v3 offset:4736
 s_waitcnt lgkmcnt(8)
 v_mfma_f32_32x32x16_bf16 v[48:63], a[208:211], a[184:187], v[48:63]
 v_mfma_f32_32x32x16_bf16 v[64:79], a[212:215], a[184:187], v[64:79]
 s_waitcnt lgkmcnt(4)
 v_mfma_f32_32x32x16_bf16 v[80:95], a[216:219], a[184:187], v[80:95]
 s_waitcnt vmcnt(0) lgkmcnt(0)
 s_barrier
 ds_read_b64_tr_b16 a[200:201], v1 offset:34816
 ds_read_b64_tr_b16 a[202:203], v1 offset:39168
 v_mfma_f32_32x32x16_bf16 v[96:111], a[220:223], a[184:187], v[96:111]
 ds_read_b64_tr_b16 a[204:205], v3 offset:34816
 ds_read_b64_tr_b16 a[206:207], v3 offset:39168
 v_mfma_f32_32x32x16_bf16 v[112:127], a[192:195], a[184:187], v[112:127]
 ds_read_b64_tr_b16 a[208:209], v1 offset:34880
 ds_read_b64_tr_b16 a[210:211], v1 offset:39232
 v_mfma_f32_32x32x16_bf16 v[128:143], a[196:199], a[184:187], v[128:143]
 ds_read_b64_tr_b16 a[212:213], v3 offset:34880
 ds_read_b64_tr_b16 a[214:215], v3 offset:39232
 s_waitcnt lgkmcnt(4)
 v_mfma_f32_32x32x16_bf16 v[32:47], a[200:203], v[220:223], v[32:47]
 ds_read_b64_tr_b16 a[216:217], v1 offset:34944
 ds_read_b64_tr_b16 a[218:219], v1 offset:39296
 v_mfma_f32_32x32x16_bf16 v[32:47], a[204:207], a[188:191], v[32:47]
 ds_read_b64_tr_b16 a[220:221], v3 offset:34944
 ds_read_b64_tr_b16 a[222:223], v3 offset:39296
 s_waitcnt lgkmcnt(4)
 v_mfma_f32_32x32x16_bf16 v[48:63], a[208:211], v[220:223], v[48:63]
 ds_read_b64_tr_b16 a[192:193], v1 offset:35008
 ds_read_b64_tr_b16 a[194:195], v1 offset:39360
 v_mfma_f32_32x32x16_bf16 v[48:63], a[212:215], a[188:191], v[48:63]
 ds_read_b64_tr_b16 a[196:197], v3 offset:35008
 ds_read_b64_tr_b16 a[198:199], v3 offset:39360
 s_waitcnt lgkmcnt(4)
 v_mfma_f32_32x32x16_bf16 v[64:79], a[216:219], v[220:223], v[64:79]
 ds_read_b64_tr_b16 a[200:201], v1 offset:35072
 ds_read_b64_tr_b16 a[202:203], v1 offset:39424
 v_cvt_pk_bf16_f32 v32, v32, v33
 v_cvt_pk_bf16_f32 v33, v34, v35
 v_cvt_pk_bf16_f32 v34, v36, v37
 v_cvt_pk_bf16_f32 v35, v38, v39
 v_mfma_f32_32x32x16_bf16 v[64:79], a[220:223], a[188:191], v[64:79]
 ds_read_b64_tr_b16 a[204:205], v3 offset:35072
 ds_read_b64_tr_b16 a[206:207], v3 offset:39424
 buffer_store_dwordx4 v[32:35], v19, s[24:27], s35 offen offset:0 sc1
 v_cvt_pk_bf16_f32 v40, v40, v41
 v_cvt_pk_bf16_f32 v41, v42, v43
 v_cvt_pk_bf16_f32 v42, v44, v45
 s_waitcnt lgkmcnt(4)
 v_mfma_f32_32x32x16_bf16 v[80:95], a[192:195], v[220:223], v[80:95]
 ds_read_b64_tr_b16 a[208:209], v1 offset:35136
 ds_read_b64_tr_b16 a[210:211], v1 offset:39488
 v_cvt_pk_bf16_f32 v43, v46, v47
 buffer_store_dwordx4 v[40:43], v19, s[24:27], s35 offen offset:1024 sc1
 v_cvt_pk_bf16_f32 v48, v48, v49
 v_cvt_pk_bf16_f32 v49, v50, v51
 v_mfma_f32_32x32x16_bf16 v[80:95], a[196:199], a[188:191], v[80:95]
 ds_read_b64_tr_b16 a[212:213], v3 offset:35136
 ds_read_b64_tr_b16 a[214:215], v3 offset:39488
 v_cvt_pk_bf16_f32 v50, v52, v53
 v_cvt_pk_bf16_f32 v51, v54, v55
 buffer_store_dwordx4 v[48:51], v19, s[24:27], s35 offen offset:2048 sc1
 v_cvt_pk_bf16_f32 v56, v56, v57
 s_waitcnt lgkmcnt(4)
 v_mfma_f32_32x32x16_bf16 v[96:111], a[200:203], v[220:223], v[96:111]
 ds_read_b64_tr_b16 a[216:217], v1 offset:35200
 ds_read_b64_tr_b16 a[218:219], v1 offset:39552
 v_cvt_pk_bf16_f32 v57, v58, v59
 v_cvt_pk_bf16_f32 v58, v60, v61
 v_cvt_pk_bf16_f32 v59, v62, v63
 buffer_store_dwordx4 v[56:59], v19, s[24:27], s35 offen offset:3072 sc1
 v_mfma_f32_32x32x16_bf16 v[96:111], a[204:207], a[188:191], v[96:111]
 ds_read_b64_tr_b16 a[220:221], v3 offset:35200
 ds_read_b64_tr_b16 a[222:223], v3 offset:39552
 v_cvt_pk_bf16_f32 v64, v64, v65
 v_cvt_pk_bf16_f32 v65, v66, v67
 v_cvt_pk_bf16_f32 v66, v68, v69
 v_cvt_pk_bf16_f32 v67, v70, v71
 s_waitcnt lgkmcnt(4)
 v_mfma_f32_32x32x16_bf16 v[112:127], a[208:211], v[220:223], v[112:127]
 s_add_u32 s35, s35, 4096
 buffer_store_dwordx4 v[64:67], v19, s[24:27], s35 offen offset:0 sc1
 v_cvt_pk_bf16_f32 v72, v72, v73
 v_cvt_pk_bf16_f32 v73, v74, v75
 v_cvt_pk_bf16_f32 v74, v76, v77
 v_cvt_pk_bf16_f32 v75, v78, v79
 v_mfma_f32_32x32x16_bf16 v[112:127], a[212:215], a[188:191], v[112:127]
 buffer_store_dwordx4 v[72:75], v19, s[24:27], s35 offen offset:1024 sc1
 v_cvt_pk_bf16_f32 v80, v80, v81
 v_cvt_pk_bf16_f32 v81, v82, v83
 v_cvt_pk_bf16_f32 v82, v84, v85
 v_cvt_pk_bf16_f32 v83, v86, v87
 buffer_store_dwordx4 v[80:83], v19, s[24:27], s35 offen offset:2048 sc1
 s_waitcnt lgkmcnt(2)
 v_mfma_f32_32x32x16_bf16 v[128:143], a[216:219], v[220:223], v[128:143]
 v_cvt_pk_bf16_f32 v88, v88, v89
 v_cvt_pk_bf16_f32 v89, v90, v91
 v_cvt_pk_bf16_f32 v90, v92, v93
 v_cvt_pk_bf16_f32 v91, v94, v95
 buffer_store_dwordx4 v[88:91], v19, s[24:27], s35 offen offset:3072 sc1
 v_cvt_pk_bf16_f32 v96, v96, v97
 s_waitcnt lgkmcnt(0)
 v_mfma_f32_32x32x16_bf16 v[128:143], a[220:223], a[188:191], v[128:143]
 v_cvt_pk_bf16_f32 v97, v98, v99
 v_cvt_pk_bf16_f32 v98, v100, v101
 v_cvt_pk_bf16_f32 v99, v102, v103
 s_add_u32 s35, s35, 4096
 buffer_store_dwordx4 v[96:99], v19, s[24:27], s35 offen offset:0 sc1
 v_cvt_pk_bf16_f32 v104, v104, v105
 v_cvt_pk_bf16_f32 v105, v106, v107
 v_cvt_pk_bf16_f32 v106, v108, v109
 v_cvt_pk_bf16_f32 v107, v110, v111
 buffer_store_dwordx4 v[104:107], v19, s[24:27], s35 offen offset:1024 sc1
 v_cvt_pk_bf16_f32 v112, v112, v113
 v_cvt_pk_bf16_f32 v113, v114, v115
 v_cvt_pk_bf16_f32 v114, v116, v117
 v_cvt_pk_bf16_f32 v115, v118, v119
 buffer_store_dwordx4 v[112:115], v19, s[24:27], s35 offen offset:2048 sc1
 v_cvt_pk_bf16_f32 v120, v120, v121
 v_cvt_pk_bf16_f32 v121, v122, v123
 v_cvt_pk_bf16_f32 v122, v124, v125
 v_cvt_pk_bf16_f32 v123, v126, v127
 buffer_store_dwordx4 v[120:123], v19, s[24:27], s35 offen offset:3072 sc1
 v_cvt_pk_bf16_f32 v128, v128, v129
 v_cvt_pk_bf16_f32 v129, v130, v131
 v_cvt_pk_bf16_f32 v130, v132, v133
 v_cvt_pk_bf16_f32 v131, v134, v135
 s_add_u32 s35, s35, 4096
 buffer_store_dwordx4 v[128:131], v19, s[24:27], s35 offen offset:0 sc1
 v_cvt_pk_bf16_f32 v136, v136, v137
 v_cvt_pk_bf16_f32 v137, v138, v139
 v_cvt_pk_bf16_f32 v138, v140, v141
 v_cvt_pk_bf16_f32 v139, v142, v143
 buffer_store_dwordx4 v[136:139], v19, s[24:27], s35 offen offset:1024 sc1
 s_add_u32 s64, s64, 1
 s_or_b32 s6, s2, s3
 s_cselect_b32 s6, 0x3000000, 0
 s_add_u32 s6, s6, 32768
 v_lshlrev_b32 v1, 4, v19
 v_lshl_add_u32 v1, v1, 18, s6
 v_mov_b32 v2, s64
 buffer_store_dword v2, v1, s[24:27], 0 offen sc1
K1_END:
 s_endpgm
.globl k2a_kernel
.p2align 8
.type k2a_kernel,@function
k2a_kernel:
 s_cmp_ge_u32 s2, 256
 s_cbranch_scc1 K2A_END
 s_load_dwordx2 s[4:5], s[0:1], 112
 s_load_dwordx2 s[6:7], s[0:1], 0
 v_lshrrev_b32 v1, 3, v0
 v_and_b32 v2, 7, v0
 v_lshlrev_b32 v3, 9, v1
 v_lshl_add_u32 v3, v2, 4, v3
 v_mul_u32_u24 v4, 896, v2
 v_lshl_add_u32 v4, v1, 4, v4
 v_lshlrev_b32 v5, 5, v1
 s_lshr_b32 s8, s2, 2
 s_and_b32 s9, s2, 3
 s_lshl_b32 s9, s9, 7
 s_mul_i32 s10, s8, 229376
 s_add_u32 s10, s10, s9
 s_add_u32 s10, s10, 18874368
 s_mul_i32 s11, s2, 7168
 s_waitcnt lgkmcnt(0)
 s_mov_b32 s12, s4
 s_mov_b32 s13, s5
 s_mov_b32 s14, 0x2300000
 s_mov_b32 s15, 0x00020000
 s_mov_b32 s16, s6
 s_mov_b32 s17, s7
 s_mov_b32 s18, 0x1c0000
 s_mov_b32 s19, 0x00020000
 buffer_load_dwordx4 v[8:11], v3, s[12:15], s10 offen
 s_add_u32 s10, s10, 28672
 buffer_load_dwordx4 v[12:15], v3, s[12:15], s10 offen
 s_add_u32 s10, s10, 28672
 buffer_load_dwordx4 v[16:19], v3, s[12:15], s10 offen
 s_add_u32 s10, s10, 28672
 buffer_load_dwordx4 v[20:23], v3, s[12:15], s10 offen
 s_add_u32 s10, s10, 28672
 buffer_load_dwordx4 v[24:27], v3, s[12:15], s10 offen
 s_add_u32 s10, s10, 28672
 buffer_load_dwordx4 v[28:31], v3, s[12:15], s10 offen
 s_add_u32 s10, s10, 28672
 buffer_load_dwordx4 v[32:35], v3, s[12:15], s10 offen
 s_add_u32 s10, s10, 28672
 buffer_load_dwordx4 v[36:39], v3, s[12:15], s10 offen
 buffer_load_dwordx4 v[40:43], v4, s[16:19], s11 offen
 s_movk_i32 s20, 3584
 buffer_load_dwordx4 v[44:47], v5, s[12:15], s20 offen offset:0
 buffer_load_dwordx4 v[48:51], v5, s[12:15], s20 offen offset:16
 buffer_load_dwordx4 v[52:55], v5, s[12:15], s20 offen offset:1792
 buffer_load_dwordx4 v[56:59], v5, s[12:15], s20 offen offset:1808
 buffer_load_dwordx4 v[60:63], v5, s[12:15], s20 offen offset:3584
 buffer_load_dwordx4 v[64:67], v5, s[12:15], s20 offen offset:3600
 s_mul_i32 s21, s8, 28672
 s_add_u32 s21, s21, s9
 s_add_u32 s22, s21, 4194304
 s_add_u32 s21, s21, 2097152
 v_lshrrev_b32 v6, 6, v0
 v_lshlrev_b32 v7, 3, v2
 v_lshl_add_u32 v6, v6, 6, v7
 s_waitcnt vmcnt(14)
 v_lshlrev_b32 v68, 16, v8
 v_and_b32 v69, 0xffff0000, v8
 v_lshlrev_b32 v70, 16, v9
 v_and_b32 v71, 0xffff0000, v9
 v_lshlrev_b32 v72, 16, v10
 v_and_b32 v73, 0xffff0000, v10
 v_lshlrev_b32 v74, 16, v11
 v_and_b32 v75, 0xffff0000, v11
 s_waitcnt vmcnt(13)
 v_lshlrev_b32 v76, 16, v12
 v_and_b32 v77, 0xffff0000, v12
 v_lshlrev_b32 v78, 16, v13
 v_and_b32 v79, 0xffff0000, v13
 v_lshlrev_b32 v80, 16, v14
 v_and_b32 v81, 0xffff0000, v14
 v_lshlrev_b32 v82, 16, v15
 v_and_b32 v83, 0xffff0000, v15
 v_pk_add_f32 v[68:69], v[68:69], v[76:77]
 v_pk_add_f32 v[70:71], v[70:71], v[78:79]
 v_pk_add_f32 v[72:73], v[72:73], v[80:81]
 v_pk_add_f32 v[74:75], v[74:75], v[82:83]
 s_waitcnt vmcnt(12)
 v_lshlrev_b32 v76, 16, v16
 v_and_b32 v77, 0xffff0000, v16
 v_lshlrev_b32 v78, 16, v17
 v_and_b32 v79, 0xffff0000, v17
 v_lshlrev_b32 v80, 16, v18
 v_and_b32 v81, 0xffff0000, v18
 v_lshlrev_b32 v82, 16, v19
 v_and_b32 v83, 0xffff0000, v19
 v_pk_add_f32 v[68:69], v[68:69], v[76:77]
 v_pk_add_f32 v[70:71], v[70:71], v[78:79]
 v_pk_add_f32 v[72:73], v[72:73], v[80:81]
 v_pk_add_f32 v[74:75], v[74:75], v[82:83]
 s_waitcnt vmcnt(11)
 v_lshlrev_b32 v76, 16, v20
 v_and_b32 v77, 0xffff0000, v20
 v_lshlrev_b32 v78, 16, v21
 v_and_b32 v79, 0xffff0000, v21
 v_lshlrev_b32 v80, 16, v22
 v_and_b32 v81, 0xffff0000, v22
 v_lshlrev_b32 v82, 16, v23
 v_and_b32 v83, 0xffff0000, v23
 v_pk_add_f32 v[68:69], v[68:69], v[76:77]
 v_pk_add_f32 v[70:71], v[70:71], v[78:79]
 v_pk_add_f32 v[72:73], v[72:73], v[80:81]
 v_pk_add_f32 v[74:75], v[74:75], v[82:83]
 s_waitcnt vmcnt(10)
 v_lshlrev_b32 v76, 16, v24
 v_and_b32 v77, 0xffff0000, v24
 v_lshlrev_b32 v78, 16, v25
 v_and_b32 v79, 0xffff0000, v25
 v_lshlrev_b32 v80, 16, v26
 v_and_b32 v81, 0xffff0000, v26
 v_lshlrev_b32 v82, 16, v27
 v_and_b32 v83, 0xffff0000, v27
 v_pk_add_f32 v[68:69], v[68:69], v[76:77]
 v_pk_add_f32 v[70:71], v[70:71], v[78:79]
 v_pk_add_f32 v[72:73], v[72:73], v[80:81]
 v_pk_add_f32 v[74:75], v[74:75], v[82:83]
 s_waitcnt vmcnt(9)
 v_lshlrev_b32 v76, 16, v28
 v_and_b32 v77, 0xffff0000, v28
 v_lshlrev_b32 v78, 16, v29
 v_and_b32 v79, 0xffff0000, v29
 v_lshlrev_b32 v80, 16, v30
 v_and_b32 v81, 0xffff0000, v30
 v_lshlrev_b32 v82, 16, v31
 v_and_b32 v83, 0xffff0000, v31
 v_pk_add_f32 v[68:69], v[68:69], v[76:77]
 v_pk_add_f32 v[70:71], v[70:71], v[78:79]
 v_pk_add_f32 v[72:73], v[72:73], v[80:81]
 v_pk_add_f32 v[74:75], v[74:75], v[82:83]
 s_waitcnt vmcnt(8)
 v_lshlrev_b32 v76, 16, v32
 v_and_b32 v77, 0xffff0000, v32
 v_lshlrev_b32 v78, 16, v33
 v_and_b32 v79, 0xffff0000, v33
 v_lshlrev_b32 v80, 16, v34
 v_and_b32 v81, 0xffff0000, v34
 v_lshlrev_b32 v82, 16, v35
 v_and_b32 v83, 0xffff0000, v35
 v_pk_add_f32 v[68:69], v[68:69], v[76:77]
 v_pk_add_f32 v[70:71], v[70:71], v[78:79]
 v_pk_add_f32 v[72:73], v[72:73], v[80:81]
 v_pk_add_f32 v[74:75], v[74:75], v[82:83]
 s_waitcnt vmcnt(7)
 v_lshlrev_b32 v76, 16, v36
 v_and_b32 v77, 0xffff0000, v36
 v_lshlrev_b32 v78, 16, v37
 v_and_b32 v79, 0xffff0000, v37
 v_lshlrev_b32 v80, 16, v38
 v_and_b32 v81, 0xffff0000, v38
 v_lshlrev_b32 v82, 16, v39
 v_and_b32 v83, 0xffff0000, v39
 v_pk_add_f32 v[68:69], v[68:69], v[76:77]
 v_pk_add_f32 v[70:71], v[70:71], v[78:79]
 v_pk_add_f32 v[72:73], v[72:73], v[80:81]
 v_pk_add_f32 v[74:75], v[74:75], v[82:83]
 s_waitcnt vmcnt(6)
 v_lshlrev_b32 v76, 16, v40
 v_and_b32 v77, 0xffff0000, v40
 v_lshlrev_b32 v78, 16, v41
 v_and_b32 v79, 0xffff0000, v41
 v_lshlrev_b32 v80, 16, v42
 v_and_b32 v81, 0xffff0000, v42
 v_lshlrev_b32 v82, 16, v43
 v_and_b32 v83, 0xffff0000, v43
 s_waitcnt vmcnt(5)
 v_pk_fma_f32 v[68:69], v[68:69], v[44:45], v[76:77]
 v_pk_fma_f32 v[70:71], v[70:71], v[46:47], v[78:79]
 s_waitcnt vmcnt(4)
 v_pk_fma_f32 v[72:73], v[72:73], v[48:49], v[80:81]
 v_pk_fma_f32 v[74:75], v[74:75], v[50:51], v[82:83]
 v_cvt_pk_bf16_f32 v8, v68, v69
 v_cvt_pk_bf16_f32 v9, v70, v71
 v_cvt_pk_bf16_f32 v10, v72, v73
 v_cvt_pk_bf16_f32 v11, v74, v75
 buffer_store_dwordx4 v[8:11], v3, s[12:15], s21 offen sc1
 v_lshlrev_b32 v68, 16, v8
 v_and_b32 v69, 0xffff0000, v8
 v_lshlrev_b32 v70, 16, v9
 v_and_b32 v71, 0xffff0000, v9
 v_lshlrev_b32 v72, 16, v10
 v_and_b32 v73, 0xffff0000, v10
 v_lshlrev_b32 v74, 16, v11
 v_and_b32 v75, 0xffff0000, v11
 v_pk_add_f32 v[12:13], v[68:69], v[70:71]
 v_pk_mul_f32 v[14:15], v[68:69], v[68:69]
 v_pk_fma_f32 v[14:15], v[70:71], v[70:71], v[14:15]
 v_pk_add_f32 v[12:13], v[12:13], v[72:73]
 v_pk_fma_f32 v[14:15], v[72:73], v[72:73], v[14:15]
 v_pk_add_f32 v[12:13], v[12:13], v[74:75]
 v_pk_fma_f32 v[14:15], v[74:75], v[74:75], v[14:15]
 v_add_f32 v12, v12, v13
 v_add_f32 v13, v14, v15
 s_nop 0
 v_add_f32_dpp v12, v12, v12 row_ror:8 row_mask:0xf bank_mask:0xf
 v_add_f32_dpp v13, v13, v13 row_ror:8 row_mask:0xf bank_mask:0xf
 v_mov_b32 v14, v12
 v_mov_b32 v15, v13
 s_nop 0
 v_permlane16_swap_b32 v12, v14
 v_permlane16_swap_b32 v13, v15
 v_add_f32 v12, v12, v14
 v_add_f32 v13, v13, v15
 v_mov_b32 v14, v12
 v_mov_b32 v15, v13
 s_nop 0
 v_permlane32_swap_b32 v12, v14
 v_permlane32_swap_b32 v13, v15
 v_add_f32 v12, v12, v14
 v_add_f32 v13, v13, v15
 ds_write_b64 v6, v[12:13]
 s_waitcnt lgkmcnt(0)
 s_barrier
 ds_read_b64 v[16:17], v7 offset:0
 ds_read_b64 v[18:19], v7 offset:64
 ds_read_b64 v[20:21], v7 offset:128
 ds_read_b64 v[22:23], v7 offset:192
 ds_read_b64 v[24:25], v7 offset:256
 ds_read_b64 v[26:27], v7 offset:320
 ds_read_b64 v[28:29], v7 offset:384
 s_waitcnt lgkmcnt(5)
 v_pk_add_f32 v[16:17], v[16:17], v[18:19]
 s_waitcnt lgkmcnt(4)
 v_pk_add_f32 v[16:17], v[16:17], v[20:21]
 s_waitcnt lgkmcnt(3)
 v_pk_add_f32 v[16:17], v[16:17], v[22:23]
 s_waitcnt lgkmcnt(2)
 v_pk_add_f32 v[16:17], v[16:17], v[24:25]
 s_waitcnt lgkmcnt(1)
 v_pk_add_f32 v[16:17], v[16:17], v[26:27]
 s_waitcnt lgkmcnt(0)
 v_pk_add_f32 v[16:17], v[16:17], v[28:29]
 v_mul_f32 v16, 0x3b124925, v16
 v_mov_b32 v18, 0x3727c5ac
 v_fmac_f32 v18, 0x3b124925, v17
 v_fma_f32 v18, -v16, v16, v18
 v_max_f32 v18, 0x3727c5ac, v18
 v_rsq_f32 v18, v18
 v_mul_f32 v16, -1.0, v16
 v_mov_b32 v17, v16
 v_mov_b32 v19, v18
 v_pk_add_f32 v[68:69], v[68:69], v[16:17]
 s_waitcnt vmcnt(2)
 v_pk_mul_f32 v[60:61], v[60:61], v[18:19]
 v_pk_add_f32 v[70:71], v[70:71], v[16:17]
 v_pk_mul_f32 v[62:63], v[62:63], v[18:19]
 v_pk_add_f32 v[72:73], v[72:73], v[16:17]
 s_waitcnt vmcnt(1)
 v_pk_mul_f32 v[64:65], v[64:65], v[18:19]
 v_pk_add_f32 v[74:75], v[74:75], v[16:17]
 v_pk_mul_f32 v[66:67], v[66:67], v[18:19]
 v_pk_fma_f32 v[68:69], v[68:69], v[60:61], v[52:53]
 v_pk_fma_f32 v[70:71], v[70:71], v[62:63], v[54:55]
 v_pk_fma_f32 v[72:73], v[72:73], v[64:65], v[56:57]
 v_pk_fma_f32 v[74:75], v[74:75], v[66:67], v[58:59]
 v_cvt_pk_bf16_f32 v20, v68, v69
 v_cvt_pk_bf16_f32 v21, v70, v71
 v_cvt_pk_bf16_f32 v22, v72, v73
 v_cvt_pk_bf16_f32 v23, v74, v75
 buffer_store_dwordx4 v[20:23], v3, s[12:15], s22 offen sc1
K2A_END:
 s_endpgm
.globl k2b_kernel
.p2align 8
.type k2b_kernel,@function
k2b_kernel:
 s_cmp_ge_u32 s2, 256
 s_cbranch_scc1 K2B_END
 s_load_dwordx2 s[40:41], s[0:1], 112
 s_load_dwordx2 s[42:43], s[0:1], 56
 v_lshrrev_b32 v96, 6, v0
 v_and_b32 v0, 63, v0
 v_readfirstlane_b32 s3, v96
 s_bfe_u32 s30, s2, 0x20001
 s_lshl_b32 s30, s30, 3
 s_bfe_u32 s31, s2, 0x30003
 s_add_u32 s5, s30, s31
 s_and_b32 s30, s2, 1
 s_lshl_b32 s30, s30, 2
 s_lshr_b32 s31, s2, 6
 s_add_u32 s4, s30, s31
 v_lshlrev_b32 v1, 4, v0
 s_and_b32 s6, s3, 1
 s_lshr_b32 s7, s3, 1
 s_waitcnt lgkmcnt(0)
 s_mov_b32 s8, s40
 s_mov_b32 s9, s41
 s_mov_b32 s10, 0x2300000
 s_mov_b32 s11, 0x00020000
 s_mul_i32 s30, s3, 14336
 s_mul_i32 s31, s5, 57344
 s_add_u32 s31, s31, s30
 s_add_u32 s31, s31, 4194304
 s_add_u32 m0, s30, 106496
 s_nop 0
 buffer_load_dwordx4 v1, s[8:11], s31 offen offset:0 lds
 buffer_load_dwordx4 v1, s[8:11], s31 offen offset:1024 lds
 buffer_load_dwordx4 v1, s[8:11], s31 offen offset:2048 lds
 buffer_load_dwordx4 v1, s[8:11], s31 offen offset:3072 lds
 s_add_u32 s31, s31, 4096
 s_add_u32 m0, s30, 110592
 s_nop 0
 buffer_load_dwordx4 v1, s[8:11], s31 offen offset:0 lds
 buffer_load_dwordx4 v1, s[8:11], s31 offen offset:1024 lds
 buffer_load_dwordx4 v1, s[8:11], s31 offen offset:2048 lds
 buffer_load_dwordx4 v1, s[8:11], s31 offen offset:3072 lds
 s_add_u32 s31, s31, 4096
 s_add_u32 m0, s30, 114688
 s_nop 0
 buffer_load_dwordx4 v1, s[8:11], s31 offen offset:0 lds
 buffer_load_dwordx4 v1, s[8:11], s31 offen offset:1024 lds
 buffer_load_dwordx4 v1, s[8:11], s31 offen offset:2048 lds
 buffer_load_dwordx4 v1, s[8:11], s31 offen offset:3072 lds
 s_add_u32 s31, s31, 4096
 s_add_u32 m0, s30, 118784
 s_nop 0
 buffer_load_dwordx4 v1, s[8:11], s31 offen offset:0 lds
 buffer_load_dwordx4 v1, s[8:11], s31 offen offset:1024 lds
 v_add_u32 v2, 0, v1
 v_add_u32 v3, 1024, v1
 v_add_u32 v4, 2048, v1
 v_add_u32 v5, 3072, v1
 s_mul_i32 s30, s4, 28
 s_add_u32 s30, s30, s3
 s_lshl_b32 s16, s30, 12
 s_add_u32 s16, s16, 34603008
 s_mul_i32 s17, s30, 3072
 s_add_u32 s17, s17, 35520512
 s_mul_i32 s18, s3, 4352
 s_mul_i32 s19, s3, 3072
 s_add_u32 m0, s18, 0
 s_nop 0
 buffer_load_dwordx4 v2, s[8:11], s16 offen lds
 s_add_u32 m0, s18, 1088
 s_nop 0
 buffer_load_dwordx4 v3, s[8:11], s16 offen lds
 s_add_u32 m0, s18, 2176
 s_nop 0
 buffer_load_dwordx4 v4, s[8:11], s16 offen lds
 s_add_u32 m0, s18, 3264
 s_nop 0
 buffer_load_dwordx4 v5, s[8:11], s16 offen lds
 s_add_u32 s16, s16, 16384
 s_add_u32 m0, s18, 17408
 s_nop 0
 buffer_load_dwordx4 v2, s[8:11], s16 offen lds
 s_add_u32 m0, s18, 18496
 s_nop 0
 buffer_load_dwordx4 v3, s[8:11], s16 offen lds
 s_add_u32 m0, s18, 19584
 s_nop 0
 buffer_load_dwordx4 v4, s[8:11], s16 offen lds
 s_add_u32 m0, s18, 20672
 s_nop 0
 buffer_load_dwordx4 v5, s[8:11], s16 offen lds
 s_add_u32 s16, s16, 16384
 s_add_u32 m0, s18, 34816
 s_nop 0
 buffer_load_dwordx4 v2, s[8:11], s16 offen lds
 s_add_u32 m0, s18, 35904
 s_nop 0
 buffer_load_dwordx4 v3, s[8:11], s16 offen lds
 s_add_u32 m0, s18, 36992
 s_nop 0
 buffer_load_dwordx4 v4, s[8:11], s16 offen lds
 s_add_u32 m0, s18, 38080
 s_nop 0
 buffer_load_dwordx4 v5, s[8:11], s16 offen lds
 s_add_u32 s16, s16, 16384
 s_add_u32 m0, s18, 52224
 s_nop 0
 buffer_load_dwordx4 v2, s[8:11], s16 offen lds
 s_add_u32 m0, s18, 53312
 s_nop 0
 buffer_load_dwordx4 v3, s[8:11], s16 offen lds
 s_add_u32 m0, s18, 54400
 s_nop 0
 buffer_load_dwordx4 v4, s[8:11], s16 offen lds
 s_add_u32 m0, s18, 55488
 s_nop 0
 buffer_load_dwordx4 v5, s[8:11], s16 offen lds
 v_bfe_u32 v96, v0, 2, 2
 v_lshrrev_b32 v97, 5, v0
 v_and_b32 v98, 1, v0
 v_bfe_u32 v99, v0, 1, 1
 v_bfe_u32 v100, v0, 4, 1
 v_mul_u32_u24 v101, 1088, v96
 v_lshl_add_u32 v101, v97, 8, v101
 v_lshl_add_u32 v101, v100, 5, v101
 v_lshl_add_u32 v101, v98, 4, v101
 v_lshl_add_u32 v101, v99, 3, v101
 s_mul_i32 s30, s6, 640
 v_add_u32 v9, s30, v101
 s_mul_i32 s30, s6, -384
 s_add_u32 s30, s30, 512
 v_add_u32 v12, s30, v101
 v_lshl_add_u32 v101, v97, 3, v96
 v_mul_u32_u24 v101, 192, v101
 v_lshl_add_u32 v101, v99, 5, v101
 v_lshl_add_u32 v101, v98, 3, v101
 v_lshl_add_u32 v102, v100, 4, v101
 s_mul_i32 s30, s6, 3200
 v_add_u32 v15, s30, v102
 s_mul_i32 s30, s6, -2944
 s_add_u32 s30, s30, 3072
 v_add_u32 v18, s30, v102
 v_xor_b32 v100, s6, v100
 v_lshl_add_u32 v102, v100, 4, v101
 s_mul_i32 s30, s6, 3072
 s_add_u32 s30, s30, 64
 v_add_u32 v21, s30, v102
 v_add_u32 v10, 52224, v9
 v_add_u32 v11, 104448, v9
 v_add_u32 v13, 52224, v12
 v_add_u32 v14, 104448, v12
 v_add_u32 v16, 52224, v15
 v_add_u32 v17, 104448, v15
 v_add_u32 v19, 52224, v18
 v_add_u32 v20, 104448, v18
 v_add_u32 v22, 52224, v21
 v_add_u32 v23, 104448, v21
 s_mul_i32 s30, s7, 28672
 s_add_u32 s30, s30, 106496
 s_lshl_b32 s31, s6, 10
 s_add_u32 s32, s30, s31
 v_add_u32 v24, s32, v1
 s_sub_u32 s32, s30, s31
 v_add_u32 v25, s32, v1
 s_lshl_b32 s30, s3, 11
 s_add_u32 s30, s30, 139264
 v_add_u32 v26, s30, v1
 v_xor_b32 v27, 2048, v26
 s_mov_b32 s20, 0xbdd2d3e8
 s_mov_b32 s21, 0xbdd2d3e8
 v_mov_b32 v112, 0xc0135761
 v_mov_b32 v113, 0xc0135761
 s_cmp_eq_u32 s6, 0
 s_cselect_b32 s22, 1.0, 0
 s_cselect_b64 s[26:27], 0, -1
 s_lshl_b32 s33, s5, 1
 s_add_u32 s33, s33, s7
 s_mul_i32 s30, s33, 57344
 s_mul_i32 s31, s4, 7168
 s_add_u32 s30, s30, s31
 s_add_u32 s30, s30, 6291456
 s_lshl_b32 s31, s6, 12
 s_add_u32 s23, s30, s31
 s_lshl_b32 s31, s6, 10
 s_add_u32 s34, s30, s31
 v_and_b32 v96, 19, v0
 v_and_b32 v97, 4, v0
 v_lshl_add_u32 v96, v97, 1, v96
 v_and_b32 v97, 8, v0
 v_lshrrev_b32 v97, 1, v97
 v_add_u32 v96, v96, v97
 v_mul_u32_u24 v96, 224, v96
 v_lshrrev_b32 v97, 5, v0
 v_lshl_add_u32 v28, v97, 4, v96
 s_mul_i32 s31, s4, 458752
 s_mul_i32 s32, s33, 7168
 s_add_u32 s31, s31, s32
 s_lshl_b32 s32, s6, 7
 s_add_u32 s31, s31, s32
 s_add_u32 s24, s31, 10485760
 s_add_u32 s30, s30, 6144
 v_add_u32 v96, s30, v1
 s_add_u32 s31, s24, 96
 v_add_u32 v97, s31, v28
 v_cndmask_b32 v29, v97, v96, s[26:27]
 s_lshl_b32 s31, s33, 12
 s_add_u32 s35, s31, 33554432
 s_lshl_b32 s31, s4, 1
 s_add_u32 s31, s31, s6
 s_lshl_b32 s31, s31, 8
 s_add_u32 s25, s35, s31
 v_and_b32 v96, 31, v0
 v_lshlrev_b32 v96, 3, v96
 v_lshrrev_b32 v97, 5, v0
 v_lshl_add_u32 v31, v97, 11, v96
 v_lshl_add_u32 v30, v97, 31, v96
 s_waitcnt vmcnt(12)
 s_barrier
 ds_read_b128 a[0:3], v24 offset:0
 ds_read_b128 a[4:7], v25 offset:1024
 ds_read_b128 a[8:11], v24 offset:2048
 ds_read_b128 a[12:15], v25 offset:3072
 ds_read_b64_tr_b16 a[112:113], v9 offset:0
 ds_read_b64_tr_b16 a[114:115], v9 offset:4352
 ds_read_b64_tr_b16 a[116:117], v9 offset:64
 ds_read_b64_tr_b16 a[118:119], v9 offset:4416
 ds_read_b64_tr_b16 a[120:121], v12 offset:0
 ds_read_b64_tr_b16 a[122:123], v12 offset:4352
 ds_read_b64_tr_b16 a[124:125], v12 offset:64
 ds_read_b64_tr_b16 a[126:127], v12 offset:4416
 ds_read_b128 a[16:19], v24 offset:4096
 ds_read_b128 a[20:23], v25 offset:5120
 ds_read_b128 a[24:27], v24 offset:6144
 ds_read_b128 a[28:31], v25 offset:7168
 ds_read_b128 a[32:35], v24 offset:8192
 ds_read_b128 a[36:39], v25 offset:9216
 ds_read_b128 a[40:43], v24 offset:10240
 ds_read_b128 a[44:47], v25 offset:11264
 ds_read_b128 a[48:51], v24 offset:12288
 ds_read_b128 a[52:55], v25 offset:13312
 ds_read_b128 a[56:59], v24 offset:14336
 ds_read_b128 a[60:63], v25 offset:15360
 ds_read_b128 a[64:67], v24 offset:16384
 ds_read_b128 a[68:71], v25 offset:17408
 ds_read_b128 a[72:75], v24 offset:18432
 ds_read_b128 a[76:79], v25 offset:19456
 ds_read_b128 a[80:83], v24 offset:20480
 ds_read_b128 a[84:87], v25 offset:21504
 ds_read_b128 a[88:91], v24 offset:22528
 ds_read_b128 a[92:95], v25 offset:23552
 ds_read_b128 a[96:99], v24 offset:24576
 ds_read_b128 a[100:103], v25 offset:25600
 ds_read_b128 a[104:107], v24 offset:26624
 ds_read_b128 a[108:111], v25 offset:27648
 s_waitcnt lgkmcnt(15)
 v_mfma_f32_32x32x16_bf16 v[32:47], a[112:115], a[0:3], 0
 ds_read_b64_tr_b16 a[128:129], v9 offset:8704
 ds_read_b64_tr_b16 a[130:131], v9 offset:13056
 v_mfma_f32_32x32x16_bf16 v[48:63], a[116:119], a[0:3], 0
 ds_read_b64_tr_b16 a[132:133], v9 offset:8768
 ds_read_b64_tr_b16 a[134:135], v9 offset:13120
 v_mfma_f32_32x32x16_bf16 v[32:47], a[120:123], a[4:7], v[32:47]
 ds_read_b64_tr_b16 a[136:137], v12 offset:8704
 ds_read_b64_tr_b16 a[138:139], v12 offset:13056
 v_mfma_f32_32x32x16_bf16 v[48:63], a[124:127], a[4:7], v[48:63]
 ds_read_b64_tr_b16 a[140:141], v12 offset:8768
 ds_read_b64_tr_b16 a[142:143], v12 offset:13120
 s_waitcnt lgkmcnt(4)
 v_mfma_f32_32x32x16_bf16 v[32:47], a[128:131], a[8:11], v[32:47]
 s_waitcnt vmcnt(8)
 s_barrier
 s_add_u32 s16, s16, 16384
 s_add_u32 m0, s18, 69632
 ds_read_b64_tr_b16 a[112:113], v9 offset:17408
 buffer_load_dwordx4 v2, s[8:11], s16 offen lds
 s_add_u32 m0, s18, 70720
 ds_read_b64_tr_b16 a[114:115], v9 offset:21760
 buffer_load_dwordx4 v3, s[8:11], s16 offen lds
 v_mfma_f32_32x32x16_bf16 v[48:63], a[132:135], a[8:11], v[48:63]
 s_add_u32 m0, s18, 71808
 ds_read_b64_tr_b16 a[116:117], v9 offset:17472
 buffer_load_dwordx4 v4, s[8:11], s16 offen lds
 s_add_u32 m0, s18, 72896
 ds_read_b64_tr_b16 a[118:119], v9 offset:21824
 buffer_load_dwordx4 v5, s[8:11], s16 offen lds
 s_waitcnt lgkmcnt(4)
 v_mfma_f32_32x32x16_bf16 v[32:47], a[136:139], a[12:15], v[32:47]
 s_add_u32 s16, s16, 16384
 s_add_u32 m0, s18, 87040
 ds_read_b64_tr_b16 a[120:121], v12 offset:17408
 buffer_load_dwordx4 v2, s[8:11], s16 offen lds
 s_add_u32 m0, s18, 88128
 ds_read_b64_tr_b16 a[122:123], v12 offset:21760
 buffer_load_dwordx4 v3, s[8:11], s16 offen lds
 v_mfma_f32_32x32x16_bf16 v[48:63], a[140:143], a[12:15], v[48:63]
 s_add_u32 m0, s18, 89216
 ds_read_b64_tr_b16 a[124:125], v12 offset:17472
 buffer_load_dwordx4 v4, s[8:11], s16 offen lds
 s_add_u32 m0, s18, 90304
 ds_read_b64_tr_b16 a[126:127], v12 offset:21824
 buffer_load_dwordx4 v5, s[8:11], s16 offen lds
 s_waitcnt lgkmcnt(4)
 v_mfma_f32_32x32x16_bf16 v[32:47], a[112:115], a[16:19], v[32:47]
 s_add_u32 s16, s16, 16384
 s_add_u32 m0, s18, 104448
 ds_read_b64_tr_b16 a[128:129], v9 offset:26112
 buffer_load_dwordx4 v2, s[8:11], s16 offen lds
 s_add_u32 m0, s18, 105536
 ds_read_b64_tr_b16 a[130:131], v9 offset:30464
 buffer_load_dwordx4 v3, s[8:11], s16 offen lds
 v_mfma_f32_32x32x16_bf16 v[48:63], a[116:119], a[16:19], v[48:63]
 s_add_u32 m0, s18, 106624
 ds_read_b64_tr_b16 a[132:133], v9 offset:26176
 buffer_load_dwordx4 v4, s[8:11], s16 offen lds
 s_add_u32 m0, s18, 107712
 ds_read_b64_tr_b16 a[134:135], v9 offset:30528
 buffer_load_dwordx4 v5, s[8:11], s16 offen lds
 s_waitcnt lgkmcnt(4)
 v_mfma_f32_32x32x16_bf16 v[32:47], a[120:123], a[20:23], v[32:47]
 s_add_u32 m0, s19, 121856
 ds_read_b64_tr_b16 a[136:137], v12 offset:26112
 buffer_load_dwordx4 v2, s[8:11], s17 offen lds
 ds_read_b64_tr_b16 a[138:139], v12 offset:30464
 v_mfma_f32_32x32x16_bf16 v[48:63], a[124:127], a[20:23], v[48:63]
 s_add_u32 m0, s19, 122880
 ds_read_b64_tr_b16 a[140:141], v12 offset:26176
 buffer_load_dwordx4 v3, s[8:11], s17 offen lds
 ds_read_b64_tr_b16 a[142:143], v12 offset:30528
 s_waitcnt lgkmcnt(4)
 v_mfma_f32_32x32x16_bf16 v[32:47], a[128:131], a[24:27], v[32:47]
 s_waitcnt vmcnt(18)
 s_barrier
 s_add_u32 m0, s19, 123904
 ds_read_b64_tr_b16 a[112:113], v9 offset:34816
 buffer_load_dwordx4 v4, s[8:11], s17 offen lds
 ds_read_b64_tr_b16 a[114:115], v9 offset:39168
 v_mfma_f32_32x32x16_bf16 v[48:63], a[132:135], a[24:27], v[48:63]
 s_add_u32 s17, s17, 12288
 s_add_u32 m0, s19, 0
 ds_read_b64_tr_b16 a[116:117], v9 offset:34880
 buffer_load_dwordx4 v2, s[8:11], s17 offen lds
 ds_read_b64_tr_b16 a[118:119], v9 offset:39232
 s_waitcnt lgkmcnt(4)
 v_mfma_f32_32x32x16_bf16 v[32:47], a[136:139], a[28:31], v[32:47]
 s_add_u32 m0, s19, 1024
 ds_read_b64_tr_b16 a[120:121], v12 offset:34816
 buffer_load_dwordx4 v3, s[8:11], s17 offen lds
 ds_read_b64_tr_b16 a[122:123], v12 offset:39168
 v_mfma_f32_32x32x16_bf16 v[48:63], a[140:143], a[28:31], v[48:63]
 s_add_u32 m0, s19, 2048
 ds_read_b64_tr_b16 a[124:125], v12 offset:34880
 buffer_load_dwordx4 v4, s[8:11], s17 offen lds
 ds_read_b64_tr_b16 a[126:127], v12 offset:39232
 s_waitcnt lgkmcnt(4)
 v_mfma_f32_32x32x16_bf16 v[32:47], a[112:115], a[32:35], v[32:47]
 ds_read_b64_tr_b16 a[128:129], v9 offset:43520
 ds_read_b64_tr_b16 a[130:131], v9 offset:47872
 v_mfma_f32_32x32x16_bf16 v[48:63], a[116:119], a[32:35], v[48:63]
 ds_read_b64_tr_b16 a[132:133], v9 offset:43584
 ds_read_b64_tr_b16 a[134:135], v9 offset:47936
 s_waitcnt lgkmcnt(4)
 v_mfma_f32_32x32x16_bf16 v[32:47], a[120:123], a[36:39], v[32:47]
 ds_read_b64_tr_b16 a[136:137], v12 offset:43520
 ds_read_b64_tr_b16 a[138:139], v12 offset:47872
 v_mfma_f32_32x32x16_bf16 v[48:63], a[124:127], a[36:39], v[48:63]
 ds_read_b64_tr_b16 a[140:141], v12 offset:43584
 ds_read_b64_tr_b16 a[142:143], v12 offset:47936
 s_waitcnt lgkmcnt(4)
 v_mfma_f32_32x32x16_bf16 v[32:47], a[128:131], a[40:43], v[32:47]
 s_waitcnt vmcnt(18)
 s_barrier
 s_add_u32 s17, s17, 12288
 s_add_u32 m0, s19, 17408
 ds_read_b64_tr_b16 a[112:113], v10 offset:0
 buffer_load_dwordx4 v2, s[8:11], s17 offen lds
 ds_read_b64_tr_b16 a[114:115], v10 offset:4352
 v_mfma_f32_32x32x16_bf16 v[48:63], a[132:135], a[40:43], v[48:63]
 s_add_u32 m0, s19, 18432
 ds_read_b64_tr_b16 a[116:117], v10 offset:64
 buffer_load_dwordx4 v3, s[8:11], s17 offen lds
 ds_read_b64_tr_b16 a[118:119], v10 offset:4416
 s_waitcnt lgkmcnt(4)
 v_mfma_f32_32x32x16_bf16 v[32:47], a[136:139], a[44:47], v[32:47]
 s_add_u32 m0, s19, 19456
 ds_read_b64_tr_b16 a[120:121], v13 offset:0
 buffer_load_dwordx4 v4, s[8:11], s17 offen lds
 ds_read_b64_tr_b16 a[122:123], v13 offset:4352
 v_mfma_f32_32x32x16_bf16 v[48:63], a[140:143], a[44:47], v[48:63]
 ds_read_b64_tr_b16 a[124:125], v13 offset:64
 ds_read_b64_tr_b16 a[126:127], v13 offset:4416
 s_waitcnt lgkmcnt(4)
 v_mfma_f32_32x32x16_bf16 v[32:47], a[112:115], a[48:51], v[32:47]
 ds_read_b64_tr_b16 a[128:129], v10 offset:8704
 ds_read_b64_tr_b16 a[130:131], v10 offset:13056
 v_mfma_f32_32x32x16_bf16 v[48:63], a[116:119], a[48:51], v[48:63]
 ds_read_b64_tr_b16 a[132:133], v10 offset:8768
 ds_read_b64_tr_b16 a[134:135], v10 offset:13120
 s_waitcnt lgkmcnt(4)
 v_mfma_f32_32x32x16_bf16 v[32:47], a[120:123], a[52:55], v[32:47]
 ds_read_b64_tr_b16 a[136:137], v13 offset:8704
 ds_read_b64_tr_b16 a[138:139], v13 offset:13056
 v_mfma_f32_32x32x16_bf16 v[48:63], a[124:127], a[52:55], v[48:63]
 ds_read_b64_tr_b16 a[140:141], v13 offset:8768
 ds_read_b64_tr_b16 a[142:143], v13 offset:13120
 s_waitcnt lgkmcnt(4)
 v_mfma_f32_32x32x16_bf16 v[32:47], a[128:131], a[56:59], v[32:47]
 s_waitcnt vmcnt(17)
 s_barrier
 s_add_u32 s17, s17, 12288
 s_add_u32 m0, s19, 34816
 ds_read_b64_tr_b16 a[112:113], v10 offset:17408
 buffer_load_dwordx4 v2, s[8:11], s17 offen lds
 ds_read_b64_tr_b16 a[114:115], v10 offset:21760
 v_mfma_f32_32x32x16_bf16 v[48:63], a[132:135], a[56:59], v[48:63]
 s_add_u32 m0, s19, 35840
 ds_read_b64_tr_b16 a[116:117], v10 offset:17472
 buffer_load_dwordx4 v3, s[8:11], s17 offen lds
 ds_read_b64_tr_b16 a[118:119], v10 offset:21824
 s_waitcnt lgkmcnt(4)
 v_mfma_f32_32x32x16_bf16 v[32:47], a[136:139], a[60:63], v[32:47]
 s_add_u32 m0, s19, 36864
 ds_read_b64_tr_b16 a[120:121], v13 offset:17408
 buffer_load_dwordx4 v4, s[8:11], s17 offen lds
 ds_read_b64_tr_b16 a[122:123], v13 offset:21760
 v_mfma_f32_32x32x16_bf16 v[48:63], a[140:143], a[60:63], v[48:63]
 ds_read_b64_tr_b16 a[124:125], v13 offset:17472
 ds_read_b64_tr_b16 a[126:127], v13 offset:21824
 s_waitcnt lgkmcnt(4)
 v_mfma_f32_32x32x16_bf16 v[32:47], a[112:115], a[64:67], v[32:47]
 ds_read_b64_tr_b16 a[128:129], v10 offset:26112
 ds_read_b64_tr_b16 a[130:131], v10 offset:30464
 v_mfma_f32_32x32x16_bf16 v[48:63], a[116:119], a[64:67], v[48:63]
 ds_read_b64_tr_b16 a[132:133], v10 offset:26176
 ds_read_b64_tr_b16 a[134:135], v10 offset:30528
 s_waitcnt lgkmcnt(4)
 v_mfma_f32_32x32x16_bf16 v[32:47], a[120:123], a[68:71], v[32:47]
 ds_read_b64_tr_b16 a[136:137], v13 offset:26112
 ds_read_b64_tr_b16 a[138:139], v13 offset:30464
 v_mfma_f32_32x32x16_bf16 v[48:63], a[124:127], a[68:71], v[48:63]
 ds_read_b64_tr_b16 a[140:141], v13 offset:26176
 ds_read_b64_tr_b16 a[142:143], v13 offset:30528
 s_waitcnt lgkmcnt(4)
 v_mfma_f32_32x32x16_bf16 v[32:47], a[128:131], a[72:75], v[32:47]
 s_waitcnt vmcnt(16)
 s_barrier
 s_add_u32 s17, s17, 12288
 s_add_u32 m0, s19, 52224
 ds_read_b64_tr_b16 a[112:113], v10 offset:34816
 buffer_load_dwordx4 v2, s[8:11], s17 offen lds
 ds_read_b64_tr_b16 a[114:115], v10 offset:39168
 v_mfma_f32_32x32x16_bf16 v[48:63], a[132:135], a[72:75], v[48:63]
 s_add_u32 m0, s19, 53248
 ds_read_b64_tr_b16 a[116:117], v10 offset:34880
 buffer_load_dwordx4 v3, s[8:11], s17 offen lds
 ds_read_b64_tr_b16 a[118:119], v10 offset:39232
 s_waitcnt lgkmcnt(4)
 v_mfma_f32_32x32x16_bf16 v[32:47], a[136:139], a[76:79], v[32:47]
 s_add_u32 m0, s19, 54272
 ds_read_b64_tr_b16 a[120:121], v13 offset:34816
 buffer_load_dwordx4 v4, s[8:11], s17 offen lds
 ds_read_b64_tr_b16 a[122:123], v13 offset:39168
 v_mfma_f32_32x32x16_bf16 v[48:63], a[140:143], a[76:79], v[48:63]
 ds_read_b64_tr_b16 a[124:125], v13 offset:34880
 ds_read_b64_tr_b16 a[126:127], v13 offset:39232
 s_waitcnt lgkmcnt(4)
 v_mfma_f32_32x32x16_bf16 v[32:47], a[112:115], a[80:83], v[32:47]
 ds_read_b64_tr_b16 a[128:129], v10 offset:43520
 ds_read_b64_tr_b16 a[130:131], v10 offset:47872
 v_mfma_f32_32x32x16_bf16 v[48:63], a[116:119], a[80:83], v[48:63]
 ds_read_b64_tr_b16 a[132:133], v10 offset:43584
 ds_read_b64_tr_b16 a[134:135], v10 offset:47936
 s_waitcnt lgkmcnt(4)
 v_mfma_f32_32x32x16_bf16 v[32:47], a[120:123], a[84:87], v[32:47]
 ds_read_b64_tr_b16 a[136:137], v13 offset:43520
 ds_read_b64_tr_b16 a[138:139], v13 offset:47872
 v_mfma_f32_32x32x16_bf16 v[48:63], a[124:127], a[84:87], v[48:63]
 ds_read_b64_tr_b16 a[140:141], v13 offset:43584
 ds_read_b64_tr_b16 a[142:143], v13 offset:47936
 s_waitcnt lgkmcnt(4)
 v_mfma_f32_32x32x16_bf16 v[32:47], a[128:131], a[88:91], v[32:47]
 s_waitcnt vmcnt(15)
 s_barrier
 s_add_u32 s17, s17, 12288
 s_add_u32 m0, s19, 69632
 ds_read_b64_tr_b16 a[112:113], v11 offset:0
 buffer_load_dwordx4 v2, s[8:11], s17 offen lds
 ds_read_b64_tr_b16 a[114:115], v11 offset:4352
 v_mfma_f32_32x32x16_bf16 v[48:63], a[132:135], a[88:91], v[48:63]
 s_add_u32 m0, s19, 70656
 ds_read_b64_tr_b16 a[116:117], v11 offset:64
 buffer_load_dwordx4 v3, s[8:11], s17 offen lds
 ds_read_b64_tr_b16 a[118:119], v11 offset:4416
 s_waitcnt lgkmcnt(4)
 v_mfma_f32_32x32x16_bf16 v[32:47], a[136:139], a[92:95], v[32:47]
 s_add_u32 m0, s19, 71680
 ds_read_b64_tr_b16 a[120:121], v14 offset:0
 buffer_load_dwordx4 v4, s[8:11], s17 offen lds
 ds_read_b64_tr_b16 a[122:123], v14 offset:4352
 v_mfma_f32_32x32x16_bf16 v[48:63], a[140:143], a[92:95], v[48:63]
 ds_read_b64_tr_b16 a[124:125], v14 offset:64
 ds_read_b64_tr_b16 a[126:127], v14 offset:4416
 s_waitcnt lgkmcnt(4)
 v_mfma_f32_32x32x16_bf16 v[32:47], a[112:115], a[96:99], v[32:47]
 ds_read_b64_tr_b16 a[128:129], v11 offset:8704
 ds_read_b64_tr_b16 a[130:131], v11 offset:13056
 v_mfma_f32_32x32x16_bf16 v[48:63], a[116:119], a[96:99], v[48:63]
 ds_read_b64_tr_b16 a[132:133], v11 offset:8768
 ds_read_b64_tr_b16 a[134:135], v11 offset:13120
 s_waitcnt lgkmcnt(4)
 v_mfma_f32_32x32x16_bf16 v[32:47], a[120:123], a[100:103], v[32:47]
 ds_read_b64_tr_b16 a[136:137], v14 offset:8704
 ds_read_b64_tr_b16 a[138:139], v14 offset:13056
 v_mfma_f32_32x32x16_bf16 v[48:63], a[124:127], a[100:103], v[48:63]
 ds_read_b64_tr_b16 a[140:141], v14 offset:8768
 ds_read_b64_tr_b16 a[142:143], v14 offset:13120
 s_waitcnt lgkmcnt(4)
 v_mfma_f32_32x32x16_bf16 v[32:47], a[128:131], a[104:107], v[32:47]
 s_waitcnt vmcnt(15)
 s_barrier
 s_add_u32 s17, s17, 12288
 s_add_u32 m0, s19, 87040
 ds_read_b64_tr_b16 a[112:113], v23 offset:17408
 buffer_load_dwordx4 v2, s[8:11], s17 offen lds
 ds_read_b64_tr_b16 a[114:115], v23 offset:18176
 v_mfma_f32_32x32x16_bf16 v[48:63], a[132:135], a[104:107], v[48:63]
 s_add_u32 m0, s19, 88064
 ds_read_b64_tr_b16 a[116:117], v17 offset:17408
 buffer_load_dwordx4 v3, s[8:11], s17 offen lds
 ds_read_b64_tr_b16 a[118:119], v17 offset:18176
 s_waitcnt lgkmcnt(4)
 v_mfma_f32_32x32x16_bf16 v[32:47], a[136:139], a[108:111], v[32:47]
 s_add_u32 m0, s19, 89088
 ds_read_b64_tr_b16 a[120:121], v20 offset:17408
 buffer_load_dwordx4 v4, s[8:11], s17 offen lds
 ds_read_b64_tr_b16 a[122:123], v20 offset:18176
 v_mfma_f32_32x32x16_bf16 v[48:63], a[140:143], a[108:111], v[48:63]
 ds_read_b64_tr_b16 a[124:125], v23 offset:23552
 ds_read_b64_tr_b16 a[126:127], v23 offset:24320
 s_waitcnt lgkmcnt(4)
 v_mfma_f32_32x32x16_bf16 v[80:95], a[112:115], a[0:3], 0
 ds_read_b64_tr_b16 a[128:129], v17 offset:23552
 ds_read_b64_tr_b16 a[130:131], v17 offset:24320
 v_mfma_f32_32x32x16_bf16 v[64:79], a[116:119], a[0:3], 0
 ds_read_b64_tr_b16 a[132:133], v20 offset:23552
 ds_read_b64_tr_b16 a[134:135], v20 offset:24320
 s_waitcnt lgkmcnt(4)
 v_mfma_f32_32x32x16_bf16 v[64:79], a[120:123], a[4:7], v[64:79]
 s_waitcnt vmcnt(15)
 s_barrier
 ds_read_b64_tr_b16 a[136:137], v21 offset:0
 ds_read_b64_tr_b16 a[138:139], v21 offset:768
 v_pk_mul_f32 v[96:97], v[32:33], v[32:33]
 v_pk_mul_f32 v[98:99], v[34:35], v[34:35]
 v_pk_mul_f32 v[100:101], v[36:37], v[36:37]
 v_pk_mul_f32 v[102:103], v[38:39], v[38:39]
 v_pk_fma_f32 v[96:97], v[96:97], s[20:21], v[112:113]
 v_pk_fma_f32 v[98:99], v[98:99], s[20:21], v[112:113]
 v_pk_fma_f32 v[100:101], v[100:101], s[20:21], v[112:113]
 v_pk_fma_f32 v[102:103], v[102:103], s[20:21], v[112:113]
 v_pk_mul_f32 v[96:97], v[96:97], v[32:33]
 v_pk_mul_f32 v[98:99], v[98:99], v[34:35]
 v_mfma_f32_32x32x16_bf16 v[80:95], a[124:127], a[8:11], v[80:95]
 ds_read_b64_tr_b16 a[140:141], v15 offset:0
 ds_read_b64_tr_b16 a[142:143], v15 offset:768
 v_pk_mul_f32 v[100:101], v[100:101], v[36:37]
 v_pk_mul_f32 v[102:103], v[102:103], v[38:39]
 v_exp_f32 v96, v96
 v_exp_f32 v98, v98
 v_exp_f32 v100, v100
 v_exp_f32 v102, v102
 v_exp_f32 v97, v97
 s_waitcnt lgkmcnt(4)
 v_mfma_f32_32x32x16_bf16 v[64:79], a[128:131], a[8:11], v[64:79]
 ds_read_b64_tr_b16 a[112:113], v18 offset:0
 ds_read_b64_tr_b16 a[114:115], v18 offset:768
 v_exp_f32 v99, v99
 v_exp_f32 v101, v101
 v_exp_f32 v103, v103
 v_pk_add_f32 v[96:97], v[96:97], 1.0 op_sel_hi:[1,0]
 v_pk_add_f32 v[98:99], v[98:99], 1.0 op_sel_hi:[1,0]
 v_pk_add_f32 v[100:101], v[100:101], 1.0 op_sel_hi:[1,0]
 v_pk_add_f32 v[102:103], v[102:103], 1.0 op_sel_hi:[1,0]
 v_rcp_f32 v96, v96
 v_mfma_f32_32x32x16_bf16 v[64:79], a[132:135], a[12:15], v[64:79]
 ds_read_b64_tr_b16 a[116:117], v21 offset:6144
 ds_read_b64_tr_b16 a[118:119], v21 offset:6912
 v_rcp_f32 v98, v98
 v_rcp_f32 v100, v100
 v_rcp_f32 v102, v102
 v_rcp_f32 v97, v97
 v_rcp_f32 v99, v99
 v_rcp_f32 v101, v101
 s_waitcnt lgkmcnt(4)
 v_mfma_f32_32x32x16_bf16 v[80:95], a[136:139], a[16:19], v[80:95]
 ds_read_b64_tr_b16 a[120:121], v15 offset:6144
 ds_read_b64_tr_b16 a[122:123], v15 offset:6912
 v_rcp_f32 v103, v103
 v_pk_mul_f32 v[32:33], v[32:33], v[96:97]
 v_pk_mul_f32 v[34:35], v[34:35], v[98:99]
 v_pk_mul_f32 v[36:37], v[36:37], v[100:101]
 v_pk_mul_f32 v[38:39], v[38:39], v[102:103]
 v_pk_mul_f32 v[116:117], v[32:33], v[32:33]
 v_pk_add_f32 v[114:115], v[32:33], v[34:35]
 v_pk_fma_f32 v[116:117], v[34:35], v[34:35], v[116:117]
 v_pk_add_f32 v[114:115], v[114:115], v[36:37]
 v_pk_fma_f32 v[116:117], v[36:37], v[36:37], v[116:117]
 v_pk_add_f32 v[114:115], v[114:115], v[38:39]
 v_mfma_f32_32x32x16_bf16 v[64:79], a[140:143], a[16:19], v[64:79]
 ds_read_b64_tr_b16 a[124:125], v18 offset:6144
 ds_read_b64_tr_b16 a[126:127], v18 offset:6912
 v_pk_fma_f32 v[116:117], v[38:39], v[38:39], v[116:117]
 v_pk_mul_f32 v[96:97], v[40:41], v[40:41]
 v_pk_mul_f32 v[98:99], v[42:43], v[42:43]
 v_pk_mul_f32 v[100:101], v[44:45], v[44:45]
 v_pk_mul_f32 v[102:103], v[46:47], v[46:47]
 v_pk_fma_f32 v[96:97], v[96:97], s[20:21], v[112:113]
 v_pk_fma_f32 v[98:99], v[98:99], s[20:21], v[112:113]
 v_pk_fma_f32 v[100:101], v[100:101], s[20:21], v[112:113]
 v_pk_fma_f32 v[102:103], v[102:103], s[20:21], v[112:113]
 v_pk_mul_f32 v[96:97], v[96:97], v[40:41]
 v_pk_mul_f32 v[98:99], v[98:99], v[42:43]
 v_pk_mul_f32 v[100:101], v[100:101], v[44:45]
 s_waitcnt lgkmcnt(4)
 v_mfma_f32_32x32x16_bf16 v[64:79], a[112:115], a[20:23], v[64:79]
 s_waitcnt vmcnt(12)
 s_barrier
 ds_read_b64_tr_b16 a[128:129], v21 offset:17408
 ds_read_b64_tr_b16 a[130:131], v21 offset:18176
 v_pk_mul_f32 v[102:103], v[102:103], v[46:47]
 v_exp_f32 v96, v96
 v_exp_f32 v98, v98
 v_exp_f32 v100, v100
 v_exp_f32 v102, v102
 v_mfma_f32_32x32x16_bf16 v[80:95], a[116:119], a[24:27], v[80:95]
 ds_read_b64_tr_b16 a[132:133], v15 offset:17408
 ds_read_b64_tr_b16 a[134:135], v15 offset:18176
 v_exp_f32 v97, v97
 v_exp_f32 v99, v99
 v_exp_f32 v101, v101
 v_exp_f32 v103, v103
 v_pk_add_f32 v[96:97], v[96:97], 1.0 op_sel_hi:[1,0]
 v_pk_add_f32 v[98:99], v[98:99], 1.0 op_sel_hi:[1,0]
 v_pk_add_f32 v[100:101], v[100:101], 1.0 op_sel_hi:[1,0]
 v_pk_add_f32 v[102:103], v[102:103], 1.0 op_sel_hi:[1,0]
 s_waitcnt lgkmcnt(4)
 v_mfma_f32_32x32x16_bf16 v[64:79], a[120:123], a[24:27], v[64:79]
 ds_read_b64_tr_b16 a[136:137], v18 offset:17408
 ds_read_b64_tr_b16 a[138:139], v18 offset:18176
 v_rcp_f32 v96, v96
 v_rcp_f32 v98, v98
 v_rcp_f32 v100, v100
 v_rcp_f32 v102, v102
 v_rcp_f32 v97, v97
 v_rcp_f32 v99, v99
 v_mfma_f32_32x32x16_bf16 v[64:79], a[124:127], a[28:31], v[64:79]
 ds_read_b64_tr_b16 a[140:141], v21 offset:23552
 ds_read_b64_tr_b16 a[142:143], v21 offset:24320
 v_rcp_f32 v101, v101
 v_rcp_f32 v103, v103
 v_pk_mul_f32 v[40:41], v[40:41], v[96:97]
 v_pk_mul_f32 v[42:43], v[42:43], v[98:99]
 v_pk_mul_f32 v[44:45], v[44:45], v[100:101]
 v_pk_mul_f32 v[46:47], v[46:47], v[102:103]
 v_pk_add_f32 v[114:115], v[114:115], v[40:41]
 v_pk_fma_f32 v[116:117], v[40:41], v[40:41], v[116:117]
 v_pk_add_f32 v[114:115], v[114:115], v[42:43]
 v_pk_fma_f32 v[116:117], v[42:43], v[42:43], v[116:117]
 s_waitcnt lgkmcnt(4)
 v_mfma_f32_32x32x16_bf16 v[80:95], a[128:131], a[32:35], v[80:95]
 ds_read_b64_tr_b16 a[112:113], v15 offset:23552
 ds_read_b64_tr_b16 a[114:115], v15 offset:24320
 v_pk_add_f32 v[114:115], v[114:115], v[44:45]
 v_pk_fma_f32 v[116:117], v[44:45], v[44:45], v[116:117]
 v_pk_add_f32 v[114:115], v[114:115], v[46:47]
 v_pk_fma_f32 v[116:117], v[46:47], v[46:47], v[116:117]
 v_pk_mul_f32 v[96:97], v[48:49], v[48:49]
 v_pk_mul_f32 v[98:99], v[50:51], v[50:51]
 v_pk_mul_f32 v[100:101], v[52:53], v[52:53]
 v_pk_mul_f32 v[102:103], v[54:55], v[54:55]
 v_pk_fma_f32 v[96:97], v[96:97], s[20:21], v[112:113]
 v_pk_fma_f32 v[98:99], v[98:99], s[20:21], v[112:113]
 v_pk_fma_f32 v[100:101], v[100:101], s[20:21], v[112:113]
 v_pk_fma_f32 v[102:103], v[102:103], s[20:21], v[112:113]
 v_mfma_f32_32x32x16_bf16 v[64:79], a[132:135], a[32:35], v[64:79]
 ds_read_b64_tr_b16 a[116:117], v18 offset:23552
 ds_read_b64_tr_b16 a[118:119], v18 offset:24320
 v_pk_mul_f32 v[96:97], v[96:97], v[48:49]
 v_pk_mul_f32 v[98:99], v[98:99], v[50:51]
 v_pk_mul_f32 v[100:101], v[100:101], v[52:53]
 v_pk_mul_f32 v[102:103], v[102:103], v[54:55]
 v_exp_f32 v96, v96
 v_exp_f32 v98, v98
 v_exp_f32 v100, v100
 v_exp_f32 v102, v102
 s_waitcnt lgkmcnt(4)
 v_mfma_f32_32x32x16_bf16 v[64:79], a[136:139], a[36:39], v[64:79]
 s_waitcnt vmcnt(9)
 s_barrier
 ds_read_b64_tr_b16 a[120:121], v21 offset:34816
 ds_read_b64_tr_b16 a[122:123], v21 offset:35584
 v_exp_f32 v97, v97
 v_exp_f32 v99, v99
 v_exp_f32 v101, v101
 v_exp_f32 v103, v103
 v_pk_add_f32 v[96:97], v[96:97], 1.0 op_sel_hi:[1,0]
 v_pk_add_f32 v[98:99], v[98:99], 1.0 op_sel_hi:[1,0]
 v_mfma_f32_32x32x16_bf16 v[80:95], a[140:143], a[40:43], v[80:95]
 ds_read_b64_tr_b16 a[124:125], v15 offset:34816
 ds_read_b64_tr_b16 a[126:127], v15 offset:35584
 v_pk_add_f32 v[100:101], v[100:101], 1.0 op_sel_hi:[1,0]
 v_pk_add_f32 v[102:103], v[102:103], 1.0 op_sel_hi:[1,0]
 v_rcp_f32 v96, v96
 v_rcp_f32 v98, v98
 v_rcp_f32 v100, v100
 v_rcp_f32 v102, v102
 v_rcp_f32 v97, v97
 s_waitcnt lgkmcnt(4)
 v_mfma_f32_32x32x16_bf16 v[64:79], a[112:115], a[40:43], v[64:79]
 ds_read_b64_tr_b16 a[128:129], v18 offset:34816
 ds_read_b64_tr_b16 a[130:131], v18 offset:35584
 v_rcp_f32 v99, v99
 v_rcp_f32 v101, v101
 v_rcp_f32 v103, v103
 v_pk_mul_f32 v[48:49], v[48:49], v[96:97]
 v_pk_mul_f32 v[50:51], v[50:51], v[98:99]
 v_pk_mul_f32 v[52:53], v[52:53], v[100:101]
 v_pk_mul_f32 v[54:55], v[54:55], v[102:103]
 v_pk_add_f32 v[114:115], v[114:115], v[48:49]
 v_pk_fma_f32 v[116:117], v[48:49], v[48:49], v[116:117]
 v_mfma_f32_32x32x16_bf16 v[64:79], a[116:119], a[44:47], v[64:79]
 ds_read_b64_tr_b16 a[132:133], v21 offset:40960
 ds_read_b64_tr_b16 a[134:135], v21 offset:41728
 v_pk_add_f32 v[114:115], v[114:115], v[50:51]
 v_pk_fma_f32 v[116:117], v[50:51], v[50:51], v[116:117]
 v_pk_add_f32 v[114:115], v[114:115], v[52:53]
 v_pk_fma_f32 v[116:117], v[52:53], v[52:53], v[116:117]
 v_pk_add_f32 v[114:115], v[114:115], v[54:55]
 v_pk_fma_f32 v[116:117], v[54:55], v[54:55], v[116:117]
 v_pk_mul_f32 v[96:97], v[56:57], v[56:57]
 v_pk_mul_f32 v[98:99], v[58:59], v[58:59]
 v_pk_mul_f32 v[100:101], v[60:61], v[60:61]
 v_pk_mul_f32 v[102:103], v[62:63], v[62:63]
 v_pk_fma_f32 v[96:97], v[96:97], s[20:21], v[112:113]
 v_pk_fma_f32 v[98:99], v[98:99], s[20:21], v[112:113]
 s_waitcnt lgkmcnt(4)
 v_mfma_f32_32x32x16_bf16 v[80:95], a[120:123], a[48:51], v[80:95]
 ds_read_b64_tr_b16 a[136:137], v15 offset:40960
 ds_read_b64_tr_b16 a[138:139], v15 offset:41728
 v_pk_fma_f32 v[100:101], v[100:101], s[20:21], v[112:113]
 v_pk_fma_f32 v[102:103], v[102:103], s[20:21], v[112:113]
 v_pk_mul_f32 v[96:97], v[96:97], v[56:57]
 v_pk_mul_f32 v[98:99], v[98:99], v[58:59]
 v_pk_mul_f32 v[100:101], v[100:101], v[60:61]
 v_pk_mul_f32 v[102:103], v[102:103], v[62:63]
 v_exp_f32 v96, v96
 v_exp_f32 v98, v98
 v_exp_f32 v100, v100
 v_mfma_f32_32x32x16_bf16 v[64:79], a[124:127], a[48:51], v[64:79]
 ds_read_b64_tr_b16 a[140:141], v18 offset:40960
 ds_read_b64_tr_b16 a[142:143], v18 offset:41728
 v_exp_f32 v102, v102
 v_exp_f32 v97, v97
 v_exp_f32 v99, v99
 v_exp_f32 v101, v101
 v_exp_f32 v103, v103
 v_pk_add_f32 v[96:97], v[96:97], 1.0 op_sel_hi:[1,0]
 v_pk_add_f32 v[98:99], v[98:99], 1.0 op_sel_hi:[1,0]
 s_waitcnt lgkmcnt(4)
 v_mfma_f32_32x32x16_bf16 v[64:79], a[128:131], a[52:55], v[64:79]
 s_waitcnt vmcnt(6)
 s_barrier
 ds_read_b64_tr_b16 a[112:113], v22 offset:0
 ds_read_b64_tr_b16 a[114:115], v22 offset:768
 v_pk_add_f32 v[100:101], v[100:101], 1.0 op_sel_hi:[1,0]
 v_pk_add_f32 v[102:103], v[102:103], 1.0 op_sel_hi:[1,0]
 v_rcp_f32 v96, v96
 v_rcp_f32 v98, v98
 v_rcp_f32 v100, v100
 v_rcp_f32 v102, v102
 v_mfma_f32_32x32x16_bf16 v[80:95], a[132:135], a[56:59], v[80:95]
 ds_read_b64_tr_b16 a[116:117], v16 offset:0
 ds_read_b64_tr_b16 a[118:119], v16 offset:768
 v_rcp_f32 v97, v97
 v_rcp_f32 v99, v99
 v_rcp_f32 v101, v101
 v_rcp_f32 v103, v103
 v_pk_mul_f32 v[56:57], v[56:57], v[96:97]
 v_pk_mul_f32 v[58:59], v[58:59], v[98:99]
 v_pk_mul_f32 v[60:61], v[60:61], v[100:101]
 v_pk_mul_f32 v[62:63], v[62:63], v[102:103]
 s_waitcnt lgkmcnt(4)
 v_mfma_f32_32x32x16_bf16 v[64:79], a[136:139], a[56:59], v[64:79]
 ds_read_b64_tr_b16 a[120:121], v19 offset:0
 ds_read_b64_tr_b16 a[122:123], v19 offset:768
 v_pk_mul_f32 v[120:121], v[56:57], v[56:57]
 v_pk_add_f32 v[118:119], v[56:57], v[58:59]
 v_pk_fma_f32 v[120:121], v[58:59], v[58:59], v[120:121]
 v_pk_add_f32 v[118:119], v[118:119], v[60:61]
 v_pk_fma_f32 v[120:121], v[60:61], v[60:61], v[120:121]
 v_pk_add_f32 v[118:119], v[118:119], v[62:63]
 v_pk_fma_f32 v[120:121], v[62:63], v[62:63], v[120:121]
 v_add_f32 v114, v114, v115
 v_add_f32 v118, v118, v119
 v_add_f32 v115, v116, v117
 v_add_f32 v120, v120, v121
 v_fmac_f32 v114, s22, v118
 v_mfma_f32_32x32x16_bf16 v[64:79], a[140:143], a[60:63], v[64:79]
 ds_read_b64_tr_b16 a[124:125], v22 offset:6144
 ds_read_b64_tr_b16 a[126:127], v22 offset:6912
 v_fmac_f32 v115, s22, v120
 v_mov_b32 v116, v114
 v_mov_b32 v117, v115
 s_nop 0
 v_permlane32_swap_b32 v114, v116
 v_permlane32_swap_b32 v115, v117
 v_pk_add_f32 v[114:115], v[114:115], v[116:117]
 v_max_f32 v115, 0, v115
 buffer_store_dwordx2 v[114:115], v30, s[8:11], s25 offen sc1
 s_waitcnt lgkmcnt(4)
 v_mfma_f32_32x32x16_bf16 v[80:95], a[112:115], a[64:67], v[80:95]
 ds_read_b64_tr_b16 a[128:129], v16 offset:6144
 ds_read_b64_tr_b16 a[130:131], v16 offset:6912
 v_mfma_f32_32x32x16_bf16 v[64:79], a[116:119], a[64:67], v[64:79]
 ds_read_b64_tr_b16 a[132:133], v19 offset:6144
 ds_read_b64_tr_b16 a[134:135], v19 offset:6912
 s_waitcnt lgkmcnt(4)
 v_mfma_f32_32x32x16_bf16 v[64:79], a[120:123], a[68:71], v[64:79]
 s_waitcnt vmcnt(4)
 s_barrier
 ds_read_b64_tr_b16 a[136:137], v22 offset:17408
 ds_read_b64_tr_b16 a[138:139], v22 offset:18176
 v_mfma_f32_32x32x16_bf16 v[80:95], a[124:127], a[72:75], v[80:95]
 ds_read_b64_tr_b16 a[140:141], v16 offset:17408
 ds_read_b64_tr_b16 a[142:143], v16 offset:18176
 s_waitcnt lgkmcnt(4)
 v_mfma_f32_32x32x16_bf16 v[64:79], a[128:131], a[72:75], v[64:79]
 ds_read_b64_tr_b16 a[112:113], v19 offset:17408
 ds_read_b64_tr_b16 a[114:115], v19 offset:18176
 v_mfma_f32_32x32x16_bf16 v[64:79], a[132:135], a[76:79], v[64:79]
 ds_read_b64_tr_b16 a[116:117], v22 offset:23552
 ds_read_b64_tr_b16 a[118:119], v22 offset:24320
 s_waitcnt lgkmcnt(4)
 v_mfma_f32_32x32x16_bf16 v[80:95], a[136:139], a[80:83], v[80:95]
 ds_read_b64_tr_b16 a[120:121], v16 offset:23552
 ds_read_b64_tr_b16 a[122:123], v16 offset:24320
 v_mfma_f32_32x32x16_bf16 v[64:79], a[140:143], a[80:83], v[64:79]
 ds_read_b64_tr_b16 a[124:125], v19 offset:23552
 ds_read_b64_tr_b16 a[126:127], v19 offset:24320
 s_waitcnt lgkmcnt(4)
 v_mfma_f32_32x32x16_bf16 v[64:79], a[112:115], a[84:87], v[64:79]
 s_waitcnt vmcnt(1)
 s_barrier
 ds_read_b64_tr_b16 a[128:129], v22 offset:34816
 ds_read_b64_tr_b16 a[130:131], v22 offset:35584
 v_mfma_f32_32x32x16_bf16 v[80:95], a[116:119], a[88:91], v[80:95]
 ds_read_b64_tr_b16 a[132:133], v16 offset:34816
 ds_read_b64_tr_b16 a[134:135], v16 offset:35584
 s_waitcnt lgkmcnt(4)
 v_mfma_f32_32x32x16_bf16 v[64:79], a[120:123], a[88:91], v[64:79]
 ds_read_b64_tr_b16 a[136:137], v19 offset:34816
 ds_read_b64_tr_b16 a[138:139], v19 offset:35584
 v_mfma_f32_32x32x16_bf16 v[64:79], a[124:127], a[92:95], v[64:79]
 ds_read_b64_tr_b16 a[140:141], v22 offset:40960
 ds_read_b64_tr_b16 a[142:143], v22 offset:41728
 s_waitcnt lgkmcnt(4)
 v_mfma_f32_32x32x16_bf16 v[80:95], a[128:131], a[96:99], v[80:95]
 ds_read_b64_tr_b16 a[112:113], v16 offset:40960
 ds_read_b64_tr_b16 a[114:115], v16 offset:41728
 v_mfma_f32_32x32x16_bf16 v[64:79], a[132:135], a[96:99], v[64:79]
 ds_read_b64_tr_b16 a[116:117], v19 offset:40960
 ds_read_b64_tr_b16 a[118:119], v19 offset:41728
 s_waitcnt lgkmcnt(4)
 v_mfma_f32_32x32x16_bf16 v[64:79], a[136:139], a[100:103], v[64:79]
 v_mfma_f32_32x32x16_bf16 v[80:95], a[140:143], a[104:107], v[80:95]
 s_waitcnt lgkmcnt(2)
 v_mfma_f32_32x32x16_bf16 v[64:79], a[112:115], a[104:107], v[64:79]
 s_waitcnt lgkmcnt(0)
 v_mfma_f32_32x32x16_bf16 v[64:79], a[116:119], a[108:111], v[64:79]
 s_nop 7
 ds_write_b128 v26, v[88:91]
 ds_write_b128 v26, v[92:95] offset:1024
 buffer_load_dwordx2 v[124:125], v31, s[8:11], s35 offen offset:0 sc1
 buffer_load_dwordx2 v[126:127], v31, s[8:11], s35 offen offset:256 sc1
 buffer_load_dwordx2 v[128:129], v31, s[8:11], s35 offen offset:512 sc1
 buffer_load_dwordx2 v[130:131], v31, s[8:11], s35 offen offset:768 sc1
 buffer_load_dwordx2 v[132:133], v31, s[8:11], s35 offen offset:1024 sc1
 buffer_load_dwordx2 v[134:135], v31, s[8:11], s35 offen offset:1280 sc1
 buffer_load_dwordx2 v[136:137], v31, s[8:11], s35 offen offset:1536 sc1
 buffer_load_dwordx2 v[138:139], v31, s[8:11], s35 offen offset:1792 sc1
 s_waitcnt lgkmcnt(0)
 s_barrier
 ds_read_b128 v[88:91], v27
 ds_read_b128 v[92:95], v27 offset:1024
 v_pk_mul_f32 v[96:97], v[64:65], v[64:65]
 v_pk_mul_f32 v[98:99], v[66:67], v[66:67]
 v_pk_mul_f32 v[100:101], v[68:69], v[68:69]
 v_pk_mul_f32 v[102:103], v[70:71], v[70:71]
 v_pk_fma_f32 v[96:97], v[96:97], s[20:21], v[112:113]
 v_pk_fma_f32 v[98:99], v[98:99], s[20:21], v[112:113]
 v_pk_fma_f32 v[100:101], v[100:101], s[20:21], v[112:113]
 v_pk_fma_f32 v[102:103], v[102:103], s[20:21], v[112:113]
 v_pk_mul_f32 v[96:97], v[96:97], v[64:65]
 v_pk_mul_f32 v[98:99], v[98:99], v[66:67]
 v_pk_mul_f32 v[100:101], v[100:101], v[68:69]
 v_pk_mul_f32 v[102:103], v[102:103], v[70:71]
 v_exp_f32 v96, v96
 v_exp_f32 v98, v98
 v_exp_f32 v100, v100
 v_exp_f32 v102, v102
 v_exp_f32 v97, v97
 v_exp_f32 v99, v99
 v_exp_f32 v101, v101
 v_exp_f32 v103, v103
 v_pk_add_f32 v[96:97], v[96:97], 1.0 op_sel_hi:[1,0]
 v_pk_add_f32 v[98:99], v[98:99], 1.0 op_sel_hi:[1,0]
 v_pk_add_f32 v[100:101], v[100:101], 1.0 op_sel_hi:[1,0]
 v_pk_add_f32 v[102:103], v[102:103], 1.0 op_sel_hi:[1,0]
 v_rcp_f32 v96, v96
 v_rcp_f32 v98, v98
 v_rcp_f32 v100, v100
 v_rcp_f32 v102, v102
 v_rcp_f32 v97, v97
 v_rcp_f32 v99, v99
 v_rcp_f32 v101, v101
 v_rcp_f32 v103, v103
 v_pk_mul_f32 v[64:65], v[64:65], v[96:97]
 v_pk_mul_f32 v[66:67], v[66:67], v[98:99]
 v_pk_mul_f32 v[68:69], v[68:69], v[100:101]
 v_pk_mul_f32 v[70:71], v[70:71], v[102:103]
 v_cvt_pk_bf16_f32 v140, v64, v65
 v_cvt_pk_bf16_f32 v141, v66, v67
 v_cvt_pk_bf16_f32 v142, v68, v69
 v_cvt_pk_bf16_f32 v143, v70, v71
 buffer_store_dwordx4 v[140:143], v1, s[8:11], s23 offen offset:0 sc1
 v_pk_mul_f32 v[96:97], v[72:73], v[72:73]
 v_pk_mul_f32 v[98:99], v[74:75], v[74:75]
 v_pk_mul_f32 v[100:101], v[76:77], v[76:77]
 v_pk_mul_f32 v[102:103], v[78:79], v[78:79]
 v_pk_fma_f32 v[96:97], v[96:97], s[20:21], v[112:113]
 v_pk_fma_f32 v[98:99], v[98:99], s[20:21], v[112:113]
 v_pk_fma_f32 v[100:101], v[100:101], s[20:21], v[112:113]
 v_pk_fma_f32 v[102:103], v[102:103], s[20:21], v[112:113]
 v_pk_mul_f32 v[96:97], v[96:97], v[72:73]
 v_pk_mul_f32 v[98:99], v[98:99], v[74:75]
 v_pk_mul_f32 v[100:101], v[100:101], v[76:77]
 v_pk_mul_f32 v[102:103], v[102:103], v[78:79]
 v_exp_f32 v96, v96
 v_exp_f32 v98, v98
 v_exp_f32 v100, v100
 v_exp_f32 v102, v102
 v_exp_f32 v97, v97
 v_exp_f32 v99, v99
 v_exp_f32 v101, v101
 v_exp_f32 v103, v103
 v_pk_add_f32 v[96:97], v[96:97], 1.0 op_sel_hi:[1,0]
 v_pk_add_f32 v[98:99], v[98:99], 1.0 op_sel_hi:[1,0]
 v_pk_add_f32 v[100:101], v[100:101], 1.0 op_sel_hi:[1,0]
 v_pk_add_f32 v[102:103], v[102:103], 1.0 op_sel_hi:[1,0]
 v_rcp_f32 v96, v96
 v_rcp_f32 v98, v98
 v_rcp_f32 v100, v100
 v_rcp_f32 v102, v102
 v_rcp_f32 v97, v97
 v_rcp_f32 v99, v99
 v_rcp_f32 v101, v101
 v_rcp_f32 v103, v103
 v_pk_mul_f32 v[72:73], v[72:73], v[96:97]
 v_pk_mul_f32 v[74:75], v[74:75], v[98:99]
 v_pk_mul_f32 v[76:77], v[76:77], v[100:101]
 v_pk_mul_f32 v[78:79], v[78:79], v[102:103]
 v_cvt_pk_bf16_f32 v144, v72, v73
 v_cvt_pk_bf16_f32 v145, v74, v75
 v_cvt_pk_bf16_f32 v146, v76, v77
 v_cvt_pk_bf16_f32 v147, v78, v79
 buffer_store_dwordx4 v[144:147], v1, s[8:11], s23 offen offset:1024 sc1
 s_waitcnt lgkmcnt(1)
 v_pk_add_f32 v[80:81], v[80:81], v[88:89]
 v_pk_add_f32 v[82:83], v[82:83], v[90:91]
 s_waitcnt lgkmcnt(0)
 v_pk_add_f32 v[84:85], v[84:85], v[92:93]
 v_pk_add_f32 v[86:87], v[86:87], v[94:95]
 v_pk_mul_f32 v[96:97], v[80:81], v[80:81]
 v_pk_mul_f32 v[98:99], v[82:83], v[82:83]
 v_pk_mul_f32 v[100:101], v[84:85], v[84:85]
 v_pk_mul_f32 v[102:103], v[86:87], v[86:87]
 v_pk_fma_f32 v[96:97], v[96:97], s[20:21], v[112:113]
 v_pk_fma_f32 v[98:99], v[98:99], s[20:21], v[112:113]
 v_pk_fma_f32 v[100:101], v[100:101], s[20:21], v[112:113]
 v_pk_fma_f32 v[102:103], v[102:103], s[20:21], v[112:113]
 v_pk_mul_f32 v[96:97], v[96:97], v[80:81]
 v_pk_mul_f32 v[98:99], v[98:99], v[82:83]
 v_pk_mul_f32 v[100:101], v[100:101], v[84:85]
 v_pk_mul_f32 v[102:103], v[102:103], v[86:87]
 v_exp_f32 v96, v96
 v_exp_f32 v98, v98
 v_exp_f32 v100, v100
 v_exp_f32 v102, v102
 v_exp_f32 v97, v97
 v_exp_f32 v99, v99
 v_exp_f32 v101, v101
 v_exp_f32 v103, v103
 v_pk_add_f32 v[96:97], v[96:97], 1.0 op_sel_hi:[1,0]
 v_pk_add_f32 v[98:99], v[98:99], 1.0 op_sel_hi:[1,0]
 v_pk_add_f32 v[100:101], v[100:101], 1.0 op_sel_hi:[1,0]
 v_pk_add_f32 v[102:103], v[102:103], 1.0 op_sel_hi:[1,0]
 v_rcp_f32 v96, v96
 v_rcp_f32 v98, v98
 v_rcp_f32 v100, v100
 v_rcp_f32 v102, v102
 v_rcp_f32 v97, v97
 v_rcp_f32 v99, v99
 v_rcp_f32 v101, v101
 v_rcp_f32 v103, v103
 v_pk_mul_f32 v[80:81], v[80:81], v[96:97]
 v_pk_mul_f32 v[82:83], v[82:83], v[98:99]
 v_pk_mul_f32 v[84:85], v[84:85], v[100:101]
 v_pk_mul_f32 v[86:87], v[86:87], v[102:103]
 v_cvt_pk_bf16_f32 v148, v80, v81
 v_cvt_pk_bf16_f32 v149, v82, v83
 v_cvt_pk_bf16_f32 v150, v84, v85
 v_cvt_pk_bf16_f32 v151, v86, v87
 buffer_store_dwordx4 v[148:151], v1, s[8:11], s34 offen offset:2048 sc1
 s_movk_i32 s28, 0x4000
 s_waitcnt vmcnt(8)
 v_max3_u32 v96, v125, v127, v129
 s_waitcnt vmcnt(5)
 v_max3_u32 v97, v131, v133, v135
 s_waitcnt vmcnt(3)
 v_max3_u32 v96, v96, v137, v139
 v_max_u32 v96, v96, v97
 v_cmp_eq_u32 vcc, -1, v96
 s_cbranch_vccz K2B_GOT
K2B_POLL:
 buffer_load_dwordx2 v[124:125], v31, s[8:11], s35 offen offset:0 sc1
 buffer_load_dwordx2 v[126:127], v31, s[8:11], s35 offen offset:256 sc1
 buffer_load_dwordx2 v[128:129], v31, s[8:11], s35 offen offset:512 sc1
 buffer_load_dwordx2 v[130:131], v31, s[8:11], s35 offen offset:768 sc1
 buffer_load_dwordx2 v[132:133], v31, s[8:11], s35 offen offset:1024 sc1
 buffer_load_dwordx2 v[134:135], v31, s[8:11], s35 offen offset:1280 sc1
 buffer_load_dwordx2 v[136:137], v31, s[8:11], s35 offen offset:1536 sc1
 buffer_load_dwordx2 v[138:139], v31, s[8:11], s35 offen offset:1792 sc1
 s_waitcnt vmcnt(0)
 v_max3_u32 v96, v125, v127, v129
 v_max3_u32 v97, v131, v133, v135
 v_max3_u32 v96, v96, v137, v139
 v_max_u32 v96, v96, v97
 v_cmp_eq_u32 vcc, -1, v96
 s_sub_u32 s28, s28, 1
 s_cbranch_scc1 K2B_GOT
 s_cbranch_vccnz K2B_POLL
K2B_GOT:
 v_pk_add_f32 v[124:125], v[124:125], v[126:127]
 v_pk_add_f32 v[124:125], v[124:125], v[128:129]
 v_pk_add_f32 v[124:125], v[124:125], v[130:131]
 v_pk_add_f32 v[124:125], v[124:125], v[132:133]
 v_pk_add_f32 v[124:125], v[124:125], v[134:135]
 v_pk_add_f32 v[124:125], v[124:125], v[136:137]
 v_pk_add_f32 v[124:125], v[124:125], v[138:139]
 v_mov_b32 v126, v124
 v_mov_b32 v127, v125
 s_nop 0
 v_permlane32_swap_b32 v124, v126
 v_permlane32_swap_b32 v125, v127
 v_pk_add_f32 v[124:125], v[124:125], v[126:127]
 v_mul_f32 v124, 0x3a924925, v124
 v_mov_b32 v156, 0x3727c5ac
 v_fmac_f32 v156, 0x3a924925, v125
 v_fma_f32 v156, -v124, v124, v156
 v_max_f32 v156, 0x3727c5ac, v156
 v_rsq_f32 v156, v156
 s_nop 0
 v_mul_f32 v158, v156, -v124
 v_cndmask_b32 v160, v156, 1.0, s[26:27]
 v_cndmask_b32 v162, v158, 0, s[26:27]
 v_pk_fma_f32 v[32:33], v[32:33], v[156:157], v[158:159] op_sel_hi:[1,0,0]
 v_pk_fma_f32 v[34:35], v[34:35], v[156:157], v[158:159] op_sel_hi:[1,0,0]
 v_pk_fma_f32 v[36:37], v[36:37], v[156:157], v[158:159] op_sel_hi:[1,0,0]
 v_pk_fma_f32 v[38:39], v[38:39], v[156:157], v[158:159] op_sel_hi:[1,0,0]
 v_cvt_pk_bf16_f32 v64, v32, v33
 v_cvt_pk_bf16_f32 v65, v34, v35
 v_cvt_pk_bf16_f32 v66, v36, v37
 v_cvt_pk_bf16_f32 v67, v38, v39
 buffer_store_dwordx4 v[64:67], v28, s[8:11], s24 offen offset:0
 v_pk_fma_f32 v[40:41], v[40:41], v[156:157], v[158:159] op_sel_hi:[1,0,0]
 v_pk_fma_f32 v[42:43], v[42:43], v[156:157], v[158:159] op_sel_hi:[1,0,0]
 v_pk_fma_f32 v[44:45], v[44:45], v[156:157], v[158:159] op_sel_hi:[1,0,0]
 v_pk_fma_f32 v[46:47], v[46:47], v[156:157], v[158:159] op_sel_hi:[1,0,0]
 v_cvt_pk_bf16_f32 v68, v40, v41
 v_cvt_pk_bf16_f32 v69, v42, v43
 v_cvt_pk_bf16_f32 v70, v44, v45
 v_cvt_pk_bf16_f32 v71, v46, v47
 buffer_store_dwordx4 v[68:71], v28, s[8:11], s24 offen offset:32
 v_pk_fma_f32 v[48:49], v[48:49], v[156:157], v[158:159] op_sel_hi:[1,0,0]
 v_pk_fma_f32 v[50:51], v[50:51], v[156:157], v[158:159] op_sel_hi:[1,0,0]
 v_pk_fma_f32 v[52:53], v[52:53], v[156:157], v[158:159] op_sel_hi:[1,0,0]
 v_pk_fma_f32 v[54:55], v[54:55], v[156:157], v[158:159] op_sel_hi:[1,0,0]
 v_cvt_pk_bf16_f32 v72, v48, v49
 v_cvt_pk_bf16_f32 v73, v50, v51
 v_cvt_pk_bf16_f32 v74, v52, v53
 v_cvt_pk_bf16_f32 v75, v54, v55
 buffer_store_dwordx4 v[72:75], v28, s[8:11], s24 offen offset:64
 v_pk_fma_f32 v[56:57], v[56:57], v[160:161], v[162:163] op_sel_hi:[1,0,0]
 v_pk_fma_f32 v[58:59], v[58:59], v[160:161], v[162:163] op_sel_hi:[1,0,0]
 v_pk_fma_f32 v[60:61], v[60:61], v[160:161], v[162:163] op_sel_hi:[1,0,0]
 v_pk_fma_f32 v[62:63], v[62:63], v[160:161], v[162:163] op_sel_hi:[1,0,0]
 v_cvt_pk_bf16_f32 v76, v56, v57
 v_cvt_pk_bf16_f32 v77, v58, v59
 v_cvt_pk_bf16_f32 v78, v60, v61
 v_cvt_pk_bf16_f32 v79, v62, v63
 buffer_store_dwordx4 v[76:79], v29, s[8:11], 0 offen
K2B_END:
 s_endpgm
.globl k3_kernel
.p2align 8
.type k3_kernel,@function
k3_kernel:
 s_cmp_ge_u32 s2, 256
 s_cbranch_scc1 K3_END
 s_load_dwordx2 s[40:41], s[0:1], 112
 s_load_dwordx4 s[44:47], s[0:1], 56
 v_lshrrev_b32 v20, 6, v0
 v_and_b32 v0, 63, v0
 v_readfirstlane_b32 s3, v20
 s_bfe_u32 s30, s2, 0x20001
 s_lshl_b32 s30, s30, 3
 s_bfe_u32 s31, s2, 0x30003
 s_add_u32 s5, s30, s31
 s_and_b32 s30, s2, 1
 s_lshl_b32 s30, s30, 2
 s_lshr_b32 s31, s2, 6
 s_add_u32 s4, s30, s31
 v_lshlrev_b32 v1, 4, v0
 v_add_u32 v2, 4096, v1
 v_lshrrev_b32 v20, 3, v0
 v_lshlrev_b32 v20, 12, v20
 v_lshrrev_b32 v21, 4, v0
 v_and_b32 v22, 7, v0
 v_xor_b32 v21, v21, v22
 v_lshl_add_u32 v3, v21, 4, v20
 v_xor_b32 v20, 64, v3
 v_add_u32 v4, 31744, v20
 v_add_u32 v5, 63488, v3
 v_add_u32 v6, 95232, v20
 s_mul_i32 s22, s3, 40960
 s_mul_i32 s25, s4, 458752
 s_mul_i32 s30, s3, 114688
 s_add_u32 s25, s25, s30
 s_add_u32 s25, s25, 10485760
 s_lshl_b32 s26, s5, 18
 s_lshl_b32 s30, s3, 10
 s_add_u32 s26, s26, s30
 s_mov_b32 s20, s25
 s_mov_b32 s21, s26
 s_add_u32 s27, s26, 131072
 s_waitcnt lgkmcnt(0)
 s_mov_b32 s8, s40
 s_mov_b32 s9, s41
 s_mov_b32 s10, 0x2300000
 s_mov_b32 s11, 0x00020000
 s_mov_b32 s12, s44
 s_mov_b32 s13, s45
 s_mov_b32 s14, 0x800000
 s_mov_b32 s15, 0x00020000
 s_mov_b32 s16, s46
 s_mov_b32 s17, s47
 s_mov_b32 s18, 0x1000
 s_mov_b32 s19, 0x00020000
 s_add_u32 m0, s22, 16384
 s_nop 0
 buffer_load_dwordx4 v1, s[8:11], s20 offen offset:0 lds
 buffer_load_dwordx4 v1, s[8:11], s20 offen offset:1024 lds
 buffer_load_dwordx4 v1, s[8:11], s20 offen offset:2048 lds
 buffer_load_dwordx4 v1, s[8:11], s20 offen offset:3072 lds
 s_add_u32 m0, s22, 20480
 s_nop 0
 buffer_load_dwordx4 v2, s[8:11], s20 offen offset:0 lds
 buffer_load_dwordx4 v2, s[8:11], s20 offen offset:1024 lds
 buffer_load_dwordx4 v2, s[8:11], s20 offen offset:2048 lds
 s_add_u32 m0, s22, 0
 s_nop 0
 buffer_load_dwordx4 v3, s[12:15], s21 offen offset:0 lds
 buffer_load_dwordx4 v4, s[12:15], s21 offen offset:1024 lds
 buffer_load_dwordx4 v5, s[12:15], s21 offen offset:2048 lds
 buffer_load_dwordx4 v6, s[12:15], s21 offen offset:3072 lds
 s_add_u32 m0, s22, 4096
 s_nop 0
 buffer_load_dwordx4 v3, s[12:15], s27 offen offset:0 lds
 buffer_load_dwordx4 v4, s[12:15], s27 offen offset:1024 lds
 buffer_load_dwordx4 v5, s[12:15], s27 offen offset:2048 lds
 buffer_load_dwordx4 v6, s[12:15], s27 offen offset:3072 lds
 s_add_u32 s20, s20, 7168
 s_add_u32 m0, s22, 23552
 s_nop 0
 buffer_load_dwordx4 v1, s[8:11], s20 offen offset:0 lds
 buffer_load_dwordx4 v1, s[8:11], s20 offen offset:1024 lds
 buffer_load_dwordx4 v1, s[8:11], s20 offen offset:2048 lds
 buffer_load_dwordx4 v1, s[8:11], s20 offen offset:3072 lds
 s_add_u32 m0, s22, 27648
 s_nop 0
 buffer_load_dwordx4 v2, s[8:11], s20 offen offset:0 lds
 buffer_load_dwordx4 v2, s[8:11], s20 offen offset:1024 lds
 buffer_load_dwordx4 v2, s[8:11], s20 offen offset:2048 lds
 s_add_u32 s20, s20, 7168
 s_add_u32 m0, s22, 30720
 s_nop 0
 buffer_load_dwordx4 v1, s[8:11], s20 offen offset:0 lds
 buffer_load_dwordx4 v1, s[8:11], s20 offen offset:1024 lds
 buffer_load_dwordx4 v1, s[8:11], s20 offen offset:2048 lds
 buffer_load_dwordx4 v1, s[8:11], s20 offen offset:3072 lds
 s_add_u32 m0, s22, 34816
 s_nop 0
 buffer_load_dwordx4 v2, s[8:11], s20 offen offset:0 lds
 buffer_load_dwordx4 v2, s[8:11], s20 offen offset:1024 lds
 buffer_load_dwordx4 v2, s[8:11], s20 offen offset:2048 lds
 s_add_u32 s21, s21, 128
 s_add_u32 s27, s27, 128
 s_add_u32 m0, s22, 8192
 s_nop 0
 buffer_load_dwordx4 v3, s[12:15], s21 offen offset:0 lds
 buffer_load_dwordx4 v4, s[12:15], s21 offen offset:1024 lds
 buffer_load_dwordx4 v5, s[12:15], s21 offen offset:2048 lds
 buffer_load_dwordx4 v6, s[12:15], s21 offen offset:3072 lds
 s_add_u32 m0, s22, 12288
 s_nop 0
 buffer_load_dwordx4 v3, s[12:15], s27 offen offset:0 lds
 buffer_load_dwordx4 v4, s[12:15], s27 offen offset:1024 lds
 buffer_load_dwordx4 v5, s[12:15], s27 offen offset:2048 lds
 buffer_load_dwordx4 v6, s[12:15], s27 offen offset:3072 lds
 v_lshrrev_b32 v20, 5, v0
 v_bfe_u32 v21, v0, 4, 1
 v_bfe_u32 v22, v0, 2, 2
 v_lshl_add_u32 v22, v21, 2, v22
 v_lshl_add_u32 v22, v20, 4, v22
 v_mul_u32_u24 v22, 224, v22
 v_and_b32 v23, 3, v0
 v_lshl_add_u32 v22, v23, 3, v22
 v_add_u32 v7, s22, v22
 v_and_b32 v20, 15, v0
 v_lshrrev_b32 v21, 4, v0
 v_lshrrev_b32 v22, 1, v20
 v_xor_b32 v22, v22, v21
 v_lshlrev_b32 v22, 4, v22
 v_lshl_add_u32 v22, v20, 7, v22
 v_add_u32 v22, s22, v22
 s_xor_b32 s30, s3, 0
 s_lshl_b32 s30, s30, 11
 v_add_u32 v8, s30, v22
 v_xor_b32 v25, 64, v8
 s_xor_b32 s30, s3, 1
 s_lshl_b32 s30, s30, 11
 v_add_u32 v9, s30, v22
 v_xor_b32 v26, 64, v9
 s_xor_b32 s30, s3, 2
 s_lshl_b32 s30, s30, 11
 v_add_u32 v10, s30, v22
 v_xor_b32 v27, 64, v10
 s_xor_b32 s30, s3, 3
 s_lshl_b32 s30, s30, 11
 v_add_u32 v11, s30, v22
 v_xor_b32 v28, 64, v11
 v_add_u32 v12, s22, v1
 s_xor_b32 s30, s3, 1
 s_mul_i32 s30, s30, 40960
 v_add_u32 v13, s30, v1
 s_xor_b32 s30, s3, 2
 s_mul_i32 s30, s30, 40960
 v_add_u32 v14, s30, v1
 s_xor_b32 s30, s3, 3
 s_mul_i32 s30, s30, 40960
 v_add_u32 v15, s30, v1
 s_and_b32 s30, s3, 1
 s_lshl_b32 s30, s30, 8
 v_lshlrev_b32 v23, 4, v20
 v_add_u32 v23, s30, v23
 v_lshl_add_u32 v16, v21, 9, v23
 v_lshrrev_b32 v24, 5, v0
 v_lshl_add_u32 v23, v24, 9, v23
 v_bfe_u32 v24, v0, 4, 1
 v_lshl_add_u32 v17, v24, 3, v23
 v_add_u32 v17, 6144, v17
 v_add_u32 v19, 4096, v16
 s_lshl_b32 s30, s5, 1
 s_lshr_b32 s31, s3, 1
 s_add_u32 s30, s30, s31
 s_mul_i32 s30, s30, 57344
 s_mul_i32 s31, s4, 7168
 s_add_u32 s30, s30, s31
 s_add_u32 s23, s30, 14680064
 s_add_u32 s30, s30, 6291456
 s_lshl_b32 s31, s5, 7
 s_lshl_b32 s32, s3, 5
 s_add_u32 s31, s31, s32
 v_lshlrev_b32 v18, 1, v20
 s_waitcnt vmcnt(22)
 ds_read_b128 a[56:59], v8 offset:0
 ds_read_b64_tr_b16 a[0:1], v7 offset:16384
 ds_read_b64_tr_b16 a[2:3], v7 offset:18176
 ds_read_b128 a[60:63], v9 offset:0
 ds_read_b64_tr_b16 a[4:5], v7 offset:16416
 ds_read_b64_tr_b16 a[6:7], v7 offset:18208
 ds_read_b128 a[64:67], v10 offset:0
 ds_read_b64_tr_b16 a[8:9], v7 offset:16448
 ds_read_b64_tr_b16 a[10:11], v7 offset:18240
 ds_read_b128 a[68:71], v11 offset:0
 ds_read_b64_tr_b16 a[12:13], v7 offset:16480
 ds_read_b64_tr_b16 a[14:15], v7 offset:18272
 ds_read_b64_tr_b16 a[16:17], v7 offset:16512
 ds_read_b64_tr_b16 a[18:19], v7 offset:18304
 ds_read_b64_tr_b16 a[20:21], v7 offset:16544
 ds_read_b64_tr_b16 a[22:23], v7 offset:18336
 ds_read_b64_tr_b16 a[24:25], v7 offset:16576
 ds_read_b64_tr_b16 a[26:27], v7 offset:18368
 s_waitcnt lgkmcnt(0)
 s_add_u32 s20, s20, 7168
 s_add_u32 m0, s22, 16384
 s_nop 0
 buffer_load_dwordx4 v1, s[8:11], s20 offen offset:0 lds
 buffer_load_dwordx4 v1, s[8:11], s20 offen offset:1024 lds
 buffer_load_dwordx4 v1, s[8:11], s20 offen offset:2048 lds
 buffer_load_dwordx4 v1, s[8:11], s20 offen offset:3072 lds
 s_add_u32 m0, s22, 20480
 s_nop 0
 buffer_load_dwordx4 v2, s[8:11], s20 offen offset:0 lds
 buffer_load_dwordx4 v2, s[8:11], s20 offen offset:1024 lds
 buffer_load_dwordx4 v2, s[8:11], s20 offen offset:2048 lds
 s_waitcnt vmcnt(22)
 v_mfma_f32_16x16x32_bf16 v[32:35], a[0:3], a[56:59], 0
 ds_read_b128 a[72:75], v25 offset:0
 ds_read_b64_tr_b16 a[28:29], v7 offset:23552
 v_mfma_f32_16x16x32_bf16 v[60:63], a[0:3], a[60:63], 0
 ds_read_b64_tr_b16 a[30:31], v7 offset:25344
 ds_read_b128 a[76:79], v26 offset:0
 v_mfma_f32_16x16x32_bf16 v[88:91], a[0:3], a[64:67], 0
 ds_read_b64_tr_b16 a[32:33], v7 offset:23584
 ds_read_b64_tr_b16 a[34:35], v7 offset:25376
 v_mfma_f32_16x16x32_bf16 v[116:119], a[0:3], a[68:71], 0
 ds_read_b128 a[80:83], v27 offset:0
 ds_read_b64_tr_b16 a[36:37], v7 offset:23616
 v_mfma_f32_16x16x32_bf16 v[36:39], a[4:7], a[56:59], 0
 ds_read_b64_tr_b16 a[38:39], v7 offset:25408
 ds_read_b128 a[84:87], v28 offset:0
 v_mfma_f32_16x16x32_bf16 v[64:67], a[4:7], a[60:63], 0
 ds_read_b64_tr_b16 a[40:41], v7 offset:23648
 ds_read_b64_tr_b16 a[42:43], v7 offset:25440
 v_mfma_f32_16x16x32_bf16 v[92:95], a[4:7], a[64:67], 0
 ds_read_b64_tr_b16 a[44:45], v7 offset:23680
 ds_read_b64_tr_b16 a[46:47], v7 offset:25472
 v_mfma_f32_16x16x32_bf16 v[120:123], a[4:7], a[68:71], 0
 ds_read_b64_tr_b16 a[48:49], v7 offset:23712
 ds_read_b64_tr_b16 a[50:51], v7 offset:25504
 v_mfma_f32_16x16x32_bf16 v[40:43], a[8:11], a[56:59], 0
 ds_read_b64_tr_b16 a[52:53], v7 offset:23744
 ds_read_b64_tr_b16 a[54:55], v7 offset:25536
 v_mfma_f32_16x16x32_bf16 v[68:71], a[8:11], a[60:63], 0
 v_mfma_f32_16x16x32_bf16 v[96:99], a[8:11], a[64:67], 0
 v_mfma_f32_16x16x32_bf16 v[124:127], a[8:11], a[68:71], 0
 v_mfma_f32_16x16x32_bf16 v[44:47], a[12:15], a[56:59], 0
 v_mfma_f32_16x16x32_bf16 v[72:75], a[12:15], a[60:63], 0
 v_mfma_f32_16x16x32_bf16 v[100:103], a[12:15], a[64:67], 0
 s_waitcnt lgkmcnt(0)
 s_add_u32 s20, s20, 7168
 s_add_u32 m0, s22, 23552
 v_mfma_f32_16x16x32_bf16 v[128:131], a[12:15], a[68:71], 0
 buffer_load_dwordx4 v1, s[8:11], s20 offen offset:0 lds
 buffer_load_dwordx4 v1, s[8:11], s20 offen offset:1024 lds
 v_mfma_f32_16x16x32_bf16 v[48:51], a[16:19], a[56:59], 0
 buffer_load_dwordx4 v1, s[8:11], s20 offen offset:2048 lds
 buffer_load_dwordx4 v1, s[8:11], s20 offen offset:3072 lds
 v_mfma_f32_16x16x32_bf16 v[76:79], a[16:19], a[60:63], 0
 s_add_u32 m0, s22, 27648
 s_nop 0
 buffer_load_dwordx4 v2, s[8:11], s20 offen offset:0 lds
 v_mfma_f32_16x16x32_bf16 v[104:107], a[16:19], a[64:67], 0
 buffer_load_dwordx4 v2, s[8:11], s20 offen offset:1024 lds
 buffer_load_dwordx4 v2, s[8:11], s20 offen offset:2048 lds
 v_mfma_f32_16x16x32_bf16 v[132:135], a[16:19], a[68:71], 0
 s_add_u32 s21, s21, 128
 s_add_u32 s27, s27, 128
 v_mfma_f32_16x16x32_bf16 v[52:55], a[20:23], a[56:59], 0
 s_add_u32 m0, s22, 0
 s_nop 0
 buffer_load_dwordx4 v3, s[12:15], s21 offen offset:0 lds
 v_mfma_f32_16x16x32_bf16 v[80:83], a[20:23], a[60:63], 0
 buffer_load_dwordx4 v4, s[12:15], s21 offen offset:1024 lds
 buffer_load_dwordx4 v5, s[12:15], s21 offen offset:2048 lds
 v_mfma_f32_16x16x32_bf16 v[108:111], a[20:23], a[64:67], 0
 buffer_load_dwordx4 v6, s[12:15], s21 offen offset:3072 lds
 s_add_u32 m0, s22, 4096
 v_mfma_f32_16x16x32_bf16 v[136:139], a[20:23], a[68:71], 0
 buffer_load_dwordx4 v3, s[12:15], s27 offen offset:0 lds
 buffer_load_dwordx4 v4, s[12:15], s27 offen offset:1024 lds
 v_mfma_f32_16x16x32_bf16 v[56:59], a[24:27], a[56:59], 0
 buffer_load_dwordx4 v5, s[12:15], s27 offen offset:2048 lds
 buffer_load_dwordx4 v6, s[12:15], s27 offen offset:3072 lds
 v_mfma_f32_16x16x32_bf16 v[84:87], a[24:27], a[60:63], 0
 v_mfma_f32_16x16x32_bf16 v[112:115], a[24:27], a[64:67], 0
 v_mfma_f32_16x16x32_bf16 v[140:143], a[24:27], a[68:71], 0
 s_waitcnt vmcnt(22)
 v_mfma_f32_16x16x32_bf16 v[32:35], a[28:31], a[72:75], v[32:35]
 ds_read_b128 a[56:59], v8 offset:8192
 ds_read_b64_tr_b16 a[0:1], v7 offset:30720
 v_mfma_f32_16x16x32_bf16 v[60:63], a[28:31], a[76:79], v[60:63]
 ds_read_b64_tr_b16 a[2:3], v7 offset:32512
 ds_read_b128 a[60:63], v9 offset:8192
 v_mfma_f32_16x16x32_bf16 v[88:91], a[28:31], a[80:83], v[88:91]
 ds_read_b64_tr_b16 a[4:5], v7 offset:30752
 ds_read_b64_tr_b16 a[6:7], v7 offset:32544
 v_mfma_f32_16x16x32_bf16 v[116:119], a[28:31], a[84:87], v[116:119]
 ds_read_b128 a[64:67], v10 offset:8192
 ds_read_b64_tr_b16 a[8:9], v7 offset:30784
 v_mfma_f32_16x16x32_bf16 v[36:39], a[32:35], a[72:75], v[36:39]
 ds_read_b64_tr_b16 a[10:11], v7 offset:32576
 ds_read_b128 a[68:71], v11 offset:8192
 v_mfma_f32_16x16x32_bf16 v[64:67], a[32:35], a[76:79], v[64:67]
 ds_read_b64_tr_b16 a[12:13], v7 offset:30816
 ds_read_b64_tr_b16 a[14:15], v7 offset:32608
 v_mfma_f32_16x16x32_bf16 v[92:95], a[32:35], a[80:83], v[92:95]
 ds_read_b64_tr_b16 a[16:17], v7 offset:30848
 ds_read_b64_tr_b16 a[18:19], v7 offset:32640
 v_mfma_f32_16x16x32_bf16 v[120:123], a[32:35], a[84:87], v[120:123]
 ds_read_b64_tr_b16 a[20:21], v7 offset:30880
 ds_read_b64_tr_b16 a[22:23], v7 offset:32672
 v_mfma_f32_16x16x32_bf16 v[40:43], a[36:39], a[72:75], v[40:43]
 ds_read_b64_tr_b16 a[24:25], v7 offset:30912
 ds_read_b64_tr_b16 a[26:27], v7 offset:32704
 v_mfma_f32_16x16x32_bf16 v[68:71], a[36:39], a[76:79], v[68:71]
 v_mfma_f32_16x16x32_bf16 v[96:99], a[36:39], a[80:83], v[96:99]
 v_mfma_f32_16x16x32_bf16 v[124:127], a[36:39], a[84:87], v[124:127]
 v_mfma_f32_16x16x32_bf16 v[44:47], a[40:43], a[72:75], v[44:47]
 v_mfma_f32_16x16x32_bf16 v[72:75], a[40:43], a[76:79], v[72:75]
 v_mfma_f32_16x16x32_bf16 v[100:103], a[40:43], a[80:83], v[100:103]
 s_waitcnt lgkmcnt(0)
 s_add_u32 s20, s20, 7168
 s_add_u32 m0, s22, 30720
 v_mfma_f32_16x16x32_bf16 v[128:131], a[40:43], a[84:87], v[128:131]
 buffer_load_dwordx4 v1, s[8:11], s20 offen offset:0 lds
 buffer_load_dwordx4 v1, s[8:11], s20 offen offset:1024 lds
 v_mfma_f32_16x16x32_bf16 v[48:51], a[44:47], a[72:75], v[48:51]
 buffer_load_dwordx4 v1, s[8:11], s20 offen offset:2048 lds
 buffer_load_dwordx4 v1, s[8:11], s20 offen offset:3072 lds
 v_mfma_f32_16x16x32_bf16 v[76:79], a[44:47], a[76:79], v[76:79]
 s_add_u32 m0, s22, 34816
 s_nop 0
 buffer_load_dwordx4 v2, s[8:11], s20 offen offset:0 lds
 v_mfma_f32_16x16x32_bf16 v[104:107], a[44:47], a[80:83], v[104:107]
 buffer_load_dwordx4 v2, s[8:11], s20 offen offset:1024 lds
 buffer_load_dwordx4 v2, s[8:11], s20 offen offset:2048 lds
 v_mfma_f32_16x16x32_bf16 v[132:135], a[44:47], a[84:87], v[132:135]
 v_mfma_f32_16x16x32_bf16 v[52:55], a[48:51], a[72:75], v[52:55]
 v_mfma_f32_16x16x32_bf16 v[80:83], a[48:51], a[76:79], v[80:83]
 v_mfma_f32_16x16x32_bf16 v[108:111], a[48:51], a[80:83], v[108:111]
 v_mfma_f32_16x16x32_bf16 v[136:139], a[48:51], a[84:87], v[136:139]
 v_mfma_f32_16x16x32_bf16 v[56:59], a[52:55], a[72:75], v[56:59]
 v_mfma_f32_16x16x32_bf16 v[84:87], a[52:55], a[76:79], v[84:87]
 v_mfma_f32_16x16x32_bf16 v[112:115], a[52:55], a[80:83], v[112:115]
 v_mfma_f32_16x16x32_bf16 v[140:143], a[52:55], a[84:87], v[140:143]
 s_waitcnt vmcnt(22)
 v_mfma_f32_16x16x32_bf16 v[32:35], a[0:3], a[56:59], v[32:35]
 ds_read_b128 a[72:75], v25 offset:8192
 ds_read_b64_tr_b16 a[28:29], v7 offset:16384
 v_mfma_f32_16x16x32_bf16 v[60:63], a[0:3], a[60:63], v[60:63]
 ds_read_b64_tr_b16 a[30:31], v7 offset:18176
 ds_read_b128 a[76:79], v26 offset:8192
 v_mfma_f32_16x16x32_bf16 v[88:91], a[0:3], a[64:67], v[88:91]
 ds_read_b64_tr_b16 a[32:33], v7 offset:16416
 ds_read_b64_tr_b16 a[34:35], v7 offset:18208
 v_mfma_f32_16x16x32_bf16 v[116:119], a[0:3], a[68:71], v[116:119]
 ds_read_b128 a[80:83], v27 offset:8192
 ds_read_b64_tr_b16 a[36:37], v7 offset:16448
 v_mfma_f32_16x16x32_bf16 v[36:39], a[4:7], a[56:59], v[36:39]
 ds_read_b64_tr_b16 a[38:39], v7 offset:18240
 ds_read_b128 a[84:87], v28 offset:8192
 v_mfma_f32_16x16x32_bf16 v[64:67], a[4:7], a[60:63], v[64:67]
 ds_read_b64_tr_b16 a[40:41], v7 offset:16480
 ds_read_b64_tr_b16 a[42:43], v7 offset:18272
 v_mfma_f32_16x16x32_bf16 v[92:95], a[4:7], a[64:67], v[92:95]
 ds_read_b64_tr_b16 a[44:45], v7 offset:16512
 ds_read_b64_tr_b16 a[46:47], v7 offset:18304
 v_mfma_f32_16x16x32_bf16 v[120:123], a[4:7], a[68:71], v[120:123]
 ds_read_b64_tr_b16 a[48:49], v7 offset:16544
 ds_read_b64_tr_b16 a[50:51], v7 offset:18336
 v_mfma_f32_16x16x32_bf16 v[40:43], a[8:11], a[56:59], v[40:43]
 ds_read_b64_tr_b16 a[52:53], v7 offset:16576
 ds_read_b64_tr_b16 a[54:55], v7 offset:18368
 v_mfma_f32_16x16x32_bf16 v[68:71], a[8:11], a[60:63], v[68:71]
 v_mfma_f32_16x16x32_bf16 v[96:99], a[8:11], a[64:67], v[96:99]
 v_mfma_f32_16x16x32_bf16 v[124:127], a[8:11], a[68:71], v[124:127]
 v_mfma_f32_16x16x32_bf16 v[44:47], a[12:15], a[56:59], v[44:47]
 v_mfma_f32_16x16x32_bf16 v[72:75], a[12:15], a[60:63], v[72:75]
 v_mfma_f32_16x16x32_bf16 v[100:103], a[12:15], a[64:67], v[100:103]
 s_waitcnt lgkmcnt(0)
 s_add_u32 s20, s20, 7168
 s_add_u32 m0, s22, 16384
 v_mfma_f32_16x16x32_bf16 v[128:131], a[12:15], a[68:71], v[128:131]
 buffer_load_dwordx4 v1, s[8:11], s20 offen offset:0 lds
 buffer_load_dwordx4 v1, s[8:11], s20 offen offset:1024 lds
 v_mfma_f32_16x16x32_bf16 v[48:51], a[16:19], a[56:59], v[48:51]
 buffer_load_dwordx4 v1, s[8:11], s20 offen offset:2048 lds
 buffer_load_dwordx4 v1, s[8:11], s20 offen offset:3072 lds
 v_mfma_f32_16x16x32_bf16 v[76:79], a[16:19], a[60:63], v[76:79]
 s_add_u32 m0, s22, 20480
 s_nop 0
 buffer_load_dwordx4 v2, s[8:11], s20 offen offset:0 lds
 v_mfma_f32_16x16x32_bf16 v[104:107], a[16:19], a[64:67], v[104:107]
 buffer_load_dwordx4 v2, s[8:11], s20 offen offset:1024 lds
 buffer_load_dwordx4 v2, s[8:11], s20 offen offset:2048 lds
 v_mfma_f32_16x16x32_bf16 v[132:135], a[16:19], a[68:71], v[132:135]
 s_add_u32 s21, s21, 128
 s_add_u32 s27, s27, 128
 v_mfma_f32_16x16x32_bf16 v[52:55], a[20:23], a[56:59], v[52:55]
 s_add_u32 m0, s22, 8192
 s_nop 0
 buffer_load_dwordx4 v3, s[12:15], s21 offen offset:0 lds
 v_mfma_f32_16x16x32_bf16 v[80:83], a[20:23], a[60:63], v[80:83]
 buffer_load_dwordx4 v4, s[12:15], s21 offen offset:1024 lds
 buffer_load_dwordx4 v5, s[12:15], s21 offen offset:2048 lds
 v_mfma_f32_16x16x32_bf16 v[108:111], a[20:23], a[64:67], v[108:111]
 buffer_load_dwordx4 v6, s[12:15], s21 offen offset:3072 lds
 s_add_u32 m0, s22, 12288
 v_mfma_f32_16x16x32_bf16 v[136:139], a[20:23], a[68:71], v[136:139]
 buffer_load_dwordx4 v3, s[12:15], s27 offen offset:0 lds
 buffer_load_dwordx4 v4, s[12:15], s27 offen offset:1024 lds
 v_mfma_f32_16x16x32_bf16 v[56:59], a[24:27], a[56:59], v[56:59]
 buffer_load_dwordx4 v5, s[12:15], s27 offen offset:2048 lds
 buffer_load_dwordx4 v6, s[12:15], s27 offen offset:3072 lds
 v_mfma_f32_16x16x32_bf16 v[84:87], a[24:27], a[60:63], v[84:87]
 v_mfma_f32_16x16x32_bf16 v[112:115], a[24:27], a[64:67], v[112:115]
 v_mfma_f32_16x16x32_bf16 v[140:143], a[24:27], a[68:71], v[140:143]
 s_waitcnt vmcnt(22)
 v_mfma_f32_16x16x32_bf16 v[32:35], a[28:31], a[72:75], v[32:35]
 ds_read_b128 a[56:59], v8 offset:0
 ds_read_b64_tr_b16 a[0:1], v7 offset:23552
 v_mfma_f32_16x16x32_bf16 v[60:63], a[28:31], a[76:79], v[60:63]
 ds_read_b64_tr_b16 a[2:3], v7 offset:25344
 ds_read_b128 a[60:63], v9 offset:0
 v_mfma_f32_16x16x32_bf16 v[88:91], a[28:31], a[80:83], v[88:91]
 ds_read_b64_tr_b16 a[4:5], v7 offset:23584
 ds_read_b64_tr_b16 a[6:7], v7 offset:25376
 v_mfma_f32_16x16x32_bf16 v[116:119], a[28:31], a[84:87], v[116:119]
 ds_read_b128 a[64:67], v10 offset:0
 ds_read_b64_tr_b16 a[8:9], v7 offset:23616
 v_mfma_f32_16x16x32_bf16 v[36:39], a[32:35], a[72:75], v[36:39]
 ds_read_b64_tr_b16 a[10:11], v7 offset:25408
 ds_read_b128 a[68:71], v11 offset:0
 v_mfma_f32_16x16x32_bf16 v[64:67], a[32:35], a[76:79], v[64:67]
 ds_read_b64_tr_b16 a[12:13], v7 offset:23648
 ds_read_b64_tr_b16 a[14:15], v7 offset:25440
 v_mfma_f32_16x16x32_bf16 v[92:95], a[32:35], a[80:83], v[92:95]
 ds_read_b64_tr_b16 a[16:17], v7 offset:23680
 ds_read_b64_tr_b16 a[18:19], v7 offset:25472
 v_mfma_f32_16x16x32_bf16 v[120:123], a[32:35], a[84:87], v[120:123]
 ds_read_b64_tr_b16 a[20:21], v7 offset:23712
 ds_read_b64_tr_b16 a[22:23], v7 offset:25504
 v_mfma_f32_16x16x32_bf16 v[40:43], a[36:39], a[72:75], v[40:43]
 ds_read_b64_tr_b16 a[24:25], v7 offset:23744
 ds_read_b64_tr_b16 a[26:27], v7 offset:25536
 v_mfma_f32_16x16x32_bf16 v[68:71], a[36:39], a[76:79], v[68:71]
 v_mfma_f32_16x16x32_bf16 v[96:99], a[36:39], a[80:83], v[96:99]
 v_mfma_f32_16x16x32_bf16 v[124:127], a[36:39], a[84:87], v[124:127]
 v_mfma_f32_16x16x32_bf16 v[44:47], a[40:43], a[72:75], v[44:47]
 v_mfma_f32_16x16x32_bf16 v[72:75], a[40:43], a[76:79], v[72:75]
 v_mfma_f32_16x16x32_bf16 v[100:103], a[40:43], a[80:83], v[100:103]
 s_waitcnt lgkmcnt(0)
 s_add_u32 s20, s20, 7168
 s_add_u32 m0, s22, 23552
 v_mfma_f32_16x16x32_bf16 v[128:131], a[40:43], a[84:87], v[128:131]
 buffer_load_dwordx4 v1, s[8:11], s20 offen offset:0 lds
 buffer_load_dwordx4 v1, s[8:11], s20 offen offset:1024 lds
 v_mfma_f32_16x16x32_bf16 v[48:51], a[44:47], a[72:75], v[48:51]
 buffer_load_dwordx4 v1, s[8:11], s20 offen offset:2048 lds
 buffer_load_dwordx4 v1, s[8:11], s20 offen offset:3072 lds
 v_mfma_f32_16x16x32_bf16 v[76:79], a[44:47], a[76:79], v[76:79]
 s_add_u32 m0, s22, 27648
 s_nop 0
 buffer_load_dwordx4 v2, s[8:11], s20 offen offset:0 lds
 v_mfma_f32_16x16x32_bf16 v[104:107], a[44:47], a[80:83], v[104:107]
 buffer_load_dwordx4 v2, s[8:11], s20 offen offset:1024 lds
 buffer_load_dwordx4 v2, s[8:11], s20 offen offset:2048 lds
 v_mfma_f32_16x16x32_bf16 v[132:135], a[44:47], a[84:87], v[132:135]
 v_mfma_f32_16x16x32_bf16 v[52:55], a[48:51], a[72:75], v[52:55]
 v_mfma_f32_16x16x32_bf16 v[80:83], a[48:51], a[76:79], v[80:83]
 v_mfma_f32_16x16x32_bf16 v[108:111], a[48:51], a[80:83], v[108:111]
 v_mfma_f32_16x16x32_bf16 v[136:139], a[48:51], a[84:87], v[136:139]
 v_mfma_f32_16x16x32_bf16 v[56:59], a[52:55], a[72:75], v[56:59]
 v_mfma_f32_16x16x32_bf16 v[84:87], a[52:55], a[76:79], v[84:87]
 v_mfma_f32_16x16x32_bf16 v[112:115], a[52:55], a[80:83], v[112:115]
 v_mfma_f32_16x16x32_bf16 v[140:143], a[52:55], a[84:87], v[140:143]
 s_waitcnt vmcnt(22)
 v_mfma_f32_16x16x32_bf16 v[32:35], a[0:3], a[56:59], v[32:35]
 ds_read_b128 a[72:75], v25 offset:0
 ds_read_b64_tr_b16 a[28:29], v7 offset:30720
 v_mfma_f32_16x16x32_bf16 v[60:63], a[0:3], a[60:63], v[60:63]
 ds_read_b64_tr_b16 a[30:31], v7 offset:32512
 ds_read_b128 a[76:79], v26 offset:0
 v_mfma_f32_16x16x32_bf16 v[88:91], a[0:3], a[64:67], v[88:91]
 ds_read_b64_tr_b16 a[32:33], v7 offset:30752
 ds_read_b64_tr_b16 a[34:35], v7 offset:32544
 v_mfma_f32_16x16x32_bf16 v[116:119], a[0:3], a[68:71], v[116:119]
 ds_read_b128 a[80:83], v27 offset:0
 ds_read_b64_tr_b16 a[36:37], v7 offset:30784
 v_mfma_f32_16x16x32_bf16 v[36:39], a[4:7], a[56:59], v[36:39]
 ds_read_b64_tr_b16 a[38:39], v7 offset:32576
 ds_read_b128 a[84:87], v28 offset:0
 v_mfma_f32_16x16x32_bf16 v[64:67], a[4:7], a[60:63], v[64:67]
 ds_read_b64_tr_b16 a[40:41], v7 offset:30816
 ds_read_b64_tr_b16 a[42:43], v7 offset:32608
 v_mfma_f32_16x16x32_bf16 v[92:95], a[4:7], a[64:67], v[92:95]
 ds_read_b64_tr_b16 a[44:45], v7 offset:30848
 ds_read_b64_tr_b16 a[46:47], v7 offset:32640
 v_mfma_f32_16x16x32_bf16 v[120:123], a[4:7], a[68:71], v[120:123]
 ds_read_b64_tr_b16 a[48:49], v7 offset:30880
 ds_read_b64_tr_b16 a[50:51], v7 offset:32672
 v_mfma_f32_16x16x32_bf16 v[40:43], a[8:11], a[56:59], v[40:43]
 ds_read_b64_tr_b16 a[52:53], v7 offset:30912
 ds_read_b64_tr_b16 a[54:55], v7 offset:32704
 v_mfma_f32_16x16x32_bf16 v[68:71], a[8:11], a[60:63], v[68:71]
 v_mfma_f32_16x16x32_bf16 v[96:99], a[8:11], a[64:67], v[96:99]
 v_mfma_f32_16x16x32_bf16 v[124:127], a[8:11], a[68:71], v[124:127]
 v_mfma_f32_16x16x32_bf16 v[44:47], a[12:15], a[56:59], v[44:47]
 v_mfma_f32_16x16x32_bf16 v[72:75], a[12:15], a[60:63], v[72:75]
 v_mfma_f32_16x16x32_bf16 v[100:103], a[12:15], a[64:67], v[100:103]
 s_waitcnt lgkmcnt(0)
 s_add_u32 s20, s20, 7168
 s_add_u32 m0, s22, 30720
 v_mfma_f32_16x16x32_bf16 v[128:131], a[12:15], a[68:71], v[128:131]
 buffer_load_dwordx4 v1, s[8:11], s20 offen offset:0 lds
 buffer_load_dwordx4 v1, s[8:11], s20 offen offset:1024 lds
 v_mfma_f32_16x16x32_bf16 v[48:51], a[16:19], a[56:59], v[48:51]
 buffer_load_dwordx4 v1, s[8:11], s20 offen offset:2048 lds
 buffer_load_dwordx4 v1, s[8:11], s20 offen offset:3072 lds
 v_mfma_f32_16x16x32_bf16 v[76:79], a[16:19], a[60:63], v[76:79]
 s_add_u32 m0, s22, 34816
 s_nop 0
 buffer_load_dwordx4 v2, s[8:11], s20 offen offset:0 lds
 v_mfma_f32_16x16x32_bf16 v[104:107], a[16:19], a[64:67], v[104:107]
 buffer_load_dwordx4 v2, s[8:11], s20 offen offset:1024 lds
 buffer_load_dwordx4 v2, s[8:11], s20 offen offset:2048 lds
 v_mfma_f32_16x16x32_bf16 v[132:135], a[16:19], a[68:71], v[132:135]
 s_add_u32 s21, s21, 128
 s_add_u32 s27, s27, 128
 v_mfma_f32_16x16x32_bf16 v[52:55], a[20:23], a[56:59], v[52:55]
 s_add_u32 m0, s22, 0
 s_nop 0
 buffer_load_dwordx4 v3, s[12:15], s21 offen offset:0 lds
 v_mfma_f32_16x16x32_bf16 v[80:83], a[20:23], a[60:63], v[80:83]
 buffer_load_dwordx4 v4, s[12:15], s21 offen offset:1024 lds
 buffer_load_dwordx4 v5, s[12:15], s21 offen offset:2048 lds
 v_mfma_f32_16x16x32_bf16 v[108:111], a[20:23], a[64:67], v[108:111]
 buffer_load_dwordx4 v6, s[12:15], s21 offen offset:3072 lds
 s_add_u32 m0, s22, 4096
 v_mfma_f32_16x16x32_bf16 v[136:139], a[20:23], a[68:71], v[136:139]
 buffer_load_dwordx4 v3, s[12:15], s27 offen offset:0 lds
 buffer_load_dwordx4 v4, s[12:15], s27 offen offset:1024 lds
 v_mfma_f32_16x16x32_bf16 v[56:59], a[24:27], a[56:59], v[56:59]
 buffer_load_dwordx4 v5, s[12:15], s27 offen offset:2048 lds
 buffer_load_dwordx4 v6, s[12:15], s27 offen offset:3072 lds
 v_mfma_f32_16x16x32_bf16 v[84:87], a[24:27], a[60:63], v[84:87]
 v_mfma_f32_16x16x32_bf16 v[112:115], a[24:27], a[64:67], v[112:115]
 v_mfma_f32_16x16x32_bf16 v[140:143], a[24:27], a[68:71], v[140:143]
 s_waitcnt vmcnt(22)
 v_mfma_f32_16x16x32_bf16 v[32:35], a[28:31], a[72:75], v[32:35]
 ds_read_b128 a[56:59], v8 offset:8192
 ds_read_b64_tr_b16 a[0:1], v7 offset:16384
 v_mfma_f32_16x16x32_bf16 v[60:63], a[28:31], a[76:79], v[60:63]
 ds_read_b64_tr_b16 a[2:3], v7 offset:18176
 ds_read_b128 a[60:63], v9 offset:8192
 v_mfma_f32_16x16x32_bf16 v[88:91], a[28:31], a[80:83], v[88:91]
 ds_read_b64_tr_b16 a[4:5], v7 offset:16416
 ds_read_b64_tr_b16 a[6:7], v7 offset:18208
 v_mfma_f32_16x16x32_bf16 v[116:119], a[28:31], a[84:87], v[116:119]
 ds_read_b128 a[64:67], v10 offset:8192
 ds_read_b64_tr_b16 a[8:9], v7 offset:16448
 v_mfma_f32_16x16x32_bf16 v[36:39], a[32:35], a[72:75], v[36:39]
 ds_read_b64_tr_b16 a[10:11], v7 offset:18240
 ds_read_b128 a[68:71], v11 offset:8192
 v_mfma_f32_16x16x32_bf16 v[64:67], a[32:35], a[76:79], v[64:67]
 ds_read_b64_tr_b16 a[12:13], v7 offset:16480
 ds_read_b64_tr_b16 a[14:15], v7 offset:18272
 v_mfma_f32_16x16x32_bf16 v[92:95], a[32:35], a[80:83], v[92:95]
 ds_read_b64_tr_b16 a[16:17], v7 offset:16512
 ds_read_b64_tr_b16 a[18:19], v7 offset:18304
 v_mfma_f32_16x16x32_bf16 v[120:123], a[32:35], a[84:87], v[120:123]
 ds_read_b64_tr_b16 a[20:21], v7 offset:16544
 ds_read_b64_tr_b16 a[22:23], v7 offset:18336
 v_mfma_f32_16x16x32_bf16 v[40:43], a[36:39], a[72:75], v[40:43]
 ds_read_b64_tr_b16 a[24:25], v7 offset:16576
 ds_read_b64_tr_b16 a[26:27], v7 offset:18368
 v_mfma_f32_16x16x32_bf16 v[68:71], a[36:39], a[76:79], v[68:71]
 v_mfma_f32_16x16x32_bf16 v[96:99], a[36:39], a[80:83], v[96:99]
 v_mfma_f32_16x16x32_bf16 v[124:127], a[36:39], a[84:87], v[124:127]
 v_mfma_f32_16x16x32_bf16 v[44:47], a[40:43], a[72:75], v[44:47]
 v_mfma_f32_16x16x32_bf16 v[72:75], a[40:43], a[76:79], v[72:75]
 v_mfma_f32_16x16x32_bf16 v[100:103], a[40:43], a[80:83], v[100:103]
 s_waitcnt lgkmcnt(0)
 s_add_u32 s20, s20, 7168
 s_add_u32 m0, s22, 16384
 v_mfma_f32_16x16x32_bf16 v[128:131], a[40:43], a[84:87], v[128:131]
 buffer_load_dwordx4 v1, s[8:11], s20 offen offset:0 lds
 buffer_load_dwordx4 v1, s[8:11], s20 offen offset:1024 lds
 v_mfma_f32_16x16x32_bf16 v[48:51], a[44:47], a[72:75], v[48:51]
 buffer_load_dwordx4 v1, s[8:11], s20 offen offset:2048 lds
 buffer_load_dwordx4 v1, s[8:11], s20 offen offset:3072 lds
 v_mfma_f32_16x16x32_bf16 v[76:79], a[44:47], a[76:79], v[76:79]
 s_add_u32 m0, s22, 20480
 s_nop 0
 buffer_load_dwordx4 v2, s[8:11], s20 offen offset:0 lds
 v_mfma_f32_16x16x32_bf16 v[104:107], a[44:47], a[80:83], v[104:107]
 buffer_load_dwordx4 v2, s[8:11], s20 offen offset:1024 lds
 buffer_load_dwordx4 v2, s[8:11], s20 offen offset:2048 lds
 v_mfma_f32_16x16x32_bf16 v[132:135], a[44:47], a[84:87], v[132:135]
 v_mfma_f32_16x16x32_bf16 v[52:55], a[48:51], a[72:75], v[52:55]
 v_mfma_f32_16x16x32_bf16 v[80:83], a[48:51], a[76:79], v[80:83]
 v_mfma_f32_16x16x32_bf16 v[108:111], a[48:51], a[80:83], v[108:111]
 v_mfma_f32_16x16x32_bf16 v[136:139], a[48:51], a[84:87], v[136:139]
 v_mfma_f32_16x16x32_bf16 v[56:59], a[52:55], a[72:75], v[56:59]
 v_mfma_f32_16x16x32_bf16 v[84:87], a[52:55], a[76:79], v[84:87]
 v_mfma_f32_16x16x32_bf16 v[112:115], a[52:55], a[80:83], v[112:115]
 v_mfma_f32_16x16x32_bf16 v[140:143], a[52:55], a[84:87], v[140:143]
 s_waitcnt vmcnt(22)
 v_mfma_f32_16x16x32_bf16 v[32:35], a[0:3], a[56:59], v[32:35]
 ds_read_b128 a[72:75], v25 offset:8192
 ds_read_b64_tr_b16 a[28:29], v7 offset:23552
 v_mfma_f32_16x16x32_bf16 v[60:63], a[0:3], a[60:63], v[60:63]
 ds_read_b64_tr_b16 a[30:31], v7 offset:25344
 ds_read_b128 a[76:79], v26 offset:8192
 v_mfma_f32_16x16x32_bf16 v[88:91], a[0:3], a[64:67], v[88:91]
 ds_read_b64_tr_b16 a[32:33], v7 offset:23584
 ds_read_b64_tr_b16 a[34:35], v7 offset:25376
 v_mfma_f32_16x16x32_bf16 v[116:119], a[0:3], a[68:71], v[116:119]
 ds_read_b128 a[80:83], v27 offset:8192
 ds_read_b64_tr_b16 a[36:37], v7 offset:23616
 v_mfma_f32_16x16x32_bf16 v[36:39], a[4:7], a[56:59], v[36:39]
 ds_read_b64_tr_b16 a[38:39], v7 offset:25408
 ds_read_b128 a[84:87], v28 offset:8192
 v_mfma_f32_16x16x32_bf16 v[64:67], a[4:7], a[60:63], v[64:67]
 ds_read_b64_tr_b16 a[40:41], v7 offset:23648
 ds_read_b64_tr_b16 a[42:43], v7 offset:25440
 v_mfma_f32_16x16x32_bf16 v[92:95], a[4:7], a[64:67], v[92:95]
 ds_read_b64_tr_b16 a[44:45], v7 offset:23680
 ds_read_b64_tr_b16 a[46:47], v7 offset:25472
 v_mfma_f32_16x16x32_bf16 v[120:123], a[4:7], a[68:71], v[120:123]
 ds_read_b64_tr_b16 a[48:49], v7 offset:23712
 ds_read_b64_tr_b16 a[50:51], v7 offset:25504
 v_mfma_f32_16x16x32_bf16 v[40:43], a[8:11], a[56:59], v[40:43]
 ds_read_b64_tr_b16 a[52:53], v7 offset:23744
 ds_read_b64_tr_b16 a[54:55], v7 offset:25536
 v_mfma_f32_16x16x32_bf16 v[68:71], a[8:11], a[60:63], v[68:71]
 v_mfma_f32_16x16x32_bf16 v[96:99], a[8:11], a[64:67], v[96:99]
 v_mfma_f32_16x16x32_bf16 v[124:127], a[8:11], a[68:71], v[124:127]
 v_mfma_f32_16x16x32_bf16 v[44:47], a[12:15], a[56:59], v[44:47]
 v_mfma_f32_16x16x32_bf16 v[72:75], a[12:15], a[60:63], v[72:75]
 v_mfma_f32_16x16x32_bf16 v[100:103], a[12:15], a[64:67], v[100:103]
 s_waitcnt lgkmcnt(0)
 s_add_u32 s20, s20, 7168
 s_add_u32 m0, s22, 23552
 v_mfma_f32_16x16x32_bf16 v[128:131], a[12:15], a[68:71], v[128:131]
 buffer_load_dwordx4 v1, s[8:11], s20 offen offset:0 lds
 buffer_load_dwordx4 v1, s[8:11], s20 offen offset:1024 lds
 v_mfma_f32_16x16x32_bf16 v[48:51], a[16:19], a[56:59], v[48:51]
 buffer_load_dwordx4 v1, s[8:11], s20 offen offset:2048 lds
 buffer_load_dwordx4 v1, s[8:11], s20 offen offset:3072 lds
 v_mfma_f32_16x16x32_bf16 v[76:79], a[16:19], a[60:63], v[76:79]
 s_add_u32 m0, s22, 27648
 s_nop 0
 buffer_load_dwordx4 v2, s[8:11], s20 offen offset:0 lds
 v_mfma_f32_16x16x32_bf16 v[104:107], a[16:19], a[64:67], v[104:107]
 buffer_load_dwordx4 v2, s[8:11], s20 offen offset:1024 lds
 buffer_load_dwordx4 v2, s[8:11], s20 offen offset:2048 lds
 v_mfma_f32_16x16x32_bf16 v[132:135], a[16:19], a[68:71], v[132:135]
 s_add_u32 s21, s21, 128
 s_add_u32 s27, s27, 128
 v_mfma_f32_16x16x32_bf16 v[52:55], a[20:23], a[56:59], v[52:55]
 s_add_u32 m0, s22, 8192
 s_nop 0
 buffer_load_dwordx4 v3, s[12:15], s21 offen offset:0 lds
 v_mfma_f32_16x16x32_bf16 v[80:83], a[20:23], a[60:63], v[80:83]
 buffer_load_dwordx4 v4, s[12:15], s21 offen offset:1024 lds
 buffer_load_dwordx4 v5, s[12:15], s21 offen offset:2048 lds
 v_mfma_f32_16x16x32_bf16 v[108:111], a[20:23], a[64:67], v[108:111]
 buffer_load_dwordx4 v6, s[12:15], s21 offen offset:3072 lds
 s_add_u32 m0, s22, 12288
 v_mfma_f32_16x16x32_bf16 v[136:139], a[20:23], a[68:71], v[136:139]
 buffer_load_dwordx4 v3, s[12:15], s27 offen offset:0 lds
 buffer_load_dwordx4 v4, s[12:15], s27 offen offset:1024 lds
 v_mfma_f32_16x16x32_bf16 v[56:59], a[24:27], a[56:59], v[56:59]
 buffer_load_dwordx4 v5, s[12:15], s27 offen offset:2048 lds
 buffer_load_dwordx4 v6, s[12:15], s27 offen offset:3072 lds
 v_mfma_f32_16x16x32_bf16 v[84:87], a[24:27], a[60:63], v[84:87]
 v_mfma_f32_16x16x32_bf16 v[112:115], a[24:27], a[64:67], v[112:115]
 v_mfma_f32_16x16x32_bf16 v[140:143], a[24:27], a[68:71], v[140:143]
 s_waitcnt vmcnt(22)
 v_mfma_f32_16x16x32_bf16 v[32:35], a[28:31], a[72:75], v[32:35]
 ds_read_b128 a[56:59], v8 offset:0
 ds_read_b64_tr_b16 a[0:1], v7 offset:30720
 v_mfma_f32_16x16x32_bf16 v[60:63], a[28:31], a[76:79], v[60:63]
 ds_read_b64_tr_b16 a[2:3], v7 offset:32512
 ds_read_b128 a[60:63], v9 offset:0
 v_mfma_f32_16x16x32_bf16 v[88:91], a[28:31], a[80:83], v[88:91]
 ds_read_b64_tr_b16 a[4:5], v7 offset:30752
 ds_read_b64_tr_b16 a[6:7], v7 offset:32544
 v_mfma_f32_16x16x32_bf16 v[116:119], a[28:31], a[84:87], v[116:119]
 ds_read_b128 a[64:67], v10 offset:0
 ds_read_b64_tr_b16 a[8:9], v7 offset:30784
 v_mfma_f32_16x16x32_bf16 v[36:39], a[32:35], a[72:75], v[36:39]
 ds_read_b64_tr_b16 a[10:11], v7 offset:32576
 ds_read_b128 a[68:71], v11 offset:0
 v_mfma_f32_16x16x32_bf16 v[64:67], a[32:35], a[76:79], v[64:67]
 ds_read_b64_tr_b16 a[12:13], v7 offset:30816
 ds_read_b64_tr_b16 a[14:15], v7 offset:32608
 v_mfma_f32_16x16x32_bf16 v[92:95], a[32:35], a[80:83], v[92:95]
 ds_read_b64_tr_b16 a[16:17], v7 offset:30848
 ds_read_b64_tr_b16 a[18:19], v7 offset:32640
 v_mfma_f32_16x16x32_bf16 v[120:123], a[32:35], a[84:87], v[120:123]
 ds_read_b64_tr_b16 a[20:21], v7 offset:30880
 ds_read_b64_tr_b16 a[22:23], v7 offset:32672
 v_mfma_f32_16x16x32_bf16 v[40:43], a[36:39], a[72:75], v[40:43]
 ds_read_b64_tr_b16 a[24:25], v7 offset:30912
 ds_read_b64_tr_b16 a[26:27], v7 offset:32704
 v_mfma_f32_16x16x32_bf16 v[68:71], a[36:39], a[76:79], v[68:71]
 v_mfma_f32_16x16x32_bf16 v[96:99], a[36:39], a[80:83], v[96:99]
 v_mfma_f32_16x16x32_bf16 v[124:127], a[36:39], a[84:87], v[124:127]
 v_mfma_f32_16x16x32_bf16 v[44:47], a[40:43], a[72:75], v[44:47]
 v_mfma_f32_16x16x32_bf16 v[72:75], a[40:43], a[76:79], v[72:75]
 v_mfma_f32_16x16x32_bf16 v[100:103], a[40:43], a[80:83], v[100:103]
 s_waitcnt lgkmcnt(0)
 s_add_u32 s20, s20, 7168
 s_add_u32 m0, s22, 30720
 v_mfma_f32_16x16x32_bf16 v[128:131], a[40:43], a[84:87], v[128:131]
 buffer_load_dwordx4 v1, s[8:11], s20 offen offset:0 lds
 buffer_load_dwordx4 v1, s[8:11], s20 offen offset:1024 lds
 v_mfma_f32_16x16x32_bf16 v[48:51], a[44:47], a[72:75], v[48:51]
 buffer_load_dwordx4 v1, s[8:11], s20 offen offset:2048 lds
 buffer_load_dwordx4 v1, s[8:11], s20 offen offset:3072 lds
 v_mfma_f32_16x16x32_bf16 v[76:79], a[44:47], a[76:79], v[76:79]
 s_add_u32 m0, s22, 34816
 s_nop 0
 buffer_load_dwordx4 v2, s[8:11], s20 offen offset:0 lds
 v_mfma_f32_16x16x32_bf16 v[104:107], a[44:47], a[80:83], v[104:107]
 buffer_load_dwordx4 v2, s[8:11], s20 offen offset:1024 lds
 buffer_load_dwordx4 v2, s[8:11], s20 offen offset:2048 lds
 v_mfma_f32_16x16x32_bf16 v[132:135], a[44:47], a[84:87], v[132:135]
 v_mfma_f32_16x16x32_bf16 v[52:55], a[48:51], a[72:75], v[52:55]
 v_mfma_f32_16x16x32_bf16 v[80:83], a[48:51], a[76:79], v[80:83]
 v_mfma_f32_16x16x32_bf16 v[108:111], a[48:51], a[80:83], v[108:111]
 v_mfma_f32_16x16x32_bf16 v[136:139], a[48:51], a[84:87], v[136:139]
 v_mfma_f32_16x16x32_bf16 v[56:59], a[52:55], a[72:75], v[56:59]
 v_mfma_f32_16x16x32_bf16 v[84:87], a[52:55], a[76:79], v[84:87]
 v_mfma_f32_16x16x32_bf16 v[112:115], a[52:55], a[80:83], v[112:115]
 v_mfma_f32_16x16x32_bf16 v[140:143], a[52:55], a[84:87], v[140:143]
 s_waitcnt vmcnt(22)
 v_mfma_f32_16x16x32_bf16 v[32:35], a[0:3], a[56:59], v[32:35]
 ds_read_b128 a[72:75], v25 offset:0
 ds_read_b64_tr_b16 a[28:29], v7 offset:16384
 v_mfma_f32_16x16x32_bf16 v[60:63], a[0:3], a[60:63], v[60:63]
 ds_read_b64_tr_b16 a[30:31], v7 offset:18176
 ds_read_b128 a[76:79], v26 offset:0
 v_mfma_f32_16x16x32_bf16 v[88:91], a[0:3], a[64:67], v[88:91]
 ds_read_b64_tr_b16 a[32:33], v7 offset:16416
 ds_read_b64_tr_b16 a[34:35], v7 offset:18208
 v_mfma_f32_16x16x32_bf16 v[116:119], a[0:3], a[68:71], v[116:119]
 ds_read_b128 a[80:83], v27 offset:0
 ds_read_b64_tr_b16 a[36:37], v7 offset:16448
 v_mfma_f32_16x16x32_bf16 v[36:39], a[4:7], a[56:59], v[36:39]
 ds_read_b64_tr_b16 a[38:39], v7 offset:18240
 ds_read_b128 a[84:87], v28 offset:0
 v_mfma_f32_16x16x32_bf16 v[64:67], a[4:7], a[60:63], v[64:67]
 ds_read_b64_tr_b16 a[40:41], v7 offset:16480
 ds_read_b64_tr_b16 a[42:43], v7 offset:18272
 v_mfma_f32_16x16x32_bf16 v[92:95], a[4:7], a[64:67], v[92:95]
 ds_read_b64_tr_b16 a[44:45], v7 offset:16512
 ds_read_b64_tr_b16 a[46:47], v7 offset:18304
 v_mfma_f32_16x16x32_bf16 v[120:123], a[4:7], a[68:71], v[120:123]
 ds_read_b64_tr_b16 a[48:49], v7 offset:16544
 ds_read_b64_tr_b16 a[50:51], v7 offset:18336
 v_mfma_f32_16x16x32_bf16 v[40:43], a[8:11], a[56:59], v[40:43]
 ds_read_b64_tr_b16 a[52:53], v7 offset:16576
 ds_read_b64_tr_b16 a[54:55], v7 offset:18368
 v_mfma_f32_16x16x32_bf16 v[68:71], a[8:11], a[60:63], v[68:71]
 v_mfma_f32_16x16x32_bf16 v[96:99], a[8:11], a[64:67], v[96:99]
 v_mfma_f32_16x16x32_bf16 v[124:127], a[8:11], a[68:71], v[124:127]
 v_mfma_f32_16x16x32_bf16 v[44:47], a[12:15], a[56:59], v[44:47]
 v_mfma_f32_16x16x32_bf16 v[72:75], a[12:15], a[60:63], v[72:75]
 v_mfma_f32_16x16x32_bf16 v[100:103], a[12:15], a[64:67], v[100:103]
 s_waitcnt lgkmcnt(0)
 s_add_u32 s20, s20, 7168
 s_add_u32 m0, s22, 16384
 v_mfma_f32_16x16x32_bf16 v[128:131], a[12:15], a[68:71], v[128:131]
 buffer_load_dwordx4 v1, s[8:11], s20 offen offset:0 lds
 buffer_load_dwordx4 v1, s[8:11], s20 offen offset:1024 lds
 v_mfma_f32_16x16x32_bf16 v[48:51], a[16:19], a[56:59], v[48:51]
 buffer_load_dwordx4 v1, s[8:11], s20 offen offset:2048 lds
 buffer_load_dwordx4 v1, s[8:11], s20 offen offset:3072 lds
 v_mfma_f32_16x16x32_bf16 v[76:79], a[16:19], a[60:63], v[76:79]
 s_add_u32 m0, s22, 20480
 s_nop 0
 buffer_load_dwordx4 v2, s[8:11], s20 offen offset:0 lds
 v_mfma_f32_16x16x32_bf16 v[104:107], a[16:19], a[64:67], v[104:107]
 buffer_load_dwordx4 v2, s[8:11], s20 offen offset:1024 lds
 buffer_load_dwordx4 v2, s[8:11], s20 offen offset:2048 lds
 v_mfma_f32_16x16x32_bf16 v[132:135], a[16:19], a[68:71], v[132:135]
 s_add_u32 s21, s21, 128
 s_add_u32 s27, s27, 128
 v_mfma_f32_16x16x32_bf16 v[52:55], a[20:23], a[56:59], v[52:55]
 s_add_u32 m0, s22, 0
 s_nop 0
 buffer_load_dwordx4 v3, s[12:15], s21 offen offset:0 lds
 v_mfma_f32_16x16x32_bf16 v[80:83], a[20:23], a[60:63], v[80:83]
 buffer_load_dwordx4 v4, s[12:15], s21 offen offset:1024 lds
 buffer_load_dwordx4 v5, s[12:15], s21 offen offset:2048 lds
 v_mfma_f32_16x16x32_bf16 v[108:111], a[20:23], a[64:67], v[108:111]
 buffer_load_dwordx4 v6, s[12:15], s21 offen offset:3072 lds
 s_add_u32 m0, s22, 4096
 v_mfma_f32_16x16x32_bf16 v[136:139], a[20:23], a[68:71], v[136:139]
 buffer_load_dwordx4 v3, s[12:15], s27 offen offset:0 lds
 buffer_load_dwordx4 v4, s[12:15], s27 offen offset:1024 lds
 v_mfma_f32_16x16x32_bf16 v[56:59], a[24:27], a[56:59], v[56:59]
 buffer_load_dwordx4 v5, s[12:15], s27 offen offset:2048 lds
 buffer_load_dwordx4 v6, s[12:15], s27 offen offset:3072 lds
 v_mfma_f32_16x16x32_bf16 v[84:87], a[24:27], a[60:63], v[84:87]
 v_mfma_f32_16x16x32_bf16 v[112:115], a[24:27], a[64:67], v[112:115]
 v_mfma_f32_16x16x32_bf16 v[140:143], a[24:27], a[68:71], v[140:143]
 s_waitcnt vmcnt(22)
 v_mfma_f32_16x16x32_bf16 v[32:35], a[28:31], a[72:75], v[32:35]
 ds_read_b128 a[56:59], v8 offset:8192
 ds_read_b64_tr_b16 a[0:1], v7 offset:23552
 v_mfma_f32_16x16x32_bf16 v[60:63], a[28:31], a[76:79], v[60:63]
 ds_read_b64_tr_b16 a[2:3], v7 offset:25344
 ds_read_b128 a[60:63], v9 offset:8192
 v_mfma_f32_16x16x32_bf16 v[88:91], a[28:31], a[80:83], v[88:91]
 ds_read_b64_tr_b16 a[4:5], v7 offset:23584
 ds_read_b64_tr_b16 a[6:7], v7 offset:25376
 v_mfma_f32_16x16x32_bf16 v[116:119], a[28:31], a[84:87], v[116:119]
 ds_read_b128 a[64:67], v10 offset:8192
 ds_read_b64_tr_b16 a[8:9], v7 offset:23616
 v_mfma_f32_16x16x32_bf16 v[36:39], a[32:35], a[72:75], v[36:39]
 ds_read_b64_tr_b16 a[10:11], v7 offset:25408
 ds_read_b128 a[68:71], v11 offset:8192
 v_mfma_f32_16x16x32_bf16 v[64:67], a[32:35], a[76:79], v[64:67]
 ds_read_b64_tr_b16 a[12:13], v7 offset:23648
 ds_read_b64_tr_b16 a[14:15], v7 offset:25440
 v_mfma_f32_16x16x32_bf16 v[92:95], a[32:35], a[80:83], v[92:95]
 ds_read_b64_tr_b16 a[16:17], v7 offset:23680
 ds_read_b64_tr_b16 a[18:19], v7 offset:25472
 v_mfma_f32_16x16x32_bf16 v[120:123], a[32:35], a[84:87], v[120:123]
 ds_read_b64_tr_b16 a[20:21], v7 offset:23712
 ds_read_b64_tr_b16 a[22:23], v7 offset:25504
 v_mfma_f32_16x16x32_bf16 v[40:43], a[36:39], a[72:75], v[40:43]
 ds_read_b64_tr_b16 a[24:25], v7 offset:23744
 ds_read_b64_tr_b16 a[26:27], v7 offset:25536
 v_mfma_f32_16x16x32_bf16 v[68:71], a[36:39], a[76:79], v[68:71]
 v_mfma_f32_16x16x32_bf16 v[96:99], a[36:39], a[80:83], v[96:99]
 v_mfma_f32_16x16x32_bf16 v[124:127], a[36:39], a[84:87], v[124:127]
 v_mfma_f32_16x16x32_bf16 v[44:47], a[40:43], a[72:75], v[44:47]
 v_mfma_f32_16x16x32_bf16 v[72:75], a[40:43], a[76:79], v[72:75]
 v_mfma_f32_16x16x32_bf16 v[100:103], a[40:43], a[80:83], v[100:103]
 s_waitcnt lgkmcnt(0)
 s_add_u32 s20, s20, 7168
 s_add_u32 m0, s22, 23552
 v_mfma_f32_16x16x32_bf16 v[128:131], a[40:43], a[84:87], v[128:131]
 buffer_load_dwordx4 v1, s[8:11], s20 offen offset:0 lds
 buffer_load_dwordx4 v1, s[8:11], s20 offen offset:1024 lds
 v_mfma_f32_16x16x32_bf16 v[48:51], a[44:47], a[72:75], v[48:51]
 buffer_load_dwordx4 v1, s[8:11], s20 offen offset:2048 lds
 buffer_load_dwordx4 v1, s[8:11], s20 offen offset:3072 lds
 v_mfma_f32_16x16x32_bf16 v[76:79], a[44:47], a[76:79], v[76:79]
 s_add_u32 m0, s22, 27648
 s_nop 0
 buffer_load_dwordx4 v2, s[8:11], s20 offen offset:0 lds
 v_mfma_f32_16x16x32_bf16 v[104:107], a[44:47], a[80:83], v[104:107]
 buffer_load_dwordx4 v2, s[8:11], s20 offen offset:1024 lds
 buffer_load_dwordx4 v2, s[8:11], s20 offen offset:2048 lds
 v_mfma_f32_16x16x32_bf16 v[132:135], a[44:47], a[84:87], v[132:135]
 v_mfma_f32_16x16x32_bf16 v[52:55], a[48:51], a[72:75], v[52:55]
 v_mfma_f32_16x16x32_bf16 v[80:83], a[48:51], a[76:79], v[80:83]
 v_mfma_f32_16x16x32_bf16 v[108:111], a[48:51], a[80:83], v[108:111]
 v_mfma_f32_16x16x32_bf16 v[136:139], a[48:51], a[84:87], v[136:139]
 v_mfma_f32_16x16x32_bf16 v[56:59], a[52:55], a[72:75], v[56:59]
 v_mfma_f32_16x16x32_bf16 v[84:87], a[52:55], a[76:79], v[84:87]
 v_mfma_f32_16x16x32_bf16 v[112:115], a[52:55], a[80:83], v[112:115]
 v_mfma_f32_16x16x32_bf16 v[140:143], a[52:55], a[84:87], v[140:143]
 s_waitcnt vmcnt(22)
 v_mfma_f32_16x16x32_bf16 v[32:35], a[0:3], a[56:59], v[32:35]
 ds_read_b128 a[72:75], v25 offset:8192
 ds_read_b64_tr_b16 a[28:29], v7 offset:30720
 v_mfma_f32_16x16x32_bf16 v[60:63], a[0:3], a[60:63], v[60:63]
 ds_read_b64_tr_b16 a[30:31], v7 offset:32512
 ds_read_b128 a[76:79], v26 offset:8192
 v_mfma_f32_16x16x32_bf16 v[88:91], a[0:3], a[64:67], v[88:91]
 ds_read_b64_tr_b16 a[32:33], v7 offset:30752
 ds_read_b64_tr_b16 a[34:35], v7 offset:32544
 v_mfma_f32_16x16x32_bf16 v[116:119], a[0:3], a[68:71], v[116:119]
 ds_read_b128 a[80:83], v27 offset:8192
 ds_read_b64_tr_b16 a[36:37], v7 offset:30784
 v_mfma_f32_16x16x32_bf16 v[36:39], a[4:7], a[56:59], v[36:39]
 ds_read_b64_tr_b16 a[38:39], v7 offset:32576
 ds_read_b128 a[84:87], v28 offset:8192
 v_mfma_f32_16x16x32_bf16 v[64:67], a[4:7], a[60:63], v[64:67]
 ds_read_b64_tr_b16 a[40:41], v7 offset:30816
 ds_read_b64_tr_b16 a[42:43], v7 offset:32608
 v_mfma_f32_16x16x32_bf16 v[92:95], a[4:7], a[64:67], v[92:95]
 ds_read_b64_tr_b16 a[44:45], v7 offset:30848
 ds_read_b64_tr_b16 a[46:47], v7 offset:32640
 v_mfma_f32_16x16x32_bf16 v[120:123], a[4:7], a[68:71], v[120:123]
 ds_read_b64_tr_b16 a[48:49], v7 offset:30880
 ds_read_b64_tr_b16 a[50:51], v7 offset:32672
 v_mfma_f32_16x16x32_bf16 v[40:43], a[8:11], a[56:59], v[40:43]
 ds_read_b64_tr_b16 a[52:53], v7 offset:30912
 ds_read_b64_tr_b16 a[54:55], v7 offset:32704
 v_mfma_f32_16x16x32_bf16 v[68:71], a[8:11], a[60:63], v[68:71]
 v_mfma_f32_16x16x32_bf16 v[96:99], a[8:11], a[64:67], v[96:99]
 v_mfma_f32_16x16x32_bf16 v[124:127], a[8:11], a[68:71], v[124:127]
 v_mfma_f32_16x16x32_bf16 v[44:47], a[12:15], a[56:59], v[44:47]
 v_mfma_f32_16x16x32_bf16 v[72:75], a[12:15], a[60:63], v[72:75]
 v_mfma_f32_16x16x32_bf16 v[100:103], a[12:15], a[64:67], v[100:103]
 s_waitcnt lgkmcnt(0)
 s_add_u32 s20, s20, 7168
 s_add_u32 m0, s22, 30720
 v_mfma_f32_16x16x32_bf16 v[128:131], a[12:15], a[68:71], v[128:131]
 buffer_load_dwordx4 v1, s[8:11], s20 offen offset:0 lds
 buffer_load_dwordx4 v1, s[8:11], s20 offen offset:1024 lds
 v_mfma_f32_16x16x32_bf16 v[48:51], a[16:19], a[56:59], v[48:51]
 buffer_load_dwordx4 v1, s[8:11], s20 offen offset:2048 lds
 buffer_load_dwordx4 v1, s[8:11], s20 offen offset:3072 lds
 v_mfma_f32_16x16x32_bf16 v[76:79], a[16:19], a[60:63], v[76:79]
 s_add_u32 m0, s22, 34816
 s_nop 0
 buffer_load_dwordx4 v2, s[8:11], s20 offen offset:0 lds
 v_mfma_f32_16x16x32_bf16 v[104:107], a[16:19], a[64:67], v[104:107]
 buffer_load_dwordx4 v2, s[8:11], s20 offen offset:1024 lds
 buffer_load_dwordx4 v2, s[8:11], s20 offen offset:2048 lds
 v_mfma_f32_16x16x32_bf16 v[132:135], a[16:19], a[68:71], v[132:135]
 s_add_u32 s21, s21, 128
 s_add_u32 s27, s27, 128
 v_mfma_f32_16x16x32_bf16 v[52:55], a[20:23], a[56:59], v[52:55]
 s_add_u32 m0, s22, 8192
 s_nop 0
 buffer_load_dwordx4 v3, s[12:15], s21 offen offset:0 lds
 v_mfma_f32_16x16x32_bf16 v[80:83], a[20:23], a[60:63], v[80:83]
 buffer_load_dwordx4 v4, s[12:15], s21 offen offset:1024 lds
 buffer_load_dwordx4 v5, s[12:15], s21 offen offset:2048 lds
 v_mfma_f32_16x16x32_bf16 v[108:111], a[20:23], a[64:67], v[108:111]
 buffer_load_dwordx4 v6, s[12:15], s21 offen offset:3072 lds
 s_add_u32 m0, s22, 12288
 v_mfma_f32_16x16x32_bf16 v[136:139], a[20:23], a[68:71], v[136:139]
 buffer_load_dwordx4 v3, s[12:15], s27 offen offset:0 lds
 buffer_load_dwordx4 v4, s[12:15], s27 offen offset:1024 lds
 v_mfma_f32_16x16x32_bf16 v[56:59], a[24:27], a[56:59], v[56:59]
 buffer_load_dwordx4 v5, s[12:15], s27 offen offset:2048 lds
 buffer_load_dwordx4 v6, s[12:15], s27 offen offset:3072 lds
 v_mfma_f32_16x16x32_bf16 v[84:87], a[24:27], a[60:63], v[84:87]
 v_mfma_f32_16x16x32_bf16 v[112:115], a[24:27], a[64:67], v[112:115]
 v_mfma_f32_16x16x32_bf16 v[140:143], a[24:27], a[68:71], v[140:143]
 s_waitcnt vmcnt(22)
 v_mfma_f32_16x16x32_bf16 v[32:35], a[28:31], a[72:75], v[32:35]
 ds_read_b128 a[56:59], v8 offset:0
 ds_read_b64_tr_b16 a[0:1], v7 offset:16384
 v_mfma_f32_16x16x32_bf16 v[60:63], a[28:31], a[76:79], v[60:63]
 ds_read_b64_tr_b16 a[2:3], v7 offset:18176
 ds_read_b128 a[60:63], v9 offset:0
 v_mfma_f32_16x16x32_bf16 v[88:91], a[28:31], a[80:83], v[88:91]
 ds_read_b64_tr_b16 a[4:5], v7 offset:16416
 ds_read_b64_tr_b16 a[6:7], v7 offset:18208
 v_mfma_f32_16x16x32_bf16 v[116:119], a[28:31], a[84:87], v[116:119]
 ds_read_b128 a[64:67], v10 offset:0
 ds_read_b64_tr_b16 a[8:9], v7 offset:16448
 v_mfma_f32_16x16x32_bf16 v[36:39], a[32:35], a[72:75], v[36:39]
 ds_read_b64_tr_b16 a[10:11], v7 offset:18240
 ds_read_b128 a[68:71], v11 offset:0
 v_mfma_f32_16x16x32_bf16 v[64:67], a[32:35], a[76:79], v[64:67]
 ds_read_b64_tr_b16 a[12:13], v7 offset:16480
 ds_read_b64_tr_b16 a[14:15], v7 offset:18272
 v_mfma_f32_16x16x32_bf16 v[92:95], a[32:35], a[80:83], v[92:95]
 ds_read_b64_tr_b16 a[16:17], v7 offset:16512
 ds_read_b64_tr_b16 a[18:19], v7 offset:18304
 v_mfma_f32_16x16x32_bf16 v[120:123], a[32:35], a[84:87], v[120:123]
 ds_read_b64_tr_b16 a[20:21], v7 offset:16544
 ds_read_b64_tr_b16 a[22:23], v7 offset:18336
 v_mfma_f32_16x16x32_bf16 v[40:43], a[36:39], a[72:75], v[40:43]
 ds_read_b64_tr_b16 a[24:25], v7 offset:16576
 ds_read_b64_tr_b16 a[26:27], v7 offset:18368
 v_mfma_f32_16x16x32_bf16 v[68:71], a[36:39], a[76:79], v[68:71]
 v_mfma_f32_16x16x32_bf16 v[96:99], a[36:39], a[80:83], v[96:99]
 v_mfma_f32_16x16x32_bf16 v[124:127], a[36:39], a[84:87], v[124:127]
 v_mfma_f32_16x16x32_bf16 v[44:47], a[40:43], a[72:75], v[44:47]
 v_mfma_f32_16x16x32_bf16 v[72:75], a[40:43], a[76:79], v[72:75]
 v_mfma_f32_16x16x32_bf16 v[100:103], a[40:43], a[80:83], v[100:103]
 s_waitcnt lgkmcnt(0)
 s_add_u32 s20, s20, 7168
 s_add_u32 m0, s22, 16384
 v_mfma_f32_16x16x32_bf16 v[128:131], a[40:43], a[84:87], v[128:131]
 buffer_load_dwordx4 v1, s[8:11], s20 offen offset:0 lds
 buffer_load_dwordx4 v1, s[8:11], s20 offen offset:1024 lds
 v_mfma_f32_16x16x32_bf16 v[48:51], a[44:47], a[72:75], v[48:51]
 buffer_load_dwordx4 v1, s[8:11], s20 offen offset:2048 lds
 buffer_load_dwordx4 v1, s[8:11], s20 offen offset:3072 lds
 v_mfma_f32_16x16x32_bf16 v[76:79], a[44:47], a[76:79], v[76:79]
 s_add_u32 m0, s22, 20480
 s_nop 0
 buffer_load_dwordx4 v2, s[8:11], s20 offen offset:0 lds
 v_mfma_f32_16x16x32_bf16 v[104:107], a[44:47], a[80:83], v[104:107]
 buffer_load_dwordx4 v2, s[8:11], s20 offen offset:1024 lds
 buffer_load_dwordx4 v2, s[8:11], s20 offen offset:2048 lds
 v_mfma_f32_16x16x32_bf16 v[132:135], a[44:47], a[84:87], v[132:135]
 v_mfma_f32_16x16x32_bf16 v[52:55], a[48:51], a[72:75], v[52:55]
 v_mfma_f32_16x16x32_bf16 v[80:83], a[48:51], a[76:79], v[80:83]
 v_mfma_f32_16x16x32_bf16 v[108:111], a[48:51], a[80:83], v[108:111]
 v_mfma_f32_16x16x32_bf16 v[136:139], a[48:51], a[84:87], v[136:139]
 v_mfma_f32_16x16x32_bf16 v[56:59], a[52:55], a[72:75], v[56:59]
 v_mfma_f32_16x16x32_bf16 v[84:87], a[52:55], a[76:79], v[84:87]
 v_mfma_f32_16x16x32_bf16 v[112:115], a[52:55], a[80:83], v[112:115]
 v_mfma_f32_16x16x32_bf16 v[140:143], a[52:55], a[84:87], v[140:143]
 s_waitcnt vmcnt(22)
 v_mfma_f32_16x16x32_bf16 v[32:35], a[0:3], a[56:59], v[32:35]
 ds_read_b128 a[72:75], v25 offset:0
 ds_read_b64_tr_b16 a[28:29], v7 offset:23552
 v_mfma_f32_16x16x32_bf16 v[60:63], a[0:3], a[60:63], v[60:63]
 ds_read_b64_tr_b16 a[30:31], v7 offset:25344
 ds_read_b128 a[76:79], v26 offset:0
 v_mfma_f32_16x16x32_bf16 v[88:91], a[0:3], a[64:67], v[88:91]
 ds_read_b64_tr_b16 a[32:33], v7 offset:23584
 ds_read_b64_tr_b16 a[34:35], v7 offset:25376
 v_mfma_f32_16x16x32_bf16 v[116:119], a[0:3], a[68:71], v[116:119]
 ds_read_b128 a[80:83], v27 offset:0
 ds_read_b64_tr_b16 a[36:37], v7 offset:23616
 v_mfma_f32_16x16x32_bf16 v[36:39], a[4:7], a[56:59], v[36:39]
 ds_read_b64_tr_b16 a[38:39], v7 offset:25408
 ds_read_b128 a[84:87], v28 offset:0
 v_mfma_f32_16x16x32_bf16 v[64:67], a[4:7], a[60:63], v[64:67]
 ds_read_b64_tr_b16 a[40:41], v7 offset:23648
 ds_read_b64_tr_b16 a[42:43], v7 offset:25440
 v_mfma_f32_16x16x32_bf16 v[92:95], a[4:7], a[64:67], v[92:95]
 ds_read_b64_tr_b16 a[44:45], v7 offset:23680
 ds_read_b64_tr_b16 a[46:47], v7 offset:25472
 v_mfma_f32_16x16x32_bf16 v[120:123], a[4:7], a[68:71], v[120:123]
 ds_read_b64_tr_b16 a[48:49], v7 offset:23712
 ds_read_b64_tr_b16 a[50:51], v7 offset:25504
 v_mfma_f32_16x16x32_bf16 v[40:43], a[8:11], a[56:59], v[40:43]
 ds_read_b64_tr_b16 a[52:53], v7 offset:23744
 ds_read_b64_tr_b16 a[54:55], v7 offset:25536
 v_mfma_f32_16x16x32_bf16 v[68:71], a[8:11], a[60:63], v[68:71]
 v_mfma_f32_16x16x32_bf16 v[96:99], a[8:11], a[64:67], v[96:99]
 v_mfma_f32_16x16x32_bf16 v[124:127], a[8:11], a[68:71], v[124:127]
 v_mfma_f32_16x16x32_bf16 v[44:47], a[12:15], a[56:59], v[44:47]
 v_mfma_f32_16x16x32_bf16 v[72:75], a[12:15], a[60:63], v[72:75]
 v_mfma_f32_16x16x32_bf16 v[100:103], a[12:15], a[64:67], v[100:103]
 s_waitcnt lgkmcnt(0)
 buffer_load_dwordx4 v[228:231], v16, s[8:11], s30 offen
 buffer_load_dwordx4 v[232:235], v16, s[8:11], s30 offen offset:2048
 v_mfma_f32_16x16x32_bf16 v[128:131], a[12:15], a[68:71], v[128:131]
 buffer_load_dwordx4 v[236:239], v19, s[8:11], s30 offen
 buffer_load_dwordx2 v[240:241], v17, s[8:11], s30 offen
 v_mfma_f32_16x16x32_bf16 v[48:51], a[16:19], a[56:59], v[48:51]
 buffer_load_ushort v242, v18, s[16:19], s31 offen
 v_mfma_f32_16x16x32_bf16 v[76:79], a[16:19], a[60:63], v[76:79]
 v_mfma_f32_16x16x32_bf16 v[104:107], a[16:19], a[64:67], v[104:107]
 v_mfma_f32_16x16x32_bf16 v[132:135], a[16:19], a[68:71], v[132:135]
 v_mfma_f32_16x16x32_bf16 v[52:55], a[20:23], a[56:59], v[52:55]
 v_mfma_f32_16x16x32_bf16 v[80:83], a[20:23], a[60:63], v[80:83]
 v_mfma_f32_16x16x32_bf16 v[108:111], a[20:23], a[64:67], v[108:111]
 v_mfma_f32_16x16x32_bf16 v[136:139], a[20:23], a[68:71], v[136:139]
 v_mfma_f32_16x16x32_bf16 v[56:59], a[24:27], a[56:59], v[56:59]
 v_mfma_f32_16x16x32_bf16 v[84:87], a[24:27], a[60:63], v[84:87]
 v_mfma_f32_16x16x32_bf16 v[112:115], a[24:27], a[64:67], v[112:115]
 v_mfma_f32_16x16x32_bf16 v[140:143], a[24:27], a[68:71], v[140:143]
 s_waitcnt vmcnt(12)
 v_mfma_f32_16x16x32_bf16 v[32:35], a[28:31], a[72:75], v[32:35]
 ds_read_b128 a[56:59], v8 offset:8192
 ds_read_b64_tr_b16 a[0:1], v7 offset:30720
 v_mfma_f32_16x16x32_bf16 v[60:63], a[28:31], a[76:79], v[60:63]
 ds_read_b64_tr_b16 a[2:3], v7 offset:32512
 ds_read_b128 a[60:63], v9 offset:8192
 v_mfma_f32_16x16x32_bf16 v[88:91], a[28:31], a[80:83], v[88:91]
 ds_read_b64_tr_b16 a[4:5], v7 offset:30752
 ds_read_b64_tr_b16 a[6:7], v7 offset:32544
 v_mfma_f32_16x16x32_bf16 v[116:119], a[28:31], a[84:87], v[116:119]
 ds_read_b128 a[64:67], v10 offset:8192
 ds_read_b64_tr_b16 a[8:9], v7 offset:30784
 v_mfma_f32_16x16x32_bf16 v[36:39], a[32:35], a[72:75], v[36:39]
 ds_read_b64_tr_b16 a[10:11], v7 offset:32576
 ds_read_b128 a[68:71], v11 offset:8192
 v_mfma_f32_16x16x32_bf16 v[64:67], a[32:35], a[76:79], v[64:67]
 ds_read_b64_tr_b16 a[12:13], v7 offset:30816
 ds_read_b64_tr_b16 a[14:15], v7 offset:32608
 v_mfma_f32_16x16x32_bf16 v[92:95], a[32:35], a[80:83], v[92:95]
 ds_read_b64_tr_b16 a[16:17], v7 offset:30848
 ds_read_b64_tr_b16 a[18:19], v7 offset:32640
 v_mfma_f32_16x16x32_bf16 v[120:123], a[32:35], a[84:87], v[120:123]
 ds_read_b64_tr_b16 a[20:21], v7 offset:30880
 ds_read_b64_tr_b16 a[22:23], v7 offset:32672
 v_mfma_f32_16x16x32_bf16 v[40:43], a[36:39], a[72:75], v[40:43]
 ds_read_b64_tr_b16 a[24:25], v7 offset:30912
 ds_read_b64_tr_b16 a[26:27], v7 offset:32704
 v_mfma_f32_16x16x32_bf16 v[68:71], a[36:39], a[76:79], v[68:71]
 v_mfma_f32_16x16x32_bf16 v[96:99], a[36:39], a[80:83], v[96:99]
 v_mfma_f32_16x16x32_bf16 v[124:127], a[36:39], a[84:87], v[124:127]
 v_mfma_f32_16x16x32_bf16 v[44:47], a[40:43], a[72:75], v[44:47]
 v_mfma_f32_16x16x32_bf16 v[72:75], a[40:43], a[76:79], v[72:75]
 v_mfma_f32_16x16x32_bf16 v[100:103], a[40:43], a[80:83], v[100:103]
 v_mfma_f32_16x16x32_bf16 v[128:131], a[40:43], a[84:87], v[128:131]
 v_mfma_f32_16x16x32_bf16 v[48:51], a[44:47], a[72:75], v[48:51]
 v_mfma_f32_16x16x32_bf16 v[76:79], a[44:47], a[76:79], v[76:79]
 v_mfma_f32_16x16x32_bf16 v[104:107], a[44:47], a[80:83], v[104:107]
 v_mfma_f32_16x16x32_bf16 v[132:135], a[44:47], a[84:87], v[132:135]
 v_mfma_f32_16x16x32_bf16 v[52:55], a[48:51], a[72:75], v[52:55]
 v_mfma_f32_16x16x32_bf16 v[80:83], a[48:51], a[76:79], v[80:83]
 v_mfma_f32_16x16x32_bf16 v[108:111], a[48:51], a[80:83], v[108:111]
 v_mfma_f32_16x16x32_bf16 v[136:139], a[48:51], a[84:87], v[136:139]
 v_mfma_f32_16x16x32_bf16 v[56:59], a[52:55], a[72:75], v[56:59]
 v_mfma_f32_16x16x32_bf16 v[84:87], a[52:55], a[76:79], v[84:87]
 v_mfma_f32_16x16x32_bf16 v[112:115], a[52:55], a[80:83], v[112:115]
 v_mfma_f32_16x16x32_bf16 v[140:143], a[52:55], a[84:87], v[140:143]
 s_waitcnt vmcnt(5) lgkmcnt(15)
 v_mfma_f32_16x16x32_bf16 v[32:35], a[0:3], a[56:59], v[32:35]
 ds_read_b128 a[72:75], v25 offset:8192
 ds_read_b64_tr_b16 a[28:29], v7 offset:16384
 s_waitcnt lgkmcnt(15)
 v_mfma_f32_16x16x32_bf16 v[60:63], a[0:3], a[60:63], v[60:63]
 ds_read_b64_tr_b16 a[30:31], v7 offset:18176
 ds_read_b128 a[76:79], v26 offset:8192
 s_waitcnt lgkmcnt(15)
 v_mfma_f32_16x16x32_bf16 v[88:91], a[0:3], a[64:67], v[88:91]
 ds_read_b64_tr_b16 a[32:33], v7 offset:16416
 ds_read_b64_tr_b16 a[34:35], v7 offset:18208
 s_waitcnt lgkmcnt(14)
 v_mfma_f32_16x16x32_bf16 v[116:119], a[0:3], a[68:71], v[116:119]
 ds_read_b128 a[80:83], v27 offset:8192
 ds_read_b64_tr_b16 a[36:37], v7 offset:16448
 v_mfma_f32_16x16x32_bf16 v[36:39], a[4:7], a[56:59], v[36:39]
 ds_read_b64_tr_b16 a[38:39], v7 offset:18240
 ds_read_b128 a[84:87], v28 offset:8192
 v_mfma_f32_16x16x32_bf16 v[64:67], a[4:7], a[60:63], v[64:67]
 ds_read_b64_tr_b16 a[40:41], v7 offset:16480
 ds_read_b64_tr_b16 a[42:43], v7 offset:18272
 v_mfma_f32_16x16x32_bf16 v[92:95], a[4:7], a[64:67], v[92:95]
 ds_read_b64_tr_b16 a[44:45], v7 offset:16512
 ds_read_b64_tr_b16 a[46:47], v7 offset:18304
 v_mfma_f32_16x16x32_bf16 v[120:123], a[4:7], a[68:71], v[120:123]
 ds_read_b64_tr_b16 a[48:49], v7 offset:16544
 ds_read_b64_tr_b16 a[50:51], v7 offset:18336
 v_mfma_f32_16x16x32_bf16 v[40:43], a[8:11], a[56:59], v[40:43]
 ds_read_b64_tr_b16 a[52:53], v7 offset:16576
 ds_read_b64_tr_b16 a[54:55], v7 offset:18368
 v_mfma_f32_16x16x32_bf16 v[68:71], a[8:11], a[60:63], v[68:71]
 v_mfma_f32_16x16x32_bf16 v[96:99], a[8:11], a[64:67], v[96:99]
 v_mfma_f32_16x16x32_bf16 v[124:127], a[8:11], a[68:71], v[124:127]
 s_waitcnt lgkmcnt(15)
 v_mfma_f32_16x16x32_bf16 v[44:47], a[12:15], a[56:59], v[44:47]
 v_mfma_f32_16x16x32_bf16 v[72:75], a[12:15], a[60:63], v[72:75]
 v_mfma_f32_16x16x32_bf16 v[100:103], a[12:15], a[64:67], v[100:103]
 v_mfma_f32_16x16x32_bf16 v[128:131], a[12:15], a[68:71], v[128:131]
 v_mfma_f32_16x16x32_bf16 v[48:51], a[16:19], a[56:59], v[48:51]
 v_mfma_f32_16x16x32_bf16 v[76:79], a[16:19], a[60:63], v[76:79]
 v_mfma_f32_16x16x32_bf16 v[104:107], a[16:19], a[64:67], v[104:107]
 v_mfma_f32_16x16x32_bf16 v[132:135], a[16:19], a[68:71], v[132:135]
 v_mfma_f32_16x16x32_bf16 v[52:55], a[20:23], a[56:59], v[52:55]
 v_mfma_f32_16x16x32_bf16 v[80:83], a[20:23], a[60:63], v[80:83]
 v_mfma_f32_16x16x32_bf16 v[108:111], a[20:23], a[64:67], v[108:111]
 v_mfma_f32_16x16x32_bf16 v[136:139], a[20:23], a[68:71], v[136:139]
 v_mfma_f32_16x16x32_bf16 v[56:59], a[24:27], a[56:59], v[56:59]
 v_mfma_f32_16x16x32_bf16 v[84:87], a[24:27], a[60:63], v[84:87]
 v_mfma_f32_16x16x32_bf16 v[112:115], a[24:27], a[64:67], v[112:115]
 v_mfma_f32_16x16x32_bf16 v[140:143], a[24:27], a[68:71], v[140:143]
 s_waitcnt lgkmcnt(14)
 v_mfma_f32_16x16x32_bf16 v[60:63], a[28:31], a[76:79], v[60:63]
 s_waitcnt lgkmcnt(12)
 v_mfma_f32_16x16x32_bf16 v[64:67], a[32:35], a[76:79], v[64:67]
 s_waitcnt lgkmcnt(9)
 v_mfma_f32_16x16x32_bf16 v[68:71], a[36:39], a[76:79], v[68:71]
 s_waitcnt lgkmcnt(6)
 v_mfma_f32_16x16x32_bf16 v[72:75], a[40:43], a[76:79], v[72:75]
 s_waitcnt lgkmcnt(4)
 v_mfma_f32_16x16x32_bf16 v[76:79], a[44:47], a[76:79], v[76:79]
 s_waitcnt lgkmcnt(2)
 v_mfma_f32_16x16x32_bf16 v[80:83], a[48:51], a[76:79], v[80:83]
 ds_write_b128 v12, v[60:63] offset:0
 s_waitcnt lgkmcnt(1)
 v_mfma_f32_16x16x32_bf16 v[84:87], a[52:55], a[76:79], v[84:87]
 ds_write_b128 v12, v[64:67] offset:1024
 v_mfma_f32_16x16x32_bf16 v[88:91], a[28:31], a[80:83], v[88:91]
 ds_write_b128 v12, v[68:71] offset:2048
 v_mfma_f32_16x16x32_bf16 v[92:95], a[32:35], a[80:83], v[92:95]
 ds_write_b128 v12, v[72:75] offset:3072
 v_mfma_f32_16x16x32_bf16 v[96:99], a[36:39], a[80:83], v[96:99]
 ds_write_b128 v12, v[76:79] offset:4096
 v_mfma_f32_16x16x32_bf16 v[100:103], a[40:43], a[80:83], v[100:103]
 ds_write_b128 v12, v[80:83] offset:5120
 v_mfma_f32_16x16x32_bf16 v[104:107], a[44:47], a[80:83], v[104:107]
 ds_write_b128 v12, v[84:87] offset:6144
 v_mfma_f32_16x16x32_bf16 v[108:111], a[48:51], a[80:83], v[108:111]
 ds_write_b128 v12, v[88:91] offset:7168
 v_mfma_f32_16x16x32_bf16 v[112:115], a[52:55], a[80:83], v[112:115]
 ds_write_b128 v12, v[92:95] offset:8192
 v_mfma_f32_16x16x32_bf16 v[116:119], a[28:31], a[84:87], v[116:119]
 ds_write_b128 v12, v[96:99] offset:9216
 v_mfma_f32_16x16x32_bf16 v[120:123], a[32:35], a[84:87], v[120:123]
 ds_write_b128 v12, v[100:103] offset:10240
 v_mfma_f32_16x16x32_bf16 v[124:127], a[36:39], a[84:87], v[124:127]
 ds_write_b128 v12, v[104:107] offset:11264
 v_mfma_f32_16x16x32_bf16 v[128:131], a[40:43], a[84:87], v[128:131]
 ds_write_b128 v12, v[108:111] offset:12288
 v_mfma_f32_16x16x32_bf16 v[132:135], a[44:47], a[84:87], v[132:135]
 ds_write_b128 v12, v[112:115] offset:13312
 v_mfma_f32_16x16x32_bf16 v[136:139], a[48:51], a[84:87], v[136:139]
 ds_write_b128 v12, v[116:119] offset:14336
 v_mfma_f32_16x16x32_bf16 v[140:143], a[52:55], a[84:87], v[140:143]
 ds_write_b128 v12, v[120:123] offset:15360
 v_mfma_f32_16x16x32_bf16 v[32:35], a[28:31], a[72:75], v[32:35]
 ds_write_b128 v12, v[124:127] offset:16384
 v_mfma_f32_16x16x32_bf16 v[36:39], a[32:35], a[72:75], v[36:39]
 ds_write_b128 v12, v[128:131] offset:17408
 v_mfma_f32_16x16x32_bf16 v[40:43], a[36:39], a[72:75], v[40:43]
 ds_write_b128 v12, v[132:135] offset:18432
 v_mfma_f32_16x16x32_bf16 v[44:47], a[40:43], a[72:75], v[44:47]
 ds_write_b128 v12, v[136:139] offset:19456
 v_mfma_f32_16x16x32_bf16 v[48:51], a[44:47], a[72:75], v[48:51]
 ds_write_b128 v12, v[140:143] offset:20480
 v_mfma_f32_16x16x32_bf16 v[52:55], a[48:51], a[72:75], v[52:55]
 v_mfma_f32_16x16x32_bf16 v[56:59], a[52:55], a[72:75], v[56:59]
 s_waitcnt lgkmcnt(0)
 s_barrier
 ds_read_b128 v[144:147], v13 offset:0
 ds_read_b128 v[148:151], v14 offset:7168
 ds_read_b128 v[152:155], v15 offset:14336
 ds_read_b128 v[156:159], v13 offset:1024
 ds_read_b128 v[160:163], v14 offset:8192
 ds_read_b128 v[164:167], v15 offset:15360
 ds_read_b128 v[168:171], v13 offset:2048
 ds_read_b128 v[172:175], v14 offset:9216
 ds_read_b128 v[176:179], v15 offset:16384
 ds_read_b128 v[180:183], v13 offset:3072
 ds_read_b128 v[184:187], v14 offset:10240
 ds_read_b128 v[188:191], v15 offset:17408
 ds_read_b128 v[192:195], v13 offset:4096
 ds_read_b128 v[196:199], v14 offset:11264
 ds_read_b128 v[200:203], v15 offset:18432
 ds_read_b128 v[204:207], v13 offset:5120
 ds_read_b128 v[208:211], v14 offset:12288
 ds_read_b128 v[212:215], v15 offset:19456
 ds_read_b128 v[216:219], v13 offset:6144
 ds_read_b128 v[220:223], v14 offset:13312
 ds_read_b128 v[224:227], v15 offset:20480
 s_waitcnt vmcnt(0)
 v_lshlrev_b32 v242, 16, v242
 v_pk_add_f32 v[32:33], v[32:33], v[242:243] op_sel_hi:[1,0]
 v_pk_add_f32 v[34:35], v[34:35], v[242:243] op_sel_hi:[1,0]
 v_lshlrev_b32 v60, 16, v228
 v_and_b32 v61, 0xffff0000, v228
 v_lshlrev_b32 v62, 16, v229
 v_and_b32 v63, 0xffff0000, v229
 v_pk_add_f32 v[36:37], v[36:37], v[242:243] op_sel_hi:[1,0]
 v_pk_add_f32 v[38:39], v[38:39], v[242:243] op_sel_hi:[1,0]
 v_lshlrev_b32 v64, 16, v230
 v_and_b32 v65, 0xffff0000, v230
 v_lshlrev_b32 v66, 16, v231
 v_and_b32 v67, 0xffff0000, v231
 v_pk_add_f32 v[40:41], v[40:41], v[242:243] op_sel_hi:[1,0]
 v_pk_add_f32 v[42:43], v[42:43], v[242:243] op_sel_hi:[1,0]
 v_lshlrev_b32 v68, 16, v232
 v_and_b32 v69, 0xffff0000, v232
 v_lshlrev_b32 v70, 16, v233
 v_and_b32 v71, 0xffff0000, v233
 v_pk_add_f32 v[44:45], v[44:45], v[242:243] op_sel_hi:[1,0]
 v_pk_add_f32 v[46:47], v[46:47], v[242:243] op_sel_hi:[1,0]
 v_lshlrev_b32 v72, 16, v234
 v_and_b32 v73, 0xffff0000, v234
 v_lshlrev_b32 v74, 16, v235
 v_and_b32 v75, 0xffff0000, v235
 v_pk_add_f32 v[48:49], v[48:49], v[242:243] op_sel_hi:[1,0]
 v_pk_add_f32 v[50:51], v[50:51], v[242:243] op_sel_hi:[1,0]
 v_lshlrev_b32 v76, 16, v236
 v_and_b32 v77, 0xffff0000, v236
 v_lshlrev_b32 v78, 16, v237
 v_and_b32 v79, 0xffff0000, v237
 v_pk_add_f32 v[52:53], v[52:53], v[242:243] op_sel_hi:[1,0]
 v_pk_add_f32 v[54:55], v[54:55], v[242:243] op_sel_hi:[1,0]
 v_lshlrev_b32 v80, 16, v238
 v_and_b32 v81, 0xffff0000, v238
 v_lshlrev_b32 v82, 16, v239
 v_and_b32 v83, 0xffff0000, v239
 v_pk_add_f32 v[56:57], v[56:57], v[242:243] op_sel_hi:[1,0]
 v_pk_add_f32 v[58:59], v[58:59], v[242:243] op_sel_hi:[1,0]
 v_lshlrev_b32 v84, 16, v240
 v_and_b32 v85, 0xffff0000, v240
 v_lshlrev_b32 v86, 16, v241
 v_and_b32 v87, 0xffff0000, v241
 s_waitcnt lgkmcnt(15)
 v_pk_add_f32 v[144:145], v[144:145], v[148:149]
 v_pk_add_f32 v[32:33], v[32:33], v[152:153]
 v_pk_add_f32 v[146:147], v[146:147], v[150:151]
 v_pk_add_f32 v[34:35], v[34:35], v[154:155]
 v_pk_add_f32 v[32:33], v[32:33], v[144:145]
 v_pk_add_f32 v[34:35], v[34:35], v[146:147]
 v_pk_mul_f32 v[32:33], v[32:33], v[60:61]
 v_pk_mul_f32 v[34:35], v[34:35], v[62:63]
 v_cvt_pk_bf16_f32 v100, v32, v33
 v_cvt_pk_bf16_f32 v101, v34, v35
 v_pk_add_f32 v[156:157], v[156:157], v[160:161]
 v_pk_add_f32 v[36:37], v[36:37], v[164:165]
 v_pk_add_f32 v[158:159], v[158:159], v[162:163]
 v_pk_add_f32 v[38:39], v[38:39], v[166:167]
 v_pk_add_f32 v[36:37], v[36:37], v[156:157]
 v_pk_add_f32 v[38:39], v[38:39], v[158:159]
 v_pk_mul_f32 v[36:37], v[36:37], v[64:65]
 v_pk_mul_f32 v[38:39], v[38:39], v[66:67]
 v_cvt_pk_bf16_f32 v102, v36, v37
 v_cvt_pk_bf16_f32 v103, v38, v39
 buffer_store_dwordx4 v[100:103], v16, s[8:11], s23 offen sc1
 s_waitcnt lgkmcnt(13)
 v_pk_add_f32 v[168:169], v[168:169], v[172:173]
 s_waitcnt lgkmcnt(12)
 v_pk_add_f32 v[40:41], v[40:41], v[176:177]
 v_pk_add_f32 v[170:171], v[170:171], v[174:175]
 v_pk_add_f32 v[42:43], v[42:43], v[178:179]
 v_pk_add_f32 v[40:41], v[40:41], v[168:169]
 v_pk_add_f32 v[42:43], v[42:43], v[170:171]
 v_pk_mul_f32 v[40:41], v[40:41], v[68:69]
 v_pk_mul_f32 v[42:43], v[42:43], v[70:71]
 v_cvt_pk_bf16_f32 v104, v40, v41
 v_cvt_pk_bf16_f32 v105, v42, v43
 s_waitcnt lgkmcnt(10)
 v_pk_add_f32 v[180:181], v[180:181], v[184:185]
 s_waitcnt lgkmcnt(9)
 v_pk_add_f32 v[44:45], v[44:45], v[188:189]
 v_pk_add_f32 v[182:183], v[182:183], v[186:187]
 v_pk_add_f32 v[46:47], v[46:47], v[190:191]
 v_pk_add_f32 v[44:45], v[44:45], v[180:181]
 v_pk_add_f32 v[46:47], v[46:47], v[182:183]
 v_pk_mul_f32 v[44:45], v[44:45], v[72:73]
 v_pk_mul_f32 v[46:47], v[46:47], v[74:75]
 v_cvt_pk_bf16_f32 v106, v44, v45
 v_cvt_pk_bf16_f32 v107, v46, v47
 buffer_store_dwordx4 v[104:107], v16, s[8:11], s23 offen offset:2048 sc1
 s_waitcnt lgkmcnt(7)
 v_pk_add_f32 v[192:193], v[192:193], v[196:197]
 s_waitcnt lgkmcnt(6)
 v_pk_add_f32 v[48:49], v[48:49], v[200:201]
 v_pk_add_f32 v[194:195], v[194:195], v[198:199]
 v_pk_add_f32 v[50:51], v[50:51], v[202:203]
 v_pk_add_f32 v[48:49], v[48:49], v[192:193]
 v_pk_add_f32 v[50:51], v[50:51], v[194:195]
 v_pk_mul_f32 v[48:49], v[48:49], v[76:77]
 v_pk_mul_f32 v[50:51], v[50:51], v[78:79]
 v_cvt_pk_bf16_f32 v108, v48, v49
 v_cvt_pk_bf16_f32 v109, v50, v51
 s_waitcnt lgkmcnt(4)
 v_pk_add_f32 v[204:205], v[204:205], v[208:209]
 s_waitcnt lgkmcnt(3)
 v_pk_add_f32 v[52:53], v[52:53], v[212:213]
 v_pk_add_f32 v[206:207], v[206:207], v[210:211]
 v_pk_add_f32 v[54:55], v[54:55], v[214:215]
 v_pk_add_f32 v[52:53], v[52:53], v[204:205]
 v_pk_add_f32 v[54:55], v[54:55], v[206:207]
 v_pk_mul_f32 v[52:53], v[52:53], v[80:81]
 v_pk_mul_f32 v[54:55], v[54:55], v[82:83]
 v_cvt_pk_bf16_f32 v110, v52, v53
 v_cvt_pk_bf16_f32 v111, v54, v55
 buffer_store_dwordx4 v[108:111], v19, s[8:11], s23 offen sc1
 s_waitcnt lgkmcnt(1)
 v_pk_add_f32 v[216:217], v[216:217], v[220:221]
 s_waitcnt lgkmcnt(0)
 v_pk_add_f32 v[56:57], v[56:57], v[224:225]
 v_pk_add_f32 v[218:219], v[218:219], v[222:223]
 v_pk_add_f32 v[58:59], v[58:59], v[226:227]
 v_pk_add_f32 v[56:57], v[56:57], v[216:217]
 v_pk_add_f32 v[58:59], v[58:59], v[218:219]
 v_pk_mul_f32 v[56:57], v[56:57], v[84:85]
 v_pk_mul_f32 v[58:59], v[58:59], v[86:87]
 v_cvt_pk_bf16_f32 v112, v56, v57
 v_cvt_pk_bf16_f32 v113, v58, v59
 buffer_store_dwordx2 v[112:113], v17, s[8:11], s23 offen sc1
K3_END:
 s_endpgm
.globl k4_kernel
.p2align 8
.type k4_kernel,@function
k4_kernel:
 s_cmp_ge_u32 s2, 224
 s_cbranch_scc1 K4_END
 s_load_dwordx2 s[40:41], s[0:1], 112
 s_load_dwordx2 s[42:43], s[0:1], 72
 s_load_dwordx2 s[44:45], s[0:1], 96
 v_lshrrev_b32 v20, 6, v0
 v_and_b32 v0, 63, v0
 v_readfirstlane_b32 s3, v20
 s_and_b32 s30, s2, 7
 s_lshl_b32 s30, s30, 2
 s_bfe_u32 s31, s2, 0x20003
 s_add_u32 s4, s30, s31
 s_lshr_b32 s5, s2, 5
 v_lshlrev_b32 v1, 4, v0
 v_lshrrev_b32 v20, 3, v0
 v_and_b32 v21, 7, v0
 v_bfe_u32 v22, v0, 4, 1
 v_lshlrev_b32 v22, 2, v22
 v_xor_b32 v21, v21, v22
 v_lshlrev_b32 v21, 4, v21
 v_mul_u32_u24 v22, 896, v20
 v_add_u32 v3, v22, v21
 v_lshrrev_b32 v22, 5, v0
 v_mul_u32_u24 v22, 10752, v22
 v_add_u32 v2, v22, v3
 s_lshr_b32 s30, s3, 1
 s_lshl_b32 s31, s4, 1
 s_add_u32 s33, s31, s30
 s_xor_b32 s32, s33, 1
 s_mul_i32 s34, s3, 14336
 s_add_u32 s34, s34, 14680064
 s_mul_i32 s20, s33, 57344
 s_add_u32 s20, s20, s34
 s_mul_i32 s21, s32, 57344
 s_add_u32 s21, s21, s34
 s_mul_i32 s22, s3, 200704
 s_lshl_b32 s31, s5, 7
 s_add_u32 s22, s22, s31
 s_mul_i32 s23, s3, 28672
 s_waitcnt lgkmcnt(0)
 s_mov_b32 s8, s40
 s_mov_b32 s9, s41
 s_mov_b32 s10, 0x2300000
 s_mov_b32 s11, 0x00020000
 s_mov_b32 s12, s42
 s_mov_b32 s13, s43
 s_mov_b32 s14, 0xc4000
 s_mov_b32 s15, 0x00020000
 s_mov_b32 s16, s44
 s_mov_b32 s17, s45
 s_mov_b32 s18, 0x1c0000
 s_mov_b32 s19, 0x00020000
 s_add_u32 s35, s22, 0
 s_add_u32 m0, s23, 0
 s_nop 0
 buffer_load_dwordx4 v2, s[12:15], s35 offen lds
 s_add_u32 s35, s22, 3584
 s_add_u32 m0, s23, 1024
 s_nop 0
 buffer_load_dwordx4 v2, s[12:15], s35 offen lds
 buffer_load_dwordx4 a[0:3], v1, s[8:11], s20 offen offset:0
 buffer_load_dwordx4 a[4:7], v1, s[8:11], s21 offen offset:0
 s_add_u32 s35, s22, 7168
 s_add_u32 m0, s23, 2048
 s_nop 0
 buffer_load_dwordx4 v2, s[12:15], s35 offen lds
 s_add_u32 s35, s22, 10752
 s_add_u32 m0, s23, 3072
 s_nop 0
 buffer_load_dwordx4 v2, s[12:15], s35 offen lds
 buffer_load_dwordx4 a[8:11], v1, s[8:11], s20 offen offset:1024
 buffer_load_dwordx4 a[12:15], v1, s[8:11], s21 offen offset:1024
 s_add_u32 s35, s22, 28672
 s_add_u32 m0, s23, 4096
 s_nop 0
 buffer_load_dwordx4 v2, s[12:15], s35 offen lds
 s_add_u32 s35, s22, 32256
 s_add_u32 m0, s23, 5120
 s_nop 0
 buffer_load_dwordx4 v2, s[12:15], s35 offen lds
 buffer_load_dwordx4 a[16:19], v1, s[8:11], s20 offen offset:2048
 buffer_load_dwordx4 a[20:23], v1, s[8:11], s21 offen offset:2048
 s_add_u32 s35, s22, 35840
 s_add_u32 m0, s23, 6144
 s_nop 0
 buffer_load_dwordx4 v2, s[12:15], s35 offen lds
 s_add_u32 s35, s22, 39424
 s_add_u32 m0, s23, 7168
 s_nop 0
 buffer_load_dwordx4 v2, s[12:15], s35 offen lds
 buffer_load_dwordx4 a[24:27], v1, s[8:11], s20 offen offset:3072
 buffer_load_dwordx4 a[28:31], v1, s[8:11], s21 offen offset:3072
 s_add_u32 s35, s22, 57344
 s_add_u32 m0, s23, 8192
 s_nop 0
 buffer_load_dwordx4 v2, s[12:15], s35 offen lds
 s_add_u32 s35, s22, 60928
 s_add_u32 m0, s23, 9216
 s_nop 0
 buffer_load_dwordx4 v2, s[12:15], s35 offen lds
 s_add_u32 s20, s20, 4096
 buffer_load_dwordx4 a[32:35], v1, s[8:11], s20 offen offset:0
 s_add_u32 s21, s21, 4096
 buffer_load_dwordx4 a[36:39], v1, s[8:11], s21 offen offset:0
 s_add_u32 s35, s22, 64512
 s_add_u32 m0, s23, 10240
 s_nop 0
 buffer_load_dwordx4 v2, s[12:15], s35 offen lds
 s_add_u32 s35, s22, 68096
 s_add_u32 m0, s23, 11264
 s_nop 0
 buffer_load_dwordx4 v2, s[12:15], s35 offen lds
 buffer_load_dwordx4 a[40:43], v1, s[8:11], s20 offen offset:1024
 buffer_load_dwordx4 a[44:47], v1, s[8:11], s21 offen offset:1024
 v_bfe_u32 v20, v0, 2, 2
 v_lshlrev_b32 v20, 7, v20
 v_lshrrev_b32 v21, 5, v0
 v_lshl_add_u32 v20, v21, 10, v20
 v_bfe_u32 v21, v0, 4, 1
 v_lshl_add_u32 v20, v21, 5, v20
 v_and_b32 v21, 1, v0
 v_lshl_add_u32 v20, v21, 4, v20
 v_bfe_u32 v21, v0, 1, 1
 v_lshl_add_u32 v20, v21, 3, v20
 v_bfe_u32 v21, v0, 3, 1
 s_and_b32 s36, s3, 1
 v_xor_b32 v21, s36, v21
 v_lshl_add_u32 v20, v21, 6, v20
 v_add_u32 v4, s23, v20
 v_xor_b32 v5, 64, v4
 v_add_u32 v6, s23, v1
 s_xor_b32 s30, s3, 1
 s_mul_i32 s30, s30, 28672
 v_add_u32 v7, s30, v1
 s_xor_b32 s30, s3, 2
 s_mul_i32 s30, s30, 28672
 v_add_u32 v8, s30, v1
 s_xor_b32 s30, s3, 3
 s_mul_i32 s30, s30, 28672
 v_add_u32 v9, s30, v1
 v_lshrrev_b32 v21, 5, v0
 v_lshlrev_b32 v10, 5, v21
 v_and_b32 v20, 31, v0
 v_mul_u32_u24 v20, 896, v20
 v_lshl_add_u32 v11, v21, 4, v20
 s_lshl_b32 s37, s5, 1
 s_add_u32 s37, s37, s36
 s_mul_i32 s38, s33, 28672
 s_lshl_b32 s30, s37, 11
 s_add_u32 s30, s30, s38
 s_add_u32 s30, s30, 2097152
 s_lshl_b32 s31, s37, 7
 s_add_u32 s31, s31, 8960
 s_lshl_b32 s39, s37, 6
 s_add_u32 s39, s39, s38
 s_waitcnt vmcnt(22)
 ds_read_b64_tr_b16 a[112:113], v4 offset:0
 ds_read_b64_tr_b16 a[114:115], v4 offset:512
 ds_read_b64_tr_b16 a[116:117], v5 offset:0
 ds_read_b64_tr_b16 a[118:119], v5 offset:512
 s_waitcnt vmcnt(18) lgkmcnt(2)
 v_mfma_f32_32x32x16_bf16 v[32:47], a[112:115], a[0:3], 0
 ds_read_b64_tr_b16 a[120:121], v4 offset:2048
 s_add_u32 s35, s22, 86016
 s_add_u32 m0, s23, 12288
 s_nop 0
 buffer_load_dwordx4 v3, s[12:15], s35 offen lds
 v_mfma_f32_32x32x16_bf16 v[64:79], a[112:115], a[4:7], 0
 ds_read_b64_tr_b16 a[122:123], v4 offset:2560
 s_add_u32 s35, s22, 93184
 s_add_u32 m0, s23, 13312
 s_nop 0
 buffer_load_dwordx4 v3, s[12:15], s35 offen lds
 s_waitcnt lgkmcnt(2)
 v_mfma_f32_32x32x16_bf16 v[48:63], a[116:119], a[0:3], 0
 ds_read_b64_tr_b16 a[124:125], v5 offset:2048
 buffer_load_dwordx4 a[48:51], v1, s[8:11], s20 offen offset:2048
 v_mfma_f32_32x32x16_bf16 v[80:95], a[116:119], a[4:7], 0
 ds_read_b64_tr_b16 a[126:127], v5 offset:2560
 buffer_load_dwordx4 a[52:55], v1, s[8:11], s21 offen offset:2048
 s_waitcnt vmcnt(18) lgkmcnt(2)
 v_mfma_f32_32x32x16_bf16 v[32:47], a[120:123], a[8:11], v[32:47]
 ds_read_b64_tr_b16 a[128:129], v4 offset:4096
 s_add_u32 s35, s22, 100352
 s_add_u32 m0, s23, 14336
 s_nop 0
 buffer_load_dwordx4 v2, s[12:15], s35 offen lds
 v_mfma_f32_32x32x16_bf16 v[64:79], a[120:123], a[12:15], v[64:79]
 ds_read_b64_tr_b16 a[130:131], v4 offset:4608
 s_add_u32 s35, s22, 103936
 s_add_u32 m0, s23, 15360
 s_nop 0
 buffer_load_dwordx4 v2, s[12:15], s35 offen lds
 s_waitcnt lgkmcnt(2)
 v_mfma_f32_32x32x16_bf16 v[48:63], a[124:127], a[8:11], v[48:63]
 ds_read_b64_tr_b16 a[132:133], v5 offset:4096
 buffer_load_dwordx4 a[56:59], v1, s[8:11], s20 offen offset:3072
 v_mfma_f32_32x32x16_bf16 v[80:95], a[124:127], a[12:15], v[80:95]
 ds_read_b64_tr_b16 a[134:135], v5 offset:4608
 buffer_load_dwordx4 a[60:63], v1, s[8:11], s21 offen offset:3072
 s_waitcnt vmcnt(18) lgkmcnt(2)
 v_mfma_f32_32x32x16_bf16 v[32:47], a[128:131], a[16:19], v[32:47]
 ds_read_b64_tr_b16 a[136:137], v4 offset:6144
 s_add_u32 s35, s22, 107520
 s_add_u32 m0, s23, 16384
 s_nop 0
 buffer_load_dwordx4 v2, s[12:15], s35 offen lds
 v_mfma_f32_32x32x16_bf16 v[64:79], a[128:131], a[20:23], v[64:79]
 ds_read_b64_tr_b16 a[138:139], v4 offset:6656
 s_add_u32 s35, s22, 111104
 s_add_u32 m0, s23, 17408
 s_nop 0
 buffer_load_dwordx4 v2, s[12:15], s35 offen lds
 s_waitcnt lgkmcnt(2)
 v_mfma_f32_32x32x16_bf16 v[48:63], a[132:135], a[16:19], v[48:63]
 ds_read_b64_tr_b16 a[140:141], v5 offset:6144
 s_add_u32 s20, s20, 4096
 buffer_load_dwordx4 a[64:67], v1, s[8:11], s20 offen offset:0
 v_mfma_f32_32x32x16_bf16 v[80:95], a[132:135], a[20:23], v[80:95]
 ds_read_b64_tr_b16 a[142:143], v5 offset:6656
 s_add_u32 s21, s21, 4096
 buffer_load_dwordx4 a[68:71], v1, s[8:11], s21 offen offset:0
 s_waitcnt vmcnt(18) lgkmcnt(2)
 v_mfma_f32_32x32x16_bf16 v[32:47], a[136:139], a[24:27], v[32:47]
 ds_read_b64_tr_b16 a[112:113], v4 offset:8192
 s_add_u32 s35, s22, 129024
 s_add_u32 m0, s23, 18432
 s_nop 0
 buffer_load_dwordx4 v2, s[12:15], s35 offen lds
 v_mfma_f32_32x32x16_bf16 v[64:79], a[136:139], a[28:31], v[64:79]
 ds_read_b64_tr_b16 a[114:115], v4 offset:8704
 s_add_u32 s35, s22, 132608
 s_add_u32 m0, s23, 19456
 s_nop 0
 buffer_load_dwordx4 v2, s[12:15], s35 offen lds
 s_waitcnt lgkmcnt(2)
 v_mfma_f32_32x32x16_bf16 v[48:63], a[140:143], a[24:27], v[48:63]
 ds_read_b64_tr_b16 a[116:117], v5 offset:8192
 buffer_load_dwordx4 a[72:75], v1, s[8:11], s20 offen offset:1024
 v_mfma_f32_32x32x16_bf16 v[80:95], a[140:143], a[28:31], v[80:95]
 ds_read_b64_tr_b16 a[118:119], v5 offset:8704
 buffer_load_dwordx4 a[76:79], v1, s[8:11], s21 offen offset:1024
 s_waitcnt vmcnt(18) lgkmcnt(2)
 v_mfma_f32_32x32x16_bf16 v[32:47], a[112:115], a[32:35], v[32:47]
 ds_read_b64_tr_b16 a[120:121], v4 offset:10240
 s_add_u32 s35, s22, 136192
 s_add_u32 m0, s23, 20480
 s_nop 0
 buffer_load_dwordx4 v2, s[12:15], s35 offen lds
 v_mfma_f32_32x32x16_bf16 v[64:79], a[112:115], a[36:39], v[64:79]
 ds_read_b64_tr_b16 a[122:123], v4 offset:10752
 s_add_u32 s35, s22, 139776
 s_add_u32 m0, s23, 21504
 s_nop 0
 buffer_load_dwordx4 v2, s[12:15], s35 offen lds
 s_waitcnt lgkmcnt(2)
 v_mfma_f32_32x32x16_bf16 v[48:63], a[116:119], a[32:35], v[48:63]
 ds_read_b64_tr_b16 a[124:125], v5 offset:10240
 buffer_load_dwordx4 a[80:83], v1, s[8:11], s20 offen offset:2048
 v_mfma_f32_32x32x16_bf16 v[80:95], a[116:119], a[36:39], v[80:95]
 ds_read_b64_tr_b16 a[126:127], v5 offset:10752
 buffer_load_dwordx4 a[84:87], v1, s[8:11], s21 offen offset:2048
 s_waitcnt vmcnt(18) lgkmcnt(2)
 v_mfma_f32_32x32x16_bf16 v[32:47], a[120:123], a[40:43], v[32:47]
 ds_read_b64_tr_b16 a[128:129], v4 offset:12288
 s_add_u32 s35, s22, 157696
 s_add_u32 m0, s23, 22528
 s_nop 0
 buffer_load_dwordx4 v2, s[12:15], s35 offen lds
 v_mfma_f32_32x32x16_bf16 v[64:79], a[120:123], a[44:47], v[64:79]
 ds_read_b64_tr_b16 a[130:131], v4 offset:12800
 s_add_u32 s35, s22, 161280
 s_add_u32 m0, s23, 23552
 s_nop 0
 buffer_load_dwordx4 v2, s[12:15], s35 offen lds
 s_waitcnt lgkmcnt(2)
 v_mfma_f32_32x32x16_bf16 v[48:63], a[124:127], a[40:43], v[48:63]
 ds_read_b64_tr_b16 a[132:133], v5 offset:12288
 buffer_load_dwordx4 a[88:91], v1, s[8:11], s20 offen offset:3072
 v_mfma_f32_32x32x16_bf16 v[80:95], a[124:127], a[44:47], v[80:95]
 ds_read_b64_tr_b16 a[134:135], v5 offset:12800
 buffer_load_dwordx4 a[92:95], v1, s[8:11], s21 offen offset:3072
 s_waitcnt vmcnt(18) lgkmcnt(2)
 v_mfma_f32_32x32x16_bf16 v[32:47], a[128:131], a[48:51], v[32:47]
 ds_read_b64_tr_b16 a[136:137], v4 offset:14336
 s_add_u32 s35, s22, 164864
 s_add_u32 m0, s23, 24576
 s_nop 0
 buffer_load_dwordx4 v2, s[12:15], s35 offen lds
 v_mfma_f32_32x32x16_bf16 v[64:79], a[128:131], a[52:55], v[64:79]
 ds_read_b64_tr_b16 a[138:139], v4 offset:14848
 s_add_u32 s35, s22, 168448
 s_add_u32 m0, s23, 25600
 s_nop 0
 buffer_load_dwordx4 v2, s[12:15], s35 offen lds
 s_waitcnt lgkmcnt(2)
 v_mfma_f32_32x32x16_bf16 v[48:63], a[132:135], a[48:51], v[48:63]
 ds_read_b64_tr_b16 a[140:141], v5 offset:14336
 s_add_u32 s20, s20, 4096
 buffer_load_dwordx4 a[96:99], v1, s[8:11], s20 offen offset:0
 v_mfma_f32_32x32x16_bf16 v[80:95], a[132:135], a[52:55], v[80:95]
 ds_read_b64_tr_b16 a[142:143], v5 offset:14848
 s_add_u32 s21, s21, 4096
 buffer_load_dwordx4 a[100:103], v1, s[8:11], s21 offen offset:0
 s_waitcnt vmcnt(18) lgkmcnt(2)
 v_mfma_f32_32x32x16_bf16 v[32:47], a[136:139], a[56:59], v[32:47]
 ds_read_b64_tr_b16 a[112:113], v4 offset:16384
 s_add_u32 s35, s22, 186368
 s_add_u32 m0, s23, 26624
 s_nop 0
 buffer_load_dwordx4 v3, s[12:15], s35 offen lds
 v_mfma_f32_32x32x16_bf16 v[64:79], a[136:139], a[60:63], v[64:79]
 ds_read_b64_tr_b16 a[114:115], v4 offset:16896
 s_add_u32 s35, s22, 193536
 s_add_u32 m0, s23, 27648
 s_nop 0
 buffer_load_dwordx4 v3, s[12:15], s35 offen lds
 s_waitcnt lgkmcnt(2)
 v_mfma_f32_32x32x16_bf16 v[48:63], a[140:143], a[56:59], v[48:63]
 ds_read_b64_tr_b16 a[116:117], v5 offset:16384
 buffer_load_dwordx4 a[104:107], v1, s[8:11], s20 offen offset:1024
 v_mfma_f32_32x32x16_bf16 v[80:95], a[140:143], a[60:63], v[80:95]
 ds_read_b64_tr_b16 a[118:119], v5 offset:16896
 buffer_load_dwordx4 a[108:111], v1, s[8:11], s21 offen offset:1024
 s_waitcnt vmcnt(18) lgkmcnt(2)
 v_mfma_f32_32x32x16_bf16 v[32:47], a[112:115], a[64:67], v[32:47]
 ds_read_b64_tr_b16 a[120:121], v4 offset:18432
 buffer_load_dwordx4 v[144:147], v1, s[8:11], s30 offen offset:0
 v_mfma_f32_32x32x16_bf16 v[64:79], a[112:115], a[68:71], v[64:79]
 ds_read_b64_tr_b16 a[122:123], v4 offset:18944
 buffer_load_dwordx4 v[148:151], v1, s[8:11], s30 offen offset:1024
 s_waitcnt lgkmcnt(2)
 v_mfma_f32_32x32x16_bf16 v[48:63], a[116:119], a[64:67], v[48:63]
 ds_read_b64_tr_b16 a[124:125], v5 offset:18432
 buffer_load_dwordx4 v[152:155], v10, s[8:11], s31 offen offset:0
 v_mfma_f32_32x32x16_bf16 v[80:95], a[116:119], a[68:71], v[80:95]
 ds_read_b64_tr_b16 a[126:127], v5 offset:18944
 buffer_load_dwordx4 v[156:159], v10, s[8:11], s31 offen offset:16
 s_waitcnt vmcnt(18) lgkmcnt(2)
 v_mfma_f32_32x32x16_bf16 v[32:47], a[120:123], a[72:75], v[32:47]
 ds_read_b64_tr_b16 a[128:129], v4 offset:20480
 buffer_load_dwordx4 v[160:163], v10, s[8:11], s31 offen offset:64
 v_mfma_f32_32x32x16_bf16 v[64:79], a[120:123], a[76:79], v[64:79]
 ds_read_b64_tr_b16 a[130:131], v4 offset:20992
 buffer_load_dwordx4 v[164:167], v10, s[8:11], s31 offen offset:80
 s_waitcnt lgkmcnt(2)
 v_mfma_f32_32x32x16_bf16 v[48:63], a[124:127], a[72:75], v[48:63]
 ds_read_b64_tr_b16 a[132:133], v5 offset:20480
 v_mfma_f32_32x32x16_bf16 v[80:95], a[124:127], a[76:79], v[80:95]
 ds_read_b64_tr_b16 a[134:135], v5 offset:20992
 s_waitcnt vmcnt(16) lgkmcnt(2)
 v_mfma_f32_32x32x16_bf16 v[32:47], a[128:131], a[80:83], v[32:47]
 ds_read_b64_tr_b16 a[136:137], v4 offset:22528
 v_mfma_f32_32x32x16_bf16 v[64:79], a[128:131], a[84:87], v[64:79]
 ds_read_b64_tr_b16 a[138:139], v4 offset:23040
 s_waitcnt lgkmcnt(2)
 v_mfma_f32_32x32x16_bf16 v[48:63], a[132:135], a[80:83], v[48:63]
 ds_read_b64_tr_b16 a[140:141], v5 offset:22528
 v_mfma_f32_32x32x16_bf16 v[80:95], a[132:135], a[84:87], v[80:95]
 ds_read_b64_tr_b16 a[142:143], v5 offset:23040
 s_waitcnt vmcnt(12) lgkmcnt(2)
 v_mfma_f32_32x32x16_bf16 v[32:47], a[136:139], a[88:91], v[32:47]
 ds_read_b64_tr_b16 a[112:113], v4 offset:24576
 v_mfma_f32_32x32x16_bf16 v[64:79], a[136:139], a[92:95], v[64:79]
 ds_read_b64_tr_b16 a[114:115], v4 offset:25088
 s_waitcnt lgkmcnt(2)
 v_mfma_f32_32x32x16_bf16 v[48:63], a[140:143], a[88:91], v[48:63]
 ds_read_b64_tr_b16 a[116:117], v5 offset:24576
 v_mfma_f32_32x32x16_bf16 v[80:95], a[140:143], a[92:95], v[80:95]
 ds_read_b64_tr_b16 a[118:119], v5 offset:25088
 s_waitcnt vmcnt(8) lgkmcnt(2)
 v_mfma_f32_32x32x16_bf16 v[32:47], a[112:115], a[96:99], v[32:47]
 ds_read_b64_tr_b16 a[120:121], v4 offset:26624
 v_mfma_f32_32x32x16_bf16 v[64:79], a[112:115], a[100:103], v[64:79]
 ds_read_b64_tr_b16 a[122:123], v4 offset:27136
 s_waitcnt lgkmcnt(2)
 v_mfma_f32_32x32x16_bf16 v[48:63], a[116:119], a[96:99], v[48:63]
 ds_read_b64_tr_b16 a[124:125], v5 offset:26624
 v_mfma_f32_32x32x16_bf16 v[80:95], a[116:119], a[100:103], v[80:95]
 ds_read_b64_tr_b16 a[126:127], v5 offset:27136
 s_waitcnt vmcnt(7) lgkmcnt(0)
 v_mfma_f32_32x32x16_bf16 v[48:63], a[124:127], a[104:107], v[48:63]
 s_waitcnt vmcnt(6)
 v_mfma_f32_32x32x16_bf16 v[64:79], a[120:123], a[108:111], v[64:79]
 v_mfma_f32_32x32x16_bf16 v[80:95], a[124:127], a[108:111], v[80:95]
 v_mfma_f32_32x32x16_bf16 v[32:47], a[120:123], a[104:107], v[32:47]
 s_nop 7
 ds_write_b128 v6, v[48:51] offset:0
 ds_write_b128 v6, v[52:55] offset:1024
 ds_write_b128 v6, v[56:59] offset:2048
 ds_write_b128 v6, v[60:63] offset:3072
 ds_write_b128 v6, v[64:67] offset:4096
 ds_write_b128 v6, v[68:71] offset:5120
 ds_write_b128 v6, v[72:75] offset:6144
 ds_write_b128 v6, v[76:79] offset:7168
 ds_write_b128 v6, v[80:83] offset:8192
 ds_write_b128 v6, v[84:87] offset:9216
 ds_write_b128 v6, v[88:91] offset:10240
 ds_write_b128 v6, v[92:95] offset:11264
 s_waitcnt lgkmcnt(0)
 s_barrier
 ds_read_b128 v[96:99], v7 offset:0
 ds_read_b128 v[112:115], v8 offset:4096
 ds_read_b128 v[128:131], v9 offset:8192
 ds_read_b128 v[100:103], v7 offset:1024
 ds_read_b128 v[116:119], v8 offset:5120
 ds_read_b128 v[132:135], v9 offset:9216
 ds_read_b128 v[104:107], v7 offset:2048
 ds_read_b128 v[120:123], v8 offset:6144
 ds_read_b128 v[136:139], v9 offset:10240
 ds_read_b128 v[108:111], v7 offset:3072
 ds_read_b128 v[124:127], v8 offset:7168
 ds_read_b128 v[140:143], v9 offset:11264
 s_waitcnt vmcnt(5)
 v_lshlrev_b32 v48, 16, v144
 v_and_b32 v49, 0xffff0000, v144
 v_lshlrev_b32 v50, 16, v145
 v_and_b32 v51, 0xffff0000, v145
 v_lshlrev_b32 v52, 16, v146
 v_and_b32 v53, 0xffff0000, v146
 v_lshlrev_b32 v54, 16, v147
 v_and_b32 v55, 0xffff0000, v147
 s_waitcnt vmcnt(4)
 v_lshlrev_b32 v56, 16, v148
 v_and_b32 v57, 0xffff0000, v148
 v_lshlrev_b32 v58, 16, v149
 v_and_b32 v59, 0xffff0000, v149
 v_lshlrev_b32 v60, 16, v150
 v_and_b32 v61, 0xffff0000, v150
 v_lshlrev_b32 v62, 16, v151
 v_and_b32 v63, 0xffff0000, v151
 s_waitcnt lgkmcnt(11)
 v_pk_add_f32 v[32:33], v[32:33], v[96:97]
 s_waitcnt lgkmcnt(9)
 v_pk_add_f32 v[112:113], v[112:113], v[128:129]
 v_pk_add_f32 v[34:35], v[34:35], v[98:99]
 v_pk_add_f32 v[114:115], v[114:115], v[130:131]
 s_waitcnt lgkmcnt(8)
 v_pk_add_f32 v[36:37], v[36:37], v[100:101]
 s_waitcnt lgkmcnt(6)
 v_pk_add_f32 v[116:117], v[116:117], v[132:133]
 v_pk_add_f32 v[38:39], v[38:39], v[102:103]
 v_pk_add_f32 v[118:119], v[118:119], v[134:135]
 v_pk_add_f32 v[32:33], v[32:33], v[112:113]
 v_pk_add_f32 v[34:35], v[34:35], v[114:115]
 v_pk_add_f32 v[36:37], v[36:37], v[116:117]
 v_pk_add_f32 v[38:39], v[38:39], v[118:119]
 s_waitcnt vmcnt(3)
 v_pk_fma_f32 v[32:33], v[32:33], v[152:153], v[48:49]
 v_pk_fma_f32 v[34:35], v[34:35], v[154:155], v[50:51]
 s_waitcnt vmcnt(2)
 v_pk_fma_f32 v[36:37], v[36:37], v[156:157], v[52:53]
 v_pk_fma_f32 v[38:39], v[38:39], v[158:159], v[54:55]
 v_cvt_pk_bf16_f32 v64, v32, v33
 v_cvt_pk_bf16_f32 v65, v34, v35
 v_cvt_pk_bf16_f32 v66, v36, v37
 v_cvt_pk_bf16_f32 v67, v38, v39
 buffer_store_dwordx4 v[64:67], v11, s[16:19], s39 offen offset:0
 s_waitcnt lgkmcnt(5)
 v_pk_add_f32 v[40:41], v[40:41], v[104:105]
 s_waitcnt lgkmcnt(3)
 v_pk_add_f32 v[120:121], v[120:121], v[136:137]
 v_pk_add_f32 v[42:43], v[42:43], v[106:107]
 v_pk_add_f32 v[122:123], v[122:123], v[138:139]
 s_waitcnt lgkmcnt(2)
 v_pk_add_f32 v[44:45], v[44:45], v[108:109]
 s_waitcnt lgkmcnt(0)
 v_pk_add_f32 v[124:125], v[124:125], v[140:141]
 v_pk_add_f32 v[46:47], v[46:47], v[110:111]
 v_pk_add_f32 v[126:127], v[126:127], v[142:143]
 v_pk_add_f32 v[40:41], v[40:41], v[120:121]
 v_pk_add_f32 v[42:43], v[42:43], v[122:123]
 v_pk_add_f32 v[44:45], v[44:45], v[124:125]
 v_pk_add_f32 v[46:47], v[46:47], v[126:127]
 s_waitcnt vmcnt(2)
 v_pk_fma_f32 v[40:41], v[40:41], v[160:161], v[56:57]
 v_pk_fma_f32 v[42:43], v[42:43], v[162:163], v[58:59]
 s_waitcnt vmcnt(1)
 v_pk_fma_f32 v[44:45], v[44:45], v[164:165], v[60:61]
 v_pk_fma_f32 v[46:47], v[46:47], v[166:167], v[62:63]
 v_cvt_pk_bf16_f32 v68, v40, v41
 v_cvt_pk_bf16_f32 v69, v42, v43
 v_cvt_pk_bf16_f32 v70, v44, v45
 v_cvt_pk_bf16_f32 v71, v46, v47
 buffer_store_dwordx4 v[68:71], v11, s[16:19], s39 offen offset:32
K4_END:
 s_endpgm
.section .rodata,"a"
.p2align 6
.amdhsa_kernel k1_kernel
  .amdhsa_next_free_vgpr 512
  .amdhsa_next_free_sgpr 102
  .amdhsa_accum_offset 256
  .amdhsa_group_segment_fixed_size 0
  .amdhsa_kernarg_size 120
  .amdhsa_user_sgpr_count 2
  .amdhsa_user_sgpr_kernarg_segment_ptr 1
  .amdhsa_system_sgpr_workgroup_id_x 1
.end_amdhsa_kernel
.p2align 6
.amdhsa_kernel k2a_kernel
  .amdhsa_next_free_vgpr 88
  .amdhsa_next_free_sgpr 102
  .amdhsa_accum_offset 88
  .amdhsa_group_segment_fixed_size 0
  .amdhsa_kernarg_size 120
  .amdhsa_user_sgpr_count 2
  .amdhsa_user_sgpr_kernarg_segment_ptr 1
  .amdhsa_system_sgpr_workgroup_id_x 1
.end_amdhsa_kernel
.p2align 6
.amdhsa_kernel k2b_kernel
  .amdhsa_next_free_vgpr 312
  .amdhsa_next_free_sgpr 102
  .amdhsa_accum_offset 168
  .amdhsa_group_segment_fixed_size 0
  .amdhsa_kernarg_size 120
  .amdhsa_user_sgpr_count 2
  .amdhsa_user_sgpr_kernarg_segment_ptr 1
  .amdhsa_system_sgpr_workgroup_id_x 1
.end_amdhsa_kernel
.p2align 6
.amdhsa_kernel k3_kernel
  .amdhsa_next_free_vgpr 336
  .amdhsa_next_free_sgpr 102
  .amdhsa_accum_offset 248
  .amdhsa_group_segment_fixed_size 0
  .amdhsa_kernarg_size 120
  .amdhsa_user_sgpr_count 2
  .amdhsa_user_sgpr_kernarg_segment_ptr 1
  .amdhsa_system_sgpr_workgroup_id_x 1
.end_amdhsa_kernel
.p2align 6
.amdhsa_kernel k4_kernel
  .amdhsa_next_free_vgpr 312
  .amdhsa_next_free_sgpr 102
  .amdhsa_accum_offset 168
  .amdhsa_group_segment_fixed_size 0
  .amdhsa_kernarg_size 120
  .amdhsa_user_sgpr_count 2
  .amdhsa_user_sgpr_kernarg_segment_ptr 1
  .amdhsa_system_sgpr_workgroup_id_x 1
.end_amdhsa_kernel
```
